```python
import torch

def _softmax(x, axis=-1):
    return torch.softmax(x, dim=axis)
def _gelu(x):
    return torch.nn.functional.gelu(x, approximate="tanh")
def _silu(x):
    return torch.nn.functional.silu(x)
def _sigmoid(x):
    return torch.sigmoid(x)
def _layernorm(x, axis=-1, eps=1e-5):
    m = x.mean(dim=axis, keepdim=True)
    v = x.var(dim=axis, keepdim=True, unbiased=False)
    return (x - m) / torch.sqrt(v + eps)
def _scatter_add(tgt, idx, src, axis=0):
    return tgt.clone().index_add_(axis, idx, src)
def _segment_sum(src, seg, n):
    out = torch.zeros((n,) + src.shape[1:], dtype=src.dtype)
    return out.index_add_(0, seg, src)
def _pad(x, pw):
    flat = tuple(v for pair in reversed(pw) for v in pair)
    return torch.nn.functional.pad(x, flat)

kernel_name = 'parallel_sum__mha_block__glu_gated_swiglu__prompt'

def setup_inputs():

    _w = (lambda a: (lambda t: t.to(torch.bfloat16) if t.is_floating_point() else t)(torch.as_tensor(a)))
    def _A_setup():
        B, S, D, H = 1, 2048, 1024, 32
        return {
            "x": _w((lambda *s: torch.randn(*s, dtype=torch.bfloat16) * 0.05)(B, S, D)),
            "wqkv": _w((lambda *s: torch.randn(*s, dtype=torch.bfloat16) * 0.05)(D, 3 * D)),
            "wo": _w((lambda *s: torch.randn(*s, dtype=torch.bfloat16) * 0.05)(D, D)),
        }
    _A_in = _A_setup()

    def _B_setup():
        B, S, D, F = 1, 2048, 1024, 3584
        return {
            "x": _w((lambda *s: torch.randn(*s, dtype=torch.bfloat16) * 0.05)(B, S, D)),
            "w1": _w((lambda *s: torch.randn(*s, dtype=torch.bfloat16) * 0.8)(D, F) * (2.0 / D) ** 0.5),
            "w3": _w((lambda *s: torch.randn(*s, dtype=torch.bfloat16) * 0.8)(D, F) * (2.0 / D) ** 0.5),
            "w2": _w((lambda *s: torch.randn(*s, dtype=torch.bfloat16) * 0.8)(F, D) * (2.0 / F) ** 0.5),
        }
    _B_in = _B_setup()

    return {
        "A_x": _A_in["x"],
        "A_wqkv": _A_in["wqkv"],
        "A_wo": _A_in["wo"],
        "B_x": _B_in["x"],
        "B_w1": _B_in["w1"],
        "B_w3": _B_in["w3"],
        "B_w2": _B_in["w2"],
    }

def reference(A_x, A_wqkv, A_wo, B_x, B_w1, B_w3, B_w2):
    def _A_ref(x, wqkv, wo):
        B, S, D = x.shape
        H = 32
        Dh = D // H
        qkv = (lambda x, *d: x.permute(*d))((x @ wqkv).reshape(B, S, 3, H, Dh), 2, 0, 3, 1, 4)
        q, k, v = qkv[0], qkv[1], qkv[2]
        scores = torch.einsum("bhqd,bhkd->bhqk", q, k) * (Dh ** -0.5)
        p = _softmax(scores, axis=-1)
        o = torch.einsum("bhqk,bhkd->bhqd", p, v)
        return (lambda x, *d: x.permute(*d))(o, 0, 2, 1, 3).reshape(B, S, D) @ wo

    def _B_ref(x, w1, w3, w2):
        gate = torch.einsum("bsd,df->bsf", x, w1)
        up = torch.einsum("bsd,df->bsf", x, w3)
        h = _silu(gate) * up
        out = torch.einsum("bsf,fd->bsd", h, w2)
        return out

    x = A_x
    xn = _layernorm(x, axis=-1)
    return x + _A_ref(xn, A_wqkv, A_wo) + _B_ref(xn, B_w1, B_w3, B_w2)
```

```asm
; @launch kernel=ln_kernel grid=(256,1,1) block=(512,1,1) lds=512
; @launch kernel=g1_kernel grid=(256,1,1) block=(256,1,1) lds=147456
; @launch kernel=k2_kernel grid=(768,1,1) block=(256,1,1) lds=50176
.amdgcn_target "amdgcn-amd-amdhsa--gfx950"
.text
.globl ln_kernel
.p2align 8
.type ln_kernel,@function
ln_kernel:
    s_load_dwordx2 s[4:5], s[0:1], 0
    s_load_dwordx2 s[6:7], s[0:1], 72
    s_cmp_ge_u32 s2, 256
    s_cbranch_scc1 ln_kernel_end
    v_and_b32 v1, 63, v0
    v_lshrrev_b32 v2, 6, v0
    v_and_b32 v3, 7, v1
    v_lshrrev_b32 v4, 3, v1
    s_lshl_b32 s3, s2, 14
    v_lshlrev_b32 v5, 11, v3
    v_lshl_add_u32 v5, v2, 8, v5
    v_lshl_add_u32 v5, v4, 4, v5
    s_mov_b32 s10, 0x400000
    s_mov_b32 s11, 0x00020000
    s_waitcnt lgkmcnt(0)
    s_mov_b32 s8, s4
    s_and_b32 s9, s5, 0xffff
    buffer_load_dwordx4 v[8:11], v5, s[8:11], s3 offen offset:0
    buffer_load_dwordx4 v[12:15], v5, s[8:11], s3 offen offset:128
    s_mov_b32 s12, s6
    s_and_b32 s13, s7, 0xffff
    s_mov_b32 s14, 0x10000000
    s_mov_b32 s15, 0x00020000
    v_and_b32 v6, 3, v4
    v_lshrrev_b32 v7, 2, v4
    v_lshlrev_b32 v60, 12, v2
    v_lshl_add_u32 v60, v7, 10, v60
    v_lshl_add_u32 v60, v6, 8, v60
    v_lshl_add_u32 v60, v3, 4, v60
    s_lshr_b32 s16, s2, 1
    s_lshl_b32 s16, s16, 15
    s_and_b32 s17, s2, 1
    s_lshl_b32 s17, s17, 7
    s_add_u32 s16, s16, s17
    v_lshlrev_b32 v61, 5, v3
    v_lshl_add_u32 v62, v2, 2, v61
    s_waitcnt vmcnt(1)
    v_lshlrev_b32 v24, 16, v8
    v_and_b32 v25, 0xffff0000, v8
    v_lshlrev_b32 v26, 16, v9
    v_and_b32 v27, 0xffff0000, v9
    v_lshlrev_b32 v28, 16, v10
    v_and_b32 v29, 0xffff0000, v10
    v_lshlrev_b32 v30, 16, v11
    v_and_b32 v31, 0xffff0000, v11
    s_waitcnt vmcnt(0)
    v_lshlrev_b32 v32, 16, v12
    v_and_b32 v33, 0xffff0000, v12
    v_lshlrev_b32 v34, 16, v13
    v_and_b32 v35, 0xffff0000, v13
    v_lshlrev_b32 v36, 16, v14
    v_and_b32 v37, 0xffff0000, v14
    v_lshlrev_b32 v38, 16, v15
    v_and_b32 v39, 0xffff0000, v15
    v_pk_add_f32 v[40:41], v[24:25], v[26:27]
    v_pk_add_f32 v[42:43], v[28:29], v[30:31]
    v_pk_add_f32 v[44:45], v[32:33], v[34:35]
    v_pk_add_f32 v[46:47], v[36:37], v[38:39]
    v_pk_add_f32 v[40:41], v[40:41], v[42:43]
    v_pk_add_f32 v[44:45], v[44:45], v[46:47]
    v_pk_add_f32 v[40:41], v[40:41], v[44:45]
    v_add_f32 v56, v40, v41
    s_nop 1
    v_add_f32_dpp v56, v56, v56 row_ror:8 row_mask:0xf bank_mask:0xf
    v_mov_b32 v63, v56
    s_nop 1
    v_permlane16_swap_b32 v56, v63
    v_add_f32 v56, v56, v63
    v_mov_b32 v63, v56
    s_nop 1
    v_permlane32_swap_b32 v56, v63
    v_add_f32 v56, v56, v63
    ds_write_b32 v62, v56 offset:0
    s_waitcnt lgkmcnt(0)
    s_barrier
    ds_read_b128 v[64:67], v61 offset:0
    ds_read_b128 v[68:71], v61 offset:16
    s_waitcnt lgkmcnt(1)
    v_pk_add_f32 v[64:65], v[64:65], v[66:67]
    s_waitcnt lgkmcnt(0)
    v_pk_add_f32 v[68:69], v[68:69], v[70:71]
    v_pk_add_f32 v[64:65], v[64:65], v[68:69]
    v_add_f32 v56, v64, v65
    v_mul_f32 v56, 0x3a800000, v56
    v_pk_add_f32 v[40:41], v[24:25], v[56:57] op_sel_hi:[1,0] neg_lo:[0,1] neg_hi:[0,1]
    v_pk_add_f32 v[42:43], v[26:27], v[56:57] op_sel_hi:[1,0] neg_lo:[0,1] neg_hi:[0,1]
    v_pk_add_f32 v[44:45], v[28:29], v[56:57] op_sel_hi:[1,0] neg_lo:[0,1] neg_hi:[0,1]
    v_pk_add_f32 v[46:47], v[30:31], v[56:57] op_sel_hi:[1,0] neg_lo:[0,1] neg_hi:[0,1]
    v_pk_add_f32 v[48:49], v[32:33], v[56:57] op_sel_hi:[1,0] neg_lo:[0,1] neg_hi:[0,1]
    v_pk_add_f32 v[50:51], v[34:35], v[56:57] op_sel_hi:[1,0] neg_lo:[0,1] neg_hi:[0,1]
    v_pk_add_f32 v[52:53], v[36:37], v[56:57] op_sel_hi:[1,0] neg_lo:[0,1] neg_hi:[0,1]
    v_pk_add_f32 v[54:55], v[38:39], v[56:57] op_sel_hi:[1,0] neg_lo:[0,1] neg_hi:[0,1]
    v_pk_mul_f32 v[8:9], v[40:41], v[40:41]
    v_pk_mul_f32 v[10:11], v[42:43], v[42:43]
    v_pk_fma_f32 v[8:9], v[44:45], v[44:45], v[8:9]
    v_pk_fma_f32 v[10:11], v[46:47], v[46:47], v[10:11]
    v_pk_fma_f32 v[8:9], v[48:49], v[48:49], v[8:9]
    v_pk_fma_f32 v[10:11], v[50:51], v[50:51], v[10:11]
    v_pk_fma_f32 v[8:9], v[52:53], v[52:53], v[8:9]
    v_pk_fma_f32 v[10:11], v[54:55], v[54:55], v[10:11]
    v_pk_add_f32 v[8:9], v[8:9], v[10:11]
    v_add_f32 v58, v8, v9
    v_cvt_pk_bf16_f32 v57, v56, v56
    v_and_b32 v56, 0xffff0000, v57
    v_pk_add_f32 v[24:25], v[24:25], v[56:57] op_sel_hi:[1,0] neg_lo:[0,1] neg_hi:[0,1]
    v_pk_add_f32 v[26:27], v[26:27], v[56:57] op_sel_hi:[1,0] neg_lo:[0,1] neg_hi:[0,1]
    v_pk_add_f32 v[28:29], v[28:29], v[56:57] op_sel_hi:[1,0] neg_lo:[0,1] neg_hi:[0,1]
    v_pk_add_f32 v[30:31], v[30:31], v[56:57] op_sel_hi:[1,0] neg_lo:[0,1] neg_hi:[0,1]
    v_pk_add_f32 v[32:33], v[32:33], v[56:57] op_sel_hi:[1,0] neg_lo:[0,1] neg_hi:[0,1]
    v_pk_add_f32 v[34:35], v[34:35], v[56:57] op_sel_hi:[1,0] neg_lo:[0,1] neg_hi:[0,1]
    v_pk_add_f32 v[36:37], v[36:37], v[56:57] op_sel_hi:[1,0] neg_lo:[0,1] neg_hi:[0,1]
    v_pk_add_f32 v[38:39], v[38:39], v[56:57] op_sel_hi:[1,0] neg_lo:[0,1] neg_hi:[0,1]
    v_add_f32_dpp v58, v58, v58 row_ror:8 row_mask:0xf bank_mask:0xf
    v_mov_b32 v63, v58
    s_nop 1
    v_permlane16_swap_b32 v58, v63
    v_add_f32 v58, v58, v63
    v_mov_b32 v63, v58
    s_nop 1
    v_permlane32_swap_b32 v58, v63
    v_add_f32 v58, v58, v63
    ds_write_b32 v62, v58 offset:256
    v_cvt_pk_bf16_f32 v8, v24, v25
    v_cvt_pk_bf16_f32 v9, v26, v27
    v_cvt_pk_bf16_f32 v10, v28, v29
    v_cvt_pk_bf16_f32 v11, v30, v31
    v_cvt_pk_bf16_f32 v12, v32, v33
    v_cvt_pk_bf16_f32 v13, v34, v35
    v_cvt_pk_bf16_f32 v14, v36, v37
    v_cvt_pk_bf16_f32 v15, v38, v39
    v_lshlrev_b32 v24, 16, v8
    v_and_b32 v25, 0xffff0000, v8
    v_lshlrev_b32 v26, 16, v9
    v_and_b32 v27, 0xffff0000, v9
    v_lshlrev_b32 v28, 16, v10
    v_and_b32 v29, 0xffff0000, v10
    v_lshlrev_b32 v30, 16, v11
    v_and_b32 v31, 0xffff0000, v11
    v_lshlrev_b32 v32, 16, v12
    v_and_b32 v33, 0xffff0000, v12
    v_lshlrev_b32 v34, 16, v13
    v_and_b32 v35, 0xffff0000, v13
    v_lshlrev_b32 v36, 16, v14
    v_and_b32 v37, 0xffff0000, v14
    v_lshlrev_b32 v38, 16, v15
    v_and_b32 v39, 0xffff0000, v15
    s_waitcnt lgkmcnt(0)
    s_barrier
    ds_read_b128 v[64:67], v61 offset:256
    ds_read_b128 v[68:71], v61 offset:272
    s_waitcnt lgkmcnt(1)
    v_pk_add_f32 v[64:65], v[64:65], v[66:67]
    s_waitcnt lgkmcnt(0)
    v_pk_add_f32 v[68:69], v[68:69], v[70:71]
    v_pk_add_f32 v[64:65], v[64:65], v[68:69]
    v_add_f32 v58, v64, v65
    v_mul_f32 v58, 0x3a800000, v58
    v_cvt_pk_bf16_f32 v58, v58, v58
    v_and_b32 v58, 0xffff0000, v58
    v_add_f32 v58, 0x3727c5ac, v58
    v_cvt_pk_bf16_f32 v58, v58, v58
    v_and_b32 v58, 0xffff0000, v58
    v_sqrt_f32 v58, v58
    s_nop 0
    v_cvt_pk_bf16_f32 v58, v58, v58
    v_and_b32 v58, 0xffff0000, v58
    v_rcp_f32 v58, v58
    s_nop 0
    v_pk_mul_f32 v[24:25], v[24:25], v[58:59] op_sel_hi:[1,0]
    v_cvt_pk_bf16_f32 v8, v24, v25
    v_pk_mul_f32 v[26:27], v[26:27], v[58:59] op_sel_hi:[1,0]
    v_cvt_pk_bf16_f32 v9, v26, v27
    v_pk_mul_f32 v[28:29], v[28:29], v[58:59] op_sel_hi:[1,0]
    v_cvt_pk_bf16_f32 v10, v28, v29
    v_pk_mul_f32 v[30:31], v[30:31], v[58:59] op_sel_hi:[1,0]
    v_cvt_pk_bf16_f32 v11, v30, v31
    buffer_store_dwordx4 v[8:11], v60, s[12:15], s16 offen offset:0
    v_pk_mul_f32 v[32:33], v[32:33], v[58:59] op_sel_hi:[1,0]
    v_cvt_pk_bf16_f32 v12, v32, v33
    v_pk_mul_f32 v[34:35], v[34:35], v[58:59] op_sel_hi:[1,0]
    v_cvt_pk_bf16_f32 v13, v34, v35
    v_pk_mul_f32 v[36:37], v[36:37], v[58:59] op_sel_hi:[1,0]
    v_cvt_pk_bf16_f32 v14, v36, v37
    v_pk_mul_f32 v[38:39], v[38:39], v[58:59] op_sel_hi:[1,0]
    v_cvt_pk_bf16_f32 v15, v38, v39
    buffer_store_dwordx4 v[12:15], v60, s[12:15], s16 offen offset:2048
ln_kernel_end:
    s_endpgm
.section .rodata,"a"
.p2align 6
.amdhsa_kernel ln_kernel
  .amdhsa_next_free_vgpr 72
  .amdhsa_next_free_sgpr 102
  .amdhsa_accum_offset 72
  .amdhsa_group_segment_fixed_size 0
  .amdhsa_kernarg_size 80
  .amdhsa_user_sgpr_count 2
  .amdhsa_user_sgpr_kernarg_segment_ptr 1
  .amdhsa_system_sgpr_workgroup_id_x 1
.end_amdhsa_kernel
.text
.globl g1_kernel
.p2align 8
.type g1_kernel,@function
g1_kernel:
    s_cmp_ge_u32 s2, 256
    s_cbranch_scc1 g1_kernel_end
    s_load_dwordx2 s[32:33], s[0:1], 8
    s_load_dwordx4 s[36:39], s[0:1], 32
    s_load_dwordx2 s[34:35], s[0:1], 72
    s_load_dwordx2 s[66:67], s[0:1], 48
    s_load_dwordx2 s[68:69], s[0:1], 16
    s_load_dwordx2 s[76:77], s[0:1], 0
    v_lshrrev_b32 v221, 6, v0
    v_and_b32 v222, 63, v0
    v_readfirstlane_b32 s20, v221
    s_lshr_b32 s22, s2, 5
    s_and_b32 s21, s2, 7
    s_lshl_b32 s21, s21, 2
    s_lshr_b32 s3, s2, 3
    s_and_b32 s3, s3, 3
    s_add_u32 s21, s21, s3
    s_mul_i32 s40, s21, 10
    s_cmp_eq_u32 s21, 9
    s_cselect_b32 s41, 1, 0
    s_cmp_ge_u32 s21, 10
    s_cselect_b32 s42, 1, 0
    s_sub_u32 s45, s21, 10
    s_lshr_b32 s46, s45, 1
    s_mul_i32 s46, s46, 10
    s_and_b32 s45, s45, 1
    s_lshl_b32 s43, s45, 2
    s_add_u32 s43, s43, s46
    s_add_u32 s44, s46, 8
    s_add_u32 s44, s44, s45
    s_and_b32 s50, s20, 1
    s_lshr_b32 s51, s20, 1
    s_or_b32 s47, s41, s42
    s_cmp_lg_u32 s50, 0
    s_cselect_b32 s52, s47, s42
    s_cmp_lg_u32 s41, 0
    s_cselect_b32 s47, 2, 4
    s_mul_i32 s47, s47, s51
    s_lshl_b32 s48, s50, 1
    s_add_u32 s47, s47, s48
    s_add_u32 s47, s47, s40
    s_add_u32 s48, s48, s43
    s_cmp_lg_u32 s41, 0
    s_cselect_b32 s48, 110, s48
    s_cmp_lg_u32 s52, 0
    s_cselect_b32 s53, s48, s47
    s_mov_b32 s54, s42
    s_cmp_lg_u32 s41, 0
    s_cselect_b32 s47, 4, 8
    s_add_u32 s47, s47, s40
    s_add_u32 s47, s47, s51
    s_cmp_lg_u32 s42, 0
    s_cselect_b32 s55, s44, s47
    s_waitcnt lgkmcnt(0)
    s_cmp_lg_u32 s51, 0
    s_cselect_b32 s47, s38, s36
    s_cselect_b32 s48, s39, s37
    s_cmp_lg_u32 s52, 0
    s_cselect_b32 s47, s47, s32
    s_cselect_b32 s48, s48, s33
    s_cselect_b32 s56, 7, 6
    s_lshl_b32 s56, s56, 10
    s_lshl_b32 s49, s53, 6
    s_add_u32 s8, s47, s49
    s_addc_u32 s9, s48, 0
    s_and_b32 s9, s9, 0xffff
    s_lshl_b32 s10, s56, 10
    s_sub_u32 s10, s10, s49
    s_mov_b32 s11, 0x00020000
    s_cmp_lg_u32 s51, 0
    s_cselect_b32 s47, s38, s36
    s_cselect_b32 s48, s39, s37
    s_cmp_lg_u32 s54, 0
    s_cselect_b32 s47, s47, s32
    s_cselect_b32 s48, s48, s33
    s_cselect_b32 s57, 7, 6
    s_lshl_b32 s57, s57, 10
    s_lshl_b32 s49, s55, 6
    s_add_u32 s12, s47, s49
    s_addc_u32 s13, s48, 0
    s_and_b32 s13, s13, 0xffff
    s_lshl_b32 s14, s57, 10
    s_sub_u32 s14, s14, s49
    s_mov_b32 s15, 0x00020000
    s_mov_b32 s4, s34
    s_and_b32 s5, s35, 0xffff
    s_mov_b32 s6, 0x400000
    s_mov_b32 s7, 0x00020000
    s_mov_b32 s16, s34
    s_and_b32 s17, s35, 0xffff
    s_mov_b32 s18, 0x10000000
    s_mov_b32 s19, 0x00020000
    s_lshl_b32 s26, s56, 5
    s_lshl_b32 s27, s57, 5
    s_mov_b32 s23, 0
    s_mov_b32 s24, 0
    s_mov_b32 s25, 0
    s_lshl_b32 s29, s20, 12
    s_lshl_b32 s31, s20, 10
    s_lshl_b32 s3, s22, 4
    s_lshl_b32 s47, s20, 2
    s_add_u32 s3, s3, s47
    s_lshl_b32 s3, s3, 15
    v_lshlrev_b32 v223, 4, v222
    v_add_u32 v200, s3, v223
    v_add_u32 v201, 32768, v200
    v_add_u32 v202, 65536, v200
    v_add_u32 v203, 98304, v200
    v_lshrrev_b32 v224, 3, v222
    v_and_b32 v225, 7, v222
    v_lshrrev_b32 v226, 1, v225
    v_bfe_u32 v227, v224, 1, 1
    v_xor_b32 v226, v226, v227
    v_and_b32 v225, 1, v225
    v_mul_lo_u32 v228, v224, s56
    s_lshl_b32 s47, s56, 3
    v_xor_b32 v229, 0, v226
    v_lshl_or_b32 v229, v229, 1, v225
    v_lshl_add_u32 v204, v229, 4, v228
    v_add_u32 v228, s47, v228
    v_xor_b32 v229, 2, v226
    v_lshl_or_b32 v229, v229, 1, v225
    v_lshl_add_u32 v205, v229, 4, v228
    v_add_u32 v228, s47, v228
    v_xor_b32 v229, 0, v226
    v_lshl_or_b32 v229, v229, 1, v225
    v_lshl_add_u32 v206, v229, 4, v228
    v_add_u32 v228, s47, v228
    v_xor_b32 v229, 2, v226
    v_lshl_or_b32 v229, v229, 1, v225
    v_lshl_add_u32 v207, v229, 4, v228
    v_lshrrev_b32 v224, 2, v222
    s_lshl_b32 s47, s50, 4
    v_add_u32 v224, s47, v224
    v_mul_lo_u32 v228, v224, s57
    v_and_b32 v225, 3, v222
    v_lshrrev_b32 v226, 5, v222
    v_lshlrev_b32 v226, 1, v226
    v_xor_b32 v225, v225, v226
    v_lshl_add_u32 v208, v225, 4, v228
    s_add_u32 m0, s29, 16384
    s_nop 0
    buffer_load_dwordx4 v204, s[8:11], s24 offen lds
    s_add_u32 m0, s29, 17408
    s_nop 0
    buffer_load_dwordx4 v205, s[8:11], s24 offen lds
    s_add_u32 m0, s29, 18432
    s_nop 0
    buffer_load_dwordx4 v206, s[8:11], s24 offen lds
    s_add_u32 m0, s29, 19456
    s_nop 0
    buffer_load_dwordx4 v207, s[8:11], s24 offen lds
    s_add_u32 m0, s31, 32768
    s_nop 0
    buffer_load_dwordx4 v208, s[12:15], s25 offen lds
    s_add_u32 m0, s29, 0
    s_nop 0
    buffer_load_dwordx4 v200, s[4:7], s23 offen lds
    s_add_u32 m0, s29, 1024
    s_nop 0
    buffer_load_dwordx4 v201, s[4:7], s23 offen lds
    s_add_u32 m0, s29, 2048
    s_nop 0
    buffer_load_dwordx4 v202, s[4:7], s23 offen lds
    s_add_u32 m0, s29, 3072
    s_nop 0
    buffer_load_dwordx4 v203, s[4:7], s23 offen lds
    s_add_u32 s23, s23, 1024
    s_add_u32 s24, s24, s26
    s_add_u32 s25, s25, s27
    s_mov_b32 s72, s66
    s_and_b32 s73, s67, 0xffff
    s_mov_b32 s74, 0x700000
    s_mov_b32 s75, 0x00020000
    s_and_b32 s69, s69, 0xffff
    s_lshl_b32 s3, s2, 2
    s_add_u32 s3, s3, s20
    s_mul_i32 s3, s3, 1280
    v_lshlrev_b32 v232, 7, v222
    v_add_u32 v232, s3, v232
    v_mov_b32 v233, 0x40000000
    v_cmp_gt_u32 vcc, 10, v222
    s_nop 1
    v_cndmask_b32 v232, v233, v232, vcc
    s_lshl_b32 s47, s51, 13
    v_add_u32 v209, s47, v223
    v_add_u32 v210, 73728, v209
    v_lshrrev_b32 v224, 4, v222
    v_bfe_u32 v225, v222, 2, 2
    v_and_b32 v226, 3, v222
    v_lshl_add_u32 v227, v224, 3, v225
    v_lshrrev_b32 v228, 1, v225
    v_and_b32 v229, 1, v224
    v_lshl_or_b32 v228, v229, 1, v228
    v_lshlrev_b32 v230, 7, v227
    v_lshl_add_u32 v230, v226, 3, v230
    s_lshl_b32 s47, s50, 12
    v_add_u32 v230, s47, v230
    v_xor_b32 v231, 0, v228
    v_lshl_add_u32 v211, v231, 5, v230
    v_add_u32 v215, 73728, v211
    v_xor_b32 v231, 1, v228
    v_lshl_add_u32 v212, v231, 5, v230
    v_add_u32 v216, 73728, v212
    v_xor_b32 v231, 2, v228
    v_lshl_add_u32 v213, v231, 5, v230
    v_add_u32 v217, 73728, v213
    v_xor_b32 v231, 3, v228
    v_lshl_add_u32 v214, v231, 5, v230
    v_add_u32 v218, 73728, v214
    v_xor_b32 v229, s50, v229
    v_lshlrev_b32 v230, 6, v227
    v_lshl_add_u32 v230, v226, 3, v230
    v_lshl_add_u32 v230, v229, 5, v230
    v_add_u32 v219, 32768, v230
    v_add_u32 v220, 106496, v230
    s_or_b32 s47, s41, s42
    s_cmp_lg_u32 s50, 0
    s_cselect_b32 s60, s47, s42
    s_cmp_lg_u32 s41, 0
    s_cselect_b32 s47, 2, 4
    s_mul_i32 s47, s47, 0
    s_lshl_b32 s48, s50, 1
    s_add_u32 s47, s47, s48
    s_add_u32 s47, s47, s40
    s_add_u32 s48, s48, s43
    s_cmp_lg_u32 s41, 0
    s_cselect_b32 s48, 110, s48
    s_cmp_lg_u32 s60, 0
    s_cselect_b32 s61, s48, s47
    s_or_b32 s47, s41, s42
    s_cmp_lg_u32 s50, 0
    s_cselect_b32 s60, s47, s42
    s_cmp_lg_u32 s41, 0
    s_cselect_b32 s47, 2, 4
    s_mul_i32 s47, s47, 1
    s_lshl_b32 s48, s50, 1
    s_add_u32 s47, s47, s48
    s_add_u32 s47, s47, s40
    s_add_u32 s48, s48, s43
    s_cmp_lg_u32 s41, 0
    s_cselect_b32 s48, 110, s48
    s_cmp_lg_u32 s60, 0
    s_cselect_b32 s62, s48, s47
    s_mov_b32 s63, s42
    s_cmp_lg_u32 s41, 0
    s_cselect_b32 s47, 4, 8
    s_add_u32 s47, s47, s40
    s_add_u32 s47, s47, 0
    s_cmp_lg_u32 s42, 0
    s_cselect_b32 s64, s44, s47
    s_mov_b32 s63, s42
    s_cmp_lg_u32 s41, 0
    s_cselect_b32 s47, 4, 8
    s_add_u32 s47, s47, s40
    s_add_u32 s47, s47, 1
    s_cmp_lg_u32 s42, 0
    s_cselect_b32 s65, s44, s47
    s_mov_b32 s70, 0xbfb8aa3b
    s_mov_b32 s71, 0xbfb8aa3b
    s_mov_b32 s78, 1.0
    s_mov_b32 s79, 1.0
    s_lshl_b32 s58, s22, 4
    s_lshl_b32 s47, s51, 3
    s_add_u32 s58, s58, s47
    s_lshl_b32 s47, s50, 3
    v_add_u32 v224, s47, v223
    s_lshl_b32 s47, s51, 14
    v_add_u32 v225, s47, v224
    s_lshl_b32 s48, s50, 12
    s_add_u32 s47, s47, s48
    v_add_u32 v221, s47, v223
    s_add_u32 m0, s29, 53248
    s_nop 0
    buffer_load_dwordx4 v204, s[8:11], s24 offen lds
    v_mov_b32 v0, 0
    v_mov_b32 v1, 0
    v_mov_b32 v2, 0
    v_mov_b32 v3, 0
    v_mov_b32 v4, 0
    v_mov_b32 v5, 0
    v_mov_b32 v6, 0
    v_mov_b32 v7, 0
    v_mov_b32 v8, 0
    v_mov_b32 v9, 0
    v_mov_b32 v10, 0
    v_mov_b32 v11, 0
    v_mov_b32 v12, 0
    v_mov_b32 v13, 0
    v_mov_b32 v14, 0
    v_mov_b32 v15, 0
    v_mov_b32 v16, 0
    s_add_u32 m0, s29, 54272
    s_nop 0
    buffer_load_dwordx4 v205, s[8:11], s24 offen lds
    v_mov_b32 v17, 0
    v_mov_b32 v18, 0
    v_mov_b32 v19, 0
    v_mov_b32 v20, 0
    v_mov_b32 v21, 0
    v_mov_b32 v22, 0
    v_mov_b32 v23, 0
    v_mov_b32 v24, 0
    v_mov_b32 v25, 0
    v_mov_b32 v26, 0
    v_mov_b32 v27, 0
    v_mov_b32 v28, 0
    v_mov_b32 v29, 0
    v_mov_b32 v30, 0
    v_mov_b32 v31, 0
    v_mov_b32 v32, 0
    v_mov_b32 v33, 0
    s_add_u32 m0, s29, 55296
    s_nop 0
    buffer_load_dwordx4 v206, s[8:11], s24 offen lds
    v_mov_b32 v34, 0
    v_mov_b32 v35, 0
    v_mov_b32 v36, 0
    v_mov_b32 v37, 0
    v_mov_b32 v38, 0
    v_mov_b32 v39, 0
    v_mov_b32 v40, 0
    v_mov_b32 v41, 0
    v_mov_b32 v42, 0
    v_mov_b32 v43, 0
    v_mov_b32 v44, 0
    v_mov_b32 v45, 0
    v_mov_b32 v46, 0
    v_mov_b32 v47, 0
    v_mov_b32 v48, 0
    v_mov_b32 v49, 0
    v_mov_b32 v50, 0
    s_add_u32 m0, s29, 56320
    s_nop 0
    buffer_load_dwordx4 v207, s[8:11], s24 offen lds
    v_mov_b32 v51, 0
    v_mov_b32 v52, 0
    v_mov_b32 v53, 0
    v_mov_b32 v54, 0
    v_mov_b32 v55, 0
    v_mov_b32 v56, 0
    v_mov_b32 v57, 0
    v_mov_b32 v58, 0
    v_mov_b32 v59, 0
    v_mov_b32 v60, 0
    v_mov_b32 v61, 0
    v_mov_b32 v62, 0
    v_mov_b32 v63, 0
    v_mov_b32 v64, 0
    v_mov_b32 v65, 0
    v_mov_b32 v66, 0
    v_mov_b32 v67, 0
    s_add_u32 m0, s31, 69632
    s_nop 0
    buffer_load_dwordx4 v208, s[12:15], s25 offen lds
    v_mov_b32 v68, 0
    v_mov_b32 v69, 0
    v_mov_b32 v70, 0
    v_mov_b32 v71, 0
    v_mov_b32 v72, 0
    v_mov_b32 v73, 0
    v_mov_b32 v74, 0
    v_mov_b32 v75, 0
    v_mov_b32 v76, 0
    v_mov_b32 v77, 0
    v_mov_b32 v78, 0
    v_mov_b32 v79, 0
    v_mov_b32 v80, 0
    v_mov_b32 v81, 0
    v_mov_b32 v82, 0
    v_mov_b32 v83, 0
    v_mov_b32 v84, 0
    s_add_u32 m0, s29, 36864
    s_nop 0
    buffer_load_dwordx4 v200, s[4:7], s23 offen lds
    v_mov_b32 v85, 0
    v_mov_b32 v86, 0
    v_mov_b32 v87, 0
    v_mov_b32 v88, 0
    v_mov_b32 v89, 0
    v_mov_b32 v90, 0
    v_mov_b32 v91, 0
    v_mov_b32 v92, 0
    v_mov_b32 v93, 0
    v_mov_b32 v94, 0
    v_mov_b32 v95, 0
    v_mov_b32 v96, 0
    v_mov_b32 v97, 0
    v_mov_b32 v98, 0
    v_mov_b32 v99, 0
    v_mov_b32 v100, 0
    v_mov_b32 v101, 0
    s_add_u32 m0, s29, 37888
    s_nop 0
    buffer_load_dwordx4 v201, s[4:7], s23 offen lds
    v_mov_b32 v102, 0
    v_mov_b32 v103, 0
    v_mov_b32 v104, 0
    v_mov_b32 v105, 0
    v_mov_b32 v106, 0
    v_mov_b32 v107, 0
    v_mov_b32 v108, 0
    v_mov_b32 v109, 0
    v_mov_b32 v110, 0
    v_mov_b32 v111, 0
    v_mov_b32 v112, 0
    v_mov_b32 v113, 0
    v_mov_b32 v114, 0
    v_mov_b32 v115, 0
    v_mov_b32 v116, 0
    v_mov_b32 v117, 0
    v_mov_b32 v118, 0
    s_add_u32 m0, s29, 38912
    s_nop 0
    buffer_load_dwordx4 v202, s[4:7], s23 offen lds
    v_mov_b32 v119, 0
    v_mov_b32 v120, 0
    v_mov_b32 v121, 0
    v_mov_b32 v122, 0
    v_mov_b32 v123, 0
    v_mov_b32 v124, 0
    v_mov_b32 v125, 0
    v_mov_b32 v126, 0
    v_mov_b32 v127, 0
    v_mov_b32 v128, 0
    v_mov_b32 v129, 0
    v_mov_b32 v130, 0
    v_mov_b32 v131, 0
    v_mov_b32 v132, 0
    v_mov_b32 v133, 0
    v_mov_b32 v134, 0
    v_mov_b32 v135, 0
    s_add_u32 m0, s29, 39936
    s_nop 0
    buffer_load_dwordx4 v203, s[4:7], s23 offen lds
    s_add_u32 s23, s23, 1024
    s_add_u32 s24, s24, s26
    s_add_u32 s25, s25, s27
    v_mov_b32 v136, 0
    v_mov_b32 v137, 0
    v_mov_b32 v138, 0
    v_mov_b32 v139, 0
    v_mov_b32 v140, 0
    v_mov_b32 v141, 0
    v_mov_b32 v142, 0
    v_mov_b32 v143, 0
    v_mov_b32 v144, 0
    v_mov_b32 v145, 0
    v_mov_b32 v146, 0
    v_mov_b32 v147, 0
    v_mov_b32 v148, 0
    v_mov_b32 v149, 0
    v_mov_b32 v150, 0
    v_mov_b32 v151, 0
    v_mov_b32 v152, 0
    s_add_u32 m0, s29, 90112
    s_nop 0
    buffer_load_dwordx4 v204, s[8:11], s24 offen lds
    v_mov_b32 v153, 0
    v_mov_b32 v154, 0
    v_mov_b32 v155, 0
    v_mov_b32 v156, 0
    v_mov_b32 v157, 0
    v_mov_b32 v158, 0
    v_mov_b32 v159, 0
    v_mov_b32 v160, 0
    v_mov_b32 v161, 0
    v_mov_b32 v162, 0
    v_mov_b32 v163, 0
    v_mov_b32 v164, 0
    v_mov_b32 v165, 0
    v_mov_b32 v166, 0
    v_mov_b32 v167, 0
    v_mov_b32 v168, 0
    v_mov_b32 v169, 0
    s_add_u32 m0, s29, 91136
    s_nop 0
    buffer_load_dwordx4 v205, s[8:11], s24 offen lds
    v_mov_b32 v170, 0
    v_mov_b32 v171, 0
    v_mov_b32 v172, 0
    v_mov_b32 v173, 0
    v_mov_b32 v174, 0
    v_mov_b32 v175, 0
    v_mov_b32 v176, 0
    v_mov_b32 v177, 0
    v_mov_b32 v178, 0
    v_mov_b32 v179, 0
    v_mov_b32 v180, 0
    v_mov_b32 v181, 0
    v_mov_b32 v182, 0
    v_mov_b32 v183, 0
    v_mov_b32 v184, 0
    v_mov_b32 v185, 0
    v_mov_b32 v186, 0
    s_add_u32 m0, s29, 92160
    s_nop 0
    buffer_load_dwordx4 v206, s[8:11], s24 offen lds
    v_mov_b32 v187, 0
    v_mov_b32 v188, 0
    v_mov_b32 v189, 0
    v_mov_b32 v190, 0
    v_mov_b32 v191, 0
    v_mov_b32 v192, 0
    v_mov_b32 v193, 0
    v_mov_b32 v194, 0
    v_mov_b32 v195, 0
    v_mov_b32 v196, 0
    v_mov_b32 v197, 0
    v_mov_b32 v198, 0
    v_mov_b32 v199, 0
    v_accvgpr_write_b32 a0, 0
    v_accvgpr_write_b32 a1, 0
    v_accvgpr_write_b32 a2, 0
    v_accvgpr_write_b32 a3, 0
    s_add_u32 m0, s29, 93184
    s_nop 0
    buffer_load_dwordx4 v207, s[8:11], s24 offen lds
    v_accvgpr_write_b32 a4, 0
    v_accvgpr_write_b32 a5, 0
    v_accvgpr_write_b32 a6, 0
    v_accvgpr_write_b32 a7, 0
    v_accvgpr_write_b32 a8, 0
    v_accvgpr_write_b32 a9, 0
    v_accvgpr_write_b32 a10, 0
    v_accvgpr_write_b32 a11, 0
    v_accvgpr_write_b32 a12, 0
    v_accvgpr_write_b32 a13, 0
    v_accvgpr_write_b32 a14, 0
    v_accvgpr_write_b32 a15, 0
    v_accvgpr_write_b32 a16, 0
    v_accvgpr_write_b32 a17, 0
    v_accvgpr_write_b32 a18, 0
    v_accvgpr_write_b32 a19, 0
    v_accvgpr_write_b32 a20, 0
    s_add_u32 m0, s31, 106496
    s_nop 0
    buffer_load_dwordx4 v208, s[12:15], s25 offen lds
    v_accvgpr_write_b32 a21, 0
    v_accvgpr_write_b32 a22, 0
    v_accvgpr_write_b32 a23, 0
    v_accvgpr_write_b32 a24, 0
    v_accvgpr_write_b32 a25, 0
    v_accvgpr_write_b32 a26, 0
    v_accvgpr_write_b32 a27, 0
    v_accvgpr_write_b32 a28, 0
    v_accvgpr_write_b32 a29, 0
    v_accvgpr_write_b32 a30, 0
    v_accvgpr_write_b32 a31, 0
    v_accvgpr_write_b32 a32, 0
    v_accvgpr_write_b32 a33, 0
    v_accvgpr_write_b32 a34, 0
    v_accvgpr_write_b32 a35, 0
    v_accvgpr_write_b32 a36, 0
    v_accvgpr_write_b32 a37, 0
    s_add_u32 m0, s29, 73728
    s_nop 0
    buffer_load_dwordx4 v200, s[4:7], s23 offen lds
    v_accvgpr_write_b32 a38, 0
    v_accvgpr_write_b32 a39, 0
    v_accvgpr_write_b32 a40, 0
    v_accvgpr_write_b32 a41, 0
    v_accvgpr_write_b32 a42, 0
    v_accvgpr_write_b32 a43, 0
    v_accvgpr_write_b32 a44, 0
    v_accvgpr_write_b32 a45, 0
    v_accvgpr_write_b32 a46, 0
    v_accvgpr_write_b32 a47, 0
    v_accvgpr_write_b32 a48, 0
    v_accvgpr_write_b32 a49, 0
    v_accvgpr_write_b32 a50, 0
    v_accvgpr_write_b32 a51, 0
    v_accvgpr_write_b32 a52, 0
    v_accvgpr_write_b32 a53, 0
    v_accvgpr_write_b32 a54, 0
    s_add_u32 m0, s29, 74752
    s_nop 0
    buffer_load_dwordx4 v201, s[4:7], s23 offen lds
    v_accvgpr_write_b32 a55, 0
    v_accvgpr_write_b32 a56, 0
    v_accvgpr_write_b32 a57, 0
    v_accvgpr_write_b32 a58, 0
    v_accvgpr_write_b32 a59, 0
    v_accvgpr_write_b32 a60, 0
    v_accvgpr_write_b32 a61, 0
    v_accvgpr_write_b32 a62, 0
    v_accvgpr_write_b32 a63, 0
    v_accvgpr_write_b32 a64, 0
    v_accvgpr_write_b32 a65, 0
    v_accvgpr_write_b32 a66, 0
    v_accvgpr_write_b32 a67, 0
    v_accvgpr_write_b32 a68, 0
    v_accvgpr_write_b32 a69, 0
    v_accvgpr_write_b32 a70, 0
    v_accvgpr_write_b32 a71, 0
    s_add_u32 m0, s29, 75776
    s_nop 0
    buffer_load_dwordx4 v202, s[4:7], s23 offen lds
    v_accvgpr_write_b32 a72, 0
    v_accvgpr_write_b32 a73, 0
    v_accvgpr_write_b32 a74, 0
    v_accvgpr_write_b32 a75, 0
    v_accvgpr_write_b32 a76, 0
    v_accvgpr_write_b32 a77, 0
    v_accvgpr_write_b32 a78, 0
    v_accvgpr_write_b32 a79, 0
    v_accvgpr_write_b32 a80, 0
    v_accvgpr_write_b32 a81, 0
    v_accvgpr_write_b32 a82, 0
    v_accvgpr_write_b32 a83, 0
    v_accvgpr_write_b32 a84, 0
    v_accvgpr_write_b32 a85, 0
    v_accvgpr_write_b32 a86, 0
    v_accvgpr_write_b32 a87, 0
    v_accvgpr_write_b32 a88, 0
    s_add_u32 m0, s29, 76800
    s_nop 0
    buffer_load_dwordx4 v203, s[4:7], s23 offen lds
    s_add_u32 s23, s23, 1024
    s_add_u32 s24, s24, s26
    s_add_u32 s25, s25, s27
    v_accvgpr_write_b32 a89, 0
    v_accvgpr_write_b32 a90, 0
    v_accvgpr_write_b32 a91, 0
    v_accvgpr_write_b32 a92, 0
    v_accvgpr_write_b32 a93, 0
    v_accvgpr_write_b32 a94, 0
    v_accvgpr_write_b32 a95, 0
    v_accvgpr_write_b32 a96, 0
    v_accvgpr_write_b32 a97, 0
    v_accvgpr_write_b32 a98, 0
    v_accvgpr_write_b32 a99, 0
    v_accvgpr_write_b32 a100, 0
    v_accvgpr_write_b32 a101, 0
    v_accvgpr_write_b32 a102, 0
    v_accvgpr_write_b32 a103, 0
    v_accvgpr_write_b32 a104, 0
    v_accvgpr_write_b32 a105, 0
    v_accvgpr_write_b32 a106, 0
    v_accvgpr_write_b32 a107, 0
    v_accvgpr_write_b32 a108, 0
    v_accvgpr_write_b32 a109, 0
    v_accvgpr_write_b32 a110, 0
    v_accvgpr_write_b32 a111, 0
    v_accvgpr_write_b32 a112, 0
    v_accvgpr_write_b32 a113, 0
    v_accvgpr_write_b32 a114, 0
    v_accvgpr_write_b32 a115, 0
    v_accvgpr_write_b32 a116, 0
    v_accvgpr_write_b32 a117, 0
    v_accvgpr_write_b32 a118, 0
    v_accvgpr_write_b32 a119, 0
    buffer_load_dword v233, v232, s[72:75], 0 offen
    s_waitcnt vmcnt(19)
    s_barrier
    ds_read_b64_tr_b16 a[184:185], v211 offset:16384
    ds_read_b64_tr_b16 a[186:187], v211 offset:16896
    ds_read_b64_tr_b16 a[188:189], v211 offset:24576
    ds_read_b64_tr_b16 a[190:191], v211 offset:25088
    ds_read_b64_tr_b16 a[192:193], v212 offset:16384
    ds_read_b64_tr_b16 a[194:195], v212 offset:16896
    ds_read_b128 a[120:123], v209 offset:0
    ds_read_b128 a[124:127], v209 offset:1024
    ds_read_b128 a[128:131], v209 offset:2048
    ds_read_b128 a[132:135], v209 offset:3072
    ds_read_b128 a[136:139], v209 offset:4096
    ds_read_b128 a[140:143], v209 offset:5120
    ds_read_b128 a[144:147], v209 offset:6144
    ds_read_b128 a[148:151], v209 offset:7168
    s_mov_b32 s28, 7
g1_kernel_loop:
    s_waitcnt vmcnt(10)
    s_barrier
    s_waitcnt lgkmcnt(6)
    v_mfma_f32_16x16x32_bf16 v[0:3], a[184:187], a[120:123], v[0:3]
    ds_read_b64_tr_b16 a[196:197], v212 offset:24576
    ds_read_b64_tr_b16 a[198:199], v212 offset:25088
    s_waitcnt lgkmcnt(8)
    v_mfma_f32_16x16x32_bf16 v[40:43], a[184:187], a[124:127], v[40:43]
    s_waitcnt lgkmcnt(7)
    v_mfma_f32_16x16x32_bf16 v[80:83], a[184:187], a[128:131], v[80:83]
    s_add_u32 m0, s29, 126976
    s_nop 0
    buffer_load_dwordx4 v204, s[8:11], s24 offen lds
    s_waitcnt lgkmcnt(6)
    v_mfma_f32_16x16x32_bf16 v[120:123], a[184:187], a[132:135], v[120:123]
    s_waitcnt lgkmcnt(5)
    v_mfma_f32_16x16x32_bf16 v[160:163], a[184:187], a[136:139], v[160:163]
    s_waitcnt lgkmcnt(4)
    v_mfma_f32_16x16x32_bf16 a[0:3], a[184:187], a[140:143], a[0:3]
    s_waitcnt lgkmcnt(3)
    v_mfma_f32_16x16x32_bf16 a[40:43], a[184:187], a[144:147], a[40:43]
    s_add_u32 m0, s29, 128000
    s_nop 0
    buffer_load_dwordx4 v205, s[8:11], s24 offen lds
    s_waitcnt lgkmcnt(2)
    v_mfma_f32_16x16x32_bf16 a[80:83], a[184:187], a[148:151], a[80:83]
    v_mfma_f32_16x16x32_bf16 v[4:7], a[188:191], a[120:123], v[4:7]
    ds_read_b64_tr_b16 a[200:201], v213 offset:16384
    ds_read_b64_tr_b16 a[202:203], v213 offset:16896
    v_mfma_f32_16x16x32_bf16 v[44:47], a[188:191], a[124:127], v[44:47]
    v_mfma_f32_16x16x32_bf16 v[84:87], a[188:191], a[128:131], v[84:87]
    s_add_u32 m0, s29, 129024
    s_nop 0
    buffer_load_dwordx4 v206, s[8:11], s24 offen lds
    v_mfma_f32_16x16x32_bf16 v[124:127], a[188:191], a[132:135], v[124:127]
    v_mfma_f32_16x16x32_bf16 v[164:167], a[188:191], a[136:139], v[164:167]
    ds_read_b128 a[152:155], v209 offset:36864
    v_mfma_f32_16x16x32_bf16 a[4:7], a[188:191], a[140:143], a[4:7]
    v_mfma_f32_16x16x32_bf16 a[44:47], a[188:191], a[144:147], a[44:47]
    s_add_u32 m0, s29, 130048
    s_nop 0
    buffer_load_dwordx4 v207, s[8:11], s24 offen lds
    v_mfma_f32_16x16x32_bf16 a[84:87], a[188:191], a[148:151], a[84:87]
    v_mfma_f32_16x16x32_bf16 v[8:11], a[192:195], a[120:123], v[8:11]
    ds_read_b64_tr_b16 a[184:185], v213 offset:24576
    ds_read_b64_tr_b16 a[186:187], v213 offset:25088
    v_mfma_f32_16x16x32_bf16 v[48:51], a[192:195], a[124:127], v[48:51]
    v_mfma_f32_16x16x32_bf16 v[88:91], a[192:195], a[128:131], v[88:91]
    s_add_u32 m0, s31, 143360
    s_nop 0
    buffer_load_dwordx4 v208, s[12:15], s25 offen lds
    v_mfma_f32_16x16x32_bf16 v[128:131], a[192:195], a[132:135], v[128:131]
    v_mfma_f32_16x16x32_bf16 v[168:171], a[192:195], a[136:139], v[168:171]
    ds_read_b128 a[156:159], v209 offset:37888
    v_mfma_f32_16x16x32_bf16 a[8:11], a[192:195], a[140:143], a[8:11]
    v_mfma_f32_16x16x32_bf16 a[48:51], a[192:195], a[144:147], a[48:51]
    s_add_u32 m0, s29, 110592
    s_nop 0
    buffer_load_dwordx4 v200, s[4:7], s23 offen lds
    v_mfma_f32_16x16x32_bf16 a[88:91], a[192:195], a[148:151], a[88:91]
    s_waitcnt lgkmcnt(6)
    v_mfma_f32_16x16x32_bf16 v[12:15], a[196:199], a[120:123], v[12:15]
    ds_read_b64_tr_b16 a[188:189], v214 offset:16384
    ds_read_b64_tr_b16 a[190:191], v214 offset:16896
    v_mfma_f32_16x16x32_bf16 v[52:55], a[196:199], a[124:127], v[52:55]
    v_mfma_f32_16x16x32_bf16 v[92:95], a[196:199], a[128:131], v[92:95]
    s_add_u32 m0, s29, 111616
    s_nop 0
    buffer_load_dwordx4 v201, s[4:7], s23 offen lds
    v_mfma_f32_16x16x32_bf16 v[132:135], a[196:199], a[132:135], v[132:135]
    v_mfma_f32_16x16x32_bf16 v[172:175], a[196:199], a[136:139], v[172:175]
    ds_read_b128 a[160:163], v209 offset:38912
    v_mfma_f32_16x16x32_bf16 a[12:15], a[196:199], a[140:143], a[12:15]
    v_mfma_f32_16x16x32_bf16 a[52:55], a[196:199], a[144:147], a[52:55]
    s_add_u32 m0, s29, 112640
    s_nop 0
    buffer_load_dwordx4 v202, s[4:7], s23 offen lds
    v_mfma_f32_16x16x32_bf16 a[92:95], a[196:199], a[148:151], a[92:95]
    s_waitcnt lgkmcnt(7)
    v_mfma_f32_16x16x32_bf16 v[16:19], a[200:203], a[120:123], v[16:19]
    ds_read_b64_tr_b16 a[192:193], v214 offset:24576
    ds_read_b64_tr_b16 a[194:195], v214 offset:25088
    v_mfma_f32_16x16x32_bf16 v[56:59], a[200:203], a[124:127], v[56:59]
    v_mfma_f32_16x16x32_bf16 v[96:99], a[200:203], a[128:131], v[96:99]
    s_add_u32 m0, s29, 113664
    s_nop 0
    buffer_load_dwordx4 v203, s[4:7], s23 offen lds
    v_mfma_f32_16x16x32_bf16 v[136:139], a[200:203], a[132:135], v[136:139]
    v_mfma_f32_16x16x32_bf16 v[176:179], a[200:203], a[136:139], v[176:179]
    ds_read_b128 a[164:167], v209 offset:39936
    v_mfma_f32_16x16x32_bf16 a[16:19], a[200:203], a[140:143], a[16:19]
    v_mfma_f32_16x16x32_bf16 a[56:59], a[200:203], a[144:147], a[56:59]
    v_mfma_f32_16x16x32_bf16 a[96:99], a[200:203], a[148:151], a[96:99]
    s_waitcnt lgkmcnt(7)
    v_mfma_f32_16x16x32_bf16 v[20:23], a[184:187], a[120:123], v[20:23]
    ds_read_b64_tr_b16 a[196:197], v219 offset:0
    ds_read_b64_tr_b16 a[198:199], v219 offset:256
    v_mfma_f32_16x16x32_bf16 v[60:63], a[184:187], a[124:127], v[60:63]
    v_mfma_f32_16x16x32_bf16 v[100:103], a[184:187], a[128:131], v[100:103]
    v_mfma_f32_16x16x32_bf16 v[140:143], a[184:187], a[132:135], v[140:143]
    v_mfma_f32_16x16x32_bf16 v[180:183], a[184:187], a[136:139], v[180:183]
    ds_read_b128 a[168:171], v209 offset:40960
    v_mfma_f32_16x16x32_bf16 a[20:23], a[184:187], a[140:143], a[20:23]
    v_mfma_f32_16x16x32_bf16 a[60:63], a[184:187], a[144:147], a[60:63]
    v_mfma_f32_16x16x32_bf16 a[100:103], a[184:187], a[148:151], a[100:103]
    s_waitcnt lgkmcnt(7)
    v_mfma_f32_16x16x32_bf16 v[24:27], a[188:191], a[120:123], v[24:27]
    ds_read_b64_tr_b16 a[200:201], v219 offset:2048
    ds_read_b64_tr_b16 a[202:203], v219 offset:2304
    v_mfma_f32_16x16x32_bf16 v[64:67], a[188:191], a[124:127], v[64:67]
    v_mfma_f32_16x16x32_bf16 v[104:107], a[188:191], a[128:131], v[104:107]
    v_mfma_f32_16x16x32_bf16 v[144:147], a[188:191], a[132:135], v[144:147]
    v_mfma_f32_16x16x32_bf16 v[184:187], a[188:191], a[136:139], v[184:187]
    ds_read_b128 a[172:175], v209 offset:41984
    v_mfma_f32_16x16x32_bf16 a[24:27], a[188:191], a[140:143], a[24:27]
    v_mfma_f32_16x16x32_bf16 a[64:67], a[188:191], a[144:147], a[64:67]
    v_mfma_f32_16x16x32_bf16 a[104:107], a[188:191], a[148:151], a[104:107]
    s_waitcnt lgkmcnt(7)
    v_mfma_f32_16x16x32_bf16 v[28:31], a[192:195], a[120:123], v[28:31]
    ds_read_b64_tr_b16 a[184:185], v211 offset:53248
    ds_read_b64_tr_b16 a[186:187], v211 offset:53760
    v_mfma_f32_16x16x32_bf16 v[68:71], a[192:195], a[124:127], v[68:71]
    v_mfma_f32_16x16x32_bf16 v[108:111], a[192:195], a[128:131], v[108:111]
    v_mfma_f32_16x16x32_bf16 v[148:151], a[192:195], a[132:135], v[148:151]
    v_mfma_f32_16x16x32_bf16 v[188:191], a[192:195], a[136:139], v[188:191]
    ds_read_b128 a[176:179], v209 offset:43008
    v_mfma_f32_16x16x32_bf16 a[28:31], a[192:195], a[140:143], a[28:31]
    v_mfma_f32_16x16x32_bf16 a[68:71], a[192:195], a[144:147], a[68:71]
    v_mfma_f32_16x16x32_bf16 a[108:111], a[192:195], a[148:151], a[108:111]
    s_waitcnt lgkmcnt(7)
    v_mfma_f32_16x16x32_bf16 v[32:35], a[196:199], a[120:123], v[32:35]
    ds_read_b64_tr_b16 a[188:189], v211 offset:61440
    ds_read_b64_tr_b16 a[190:191], v211 offset:61952
    v_mfma_f32_16x16x32_bf16 v[72:75], a[196:199], a[124:127], v[72:75]
    v_mfma_f32_16x16x32_bf16 v[112:115], a[196:199], a[128:131], v[112:115]
    v_mfma_f32_16x16x32_bf16 v[152:155], a[196:199], a[132:135], v[152:155]
    v_mfma_f32_16x16x32_bf16 v[192:195], a[196:199], a[136:139], v[192:195]
    ds_read_b128 a[180:183], v209 offset:44032
    v_mfma_f32_16x16x32_bf16 a[32:35], a[196:199], a[140:143], a[32:35]
    v_mfma_f32_16x16x32_bf16 a[72:75], a[196:199], a[144:147], a[72:75]
    v_mfma_f32_16x16x32_bf16 a[112:115], a[196:199], a[148:151], a[112:115]
    s_waitcnt lgkmcnt(7)
    v_mfma_f32_16x16x32_bf16 v[36:39], a[200:203], a[120:123], v[36:39]
    ds_read_b64_tr_b16 a[192:193], v212 offset:53248
    ds_read_b64_tr_b16 a[194:195], v212 offset:53760
    v_mfma_f32_16x16x32_bf16 v[76:79], a[200:203], a[124:127], v[76:79]
    v_mfma_f32_16x16x32_bf16 v[116:119], a[200:203], a[128:131], v[116:119]
    v_mfma_f32_16x16x32_bf16 v[156:159], a[200:203], a[132:135], v[156:159]
    v_mfma_f32_16x16x32_bf16 v[196:199], a[200:203], a[136:139], v[196:199]
    v_mfma_f32_16x16x32_bf16 a[36:39], a[200:203], a[140:143], a[36:39]
    v_mfma_f32_16x16x32_bf16 a[76:79], a[200:203], a[144:147], a[76:79]
    v_mfma_f32_16x16x32_bf16 a[116:119], a[200:203], a[148:151], a[116:119]
    s_add_u32 s23, s23, 1024
    s_add_u32 s24, s24, s26
    s_add_u32 s25, s25, s27
    s_waitcnt vmcnt(10)
    s_barrier
    s_waitcnt lgkmcnt(6)
    v_mfma_f32_16x16x32_bf16 v[0:3], a[184:187], a[152:155], v[0:3]
    ds_read_b64_tr_b16 a[196:197], v212 offset:61440
    ds_read_b64_tr_b16 a[198:199], v212 offset:61952
    v_mfma_f32_16x16x32_bf16 v[40:43], a[184:187], a[156:159], v[40:43]
    v_mfma_f32_16x16x32_bf16 v[80:83], a[184:187], a[160:163], v[80:83]
    s_add_u32 m0, s29, 16384
    s_nop 0
    buffer_load_dwordx4 v204, s[8:11], s24 offen lds
    v_mfma_f32_16x16x32_bf16 v[120:123], a[184:187], a[164:167], v[120:123]
    v_mfma_f32_16x16x32_bf16 v[160:163], a[184:187], a[168:171], v[160:163]
    v_mfma_f32_16x16x32_bf16 a[0:3], a[184:187], a[172:175], a[0:3]
    s_waitcnt lgkmcnt(7)
    v_mfma_f32_16x16x32_bf16 a[40:43], a[184:187], a[176:179], a[40:43]
    s_add_u32 m0, s29, 17408
    s_nop 0
    buffer_load_dwordx4 v205, s[8:11], s24 offen lds
    s_waitcnt lgkmcnt(4)
    v_mfma_f32_16x16x32_bf16 a[80:83], a[184:187], a[180:183], a[80:83]
    v_mfma_f32_16x16x32_bf16 v[4:7], a[188:191], a[152:155], v[4:7]
    ds_read_b64_tr_b16 a[200:201], v213 offset:53248
    ds_read_b64_tr_b16 a[202:203], v213 offset:53760
    v_mfma_f32_16x16x32_bf16 v[44:47], a[188:191], a[156:159], v[44:47]
    v_mfma_f32_16x16x32_bf16 v[84:87], a[188:191], a[160:163], v[84:87]
    s_add_u32 m0, s29, 18432
    s_nop 0
    buffer_load_dwordx4 v206, s[8:11], s24 offen lds
    v_mfma_f32_16x16x32_bf16 v[124:127], a[188:191], a[164:167], v[124:127]
    v_mfma_f32_16x16x32_bf16 v[164:167], a[188:191], a[168:171], v[164:167]
    ds_read_b128 a[120:123], v210 offset:0
    v_mfma_f32_16x16x32_bf16 a[4:7], a[188:191], a[172:175], a[4:7]
    v_mfma_f32_16x16x32_bf16 a[44:47], a[188:191], a[176:179], a[44:47]
    s_add_u32 m0, s29, 19456
    s_nop 0
    buffer_load_dwordx4 v207, s[8:11], s24 offen lds
    v_mfma_f32_16x16x32_bf16 a[84:87], a[188:191], a[180:183], a[84:87]
    s_waitcnt lgkmcnt(5)
    v_mfma_f32_16x16x32_bf16 v[8:11], a[192:195], a[152:155], v[8:11]
    ds_read_b64_tr_b16 a[184:185], v213 offset:61440
    ds_read_b64_tr_b16 a[186:187], v213 offset:61952
    v_mfma_f32_16x16x32_bf16 v[48:51], a[192:195], a[156:159], v[48:51]
    v_mfma_f32_16x16x32_bf16 v[88:91], a[192:195], a[160:163], v[88:91]
    s_add_u32 m0, s31, 32768
    s_nop 0
    buffer_load_dwordx4 v208, s[12:15], s25 offen lds
    v_mfma_f32_16x16x32_bf16 v[128:131], a[192:195], a[164:167], v[128:131]
    v_mfma_f32_16x16x32_bf16 v[168:171], a[192:195], a[168:171], v[168:171]
    ds_read_b128 a[124:127], v210 offset:1024
    v_mfma_f32_16x16x32_bf16 a[8:11], a[192:195], a[172:175], a[8:11]
    v_mfma_f32_16x16x32_bf16 a[48:51], a[192:195], a[176:179], a[48:51]
    s_add_u32 m0, s29, 0
    s_nop 0
    buffer_load_dwordx4 v200, s[4:7], s23 offen lds
    v_mfma_f32_16x16x32_bf16 a[88:91], a[192:195], a[180:183], a[88:91]
    s_waitcnt lgkmcnt(6)
    v_mfma_f32_16x16x32_bf16 v[12:15], a[196:199], a[152:155], v[12:15]
    ds_read_b64_tr_b16 a[188:189], v214 offset:53248
    ds_read_b64_tr_b16 a[190:191], v214 offset:53760
    v_mfma_f32_16x16x32_bf16 v[52:55], a[196:199], a[156:159], v[52:55]
    v_mfma_f32_16x16x32_bf16 v[92:95], a[196:199], a[160:163], v[92:95]
    s_add_u32 m0, s29, 1024
    s_nop 0
    buffer_load_dwordx4 v201, s[4:7], s23 offen lds
    v_mfma_f32_16x16x32_bf16 v[132:135], a[196:199], a[164:167], v[132:135]
    v_mfma_f32_16x16x32_bf16 v[172:175], a[196:199], a[168:171], v[172:175]
    ds_read_b128 a[128:131], v210 offset:2048
    v_mfma_f32_16x16x32_bf16 a[12:15], a[196:199], a[172:175], a[12:15]
    v_mfma_f32_16x16x32_bf16 a[52:55], a[196:199], a[176:179], a[52:55]
    s_add_u32 m0, s29, 2048
    s_nop 0
    buffer_load_dwordx4 v202, s[4:7], s23 offen lds
    v_mfma_f32_16x16x32_bf16 a[92:95], a[196:199], a[180:183], a[92:95]
    s_waitcnt lgkmcnt(7)
    v_mfma_f32_16x16x32_bf16 v[16:19], a[200:203], a[152:155], v[16:19]
    ds_read_b64_tr_b16 a[192:193], v214 offset:61440
    ds_read_b64_tr_b16 a[194:195], v214 offset:61952
    v_mfma_f32_16x16x32_bf16 v[56:59], a[200:203], a[156:159], v[56:59]
    v_mfma_f32_16x16x32_bf16 v[96:99], a[200:203], a[160:163], v[96:99]
    s_add_u32 m0, s29, 3072
    s_nop 0
    buffer_load_dwordx4 v203, s[4:7], s23 offen lds
    v_mfma_f32_16x16x32_bf16 v[136:139], a[200:203], a[164:167], v[136:139]
    v_mfma_f32_16x16x32_bf16 v[176:179], a[200:203], a[168:171], v[176:179]
    ds_read_b128 a[132:135], v210 offset:3072
    v_mfma_f32_16x16x32_bf16 a[16:19], a[200:203], a[172:175], a[16:19]
    v_mfma_f32_16x16x32_bf16 a[56:59], a[200:203], a[176:179], a[56:59]
    v_mfma_f32_16x16x32_bf16 a[96:99], a[200:203], a[180:183], a[96:99]
    s_waitcnt lgkmcnt(7)
    v_mfma_f32_16x16x32_bf16 v[20:23], a[184:187], a[152:155], v[20:23]
    ds_read_b64_tr_b16 a[196:197], v219 offset:36864
    ds_read_b64_tr_b16 a[198:199], v219 offset:37120
    v_mfma_f32_16x16x32_bf16 v[60:63], a[184:187], a[156:159], v[60:63]
    v_mfma_f32_16x16x32_bf16 v[100:103], a[184:187], a[160:163], v[100:103]
    v_mfma_f32_16x16x32_bf16 v[140:143], a[184:187], a[164:167], v[140:143]
    v_mfma_f32_16x16x32_bf16 v[180:183], a[184:187], a[168:171], v[180:183]
    ds_read_b128 a[136:139], v210 offset:4096
    v_mfma_f32_16x16x32_bf16 a[20:23], a[184:187], a[172:175], a[20:23]
    v_mfma_f32_16x16x32_bf16 a[60:63], a[184:187], a[176:179], a[60:63]
    v_mfma_f32_16x16x32_bf16 a[100:103], a[184:187], a[180:183], a[100:103]
    s_waitcnt lgkmcnt(7)
    v_mfma_f32_16x16x32_bf16 v[24:27], a[188:191], a[152:155], v[24:27]
    ds_read_b64_tr_b16 a[200:201], v219 offset:38912
    ds_read_b64_tr_b16 a[202:203], v219 offset:39168
    v_mfma_f32_16x16x32_bf16 v[64:67], a[188:191], a[156:159], v[64:67]
    v_mfma_f32_16x16x32_bf16 v[104:107], a[188:191], a[160:163], v[104:107]
    v_mfma_f32_16x16x32_bf16 v[144:147], a[188:191], a[164:167], v[144:147]
    v_mfma_f32_16x16x32_bf16 v[184:187], a[188:191], a[168:171], v[184:187]
    ds_read_b128 a[140:143], v210 offset:5120
    v_mfma_f32_16x16x32_bf16 a[24:27], a[188:191], a[172:175], a[24:27]
    v_mfma_f32_16x16x32_bf16 a[64:67], a[188:191], a[176:179], a[64:67]
    v_mfma_f32_16x16x32_bf16 a[104:107], a[188:191], a[180:183], a[104:107]
    s_waitcnt lgkmcnt(7)
    v_mfma_f32_16x16x32_bf16 v[28:31], a[192:195], a[152:155], v[28:31]
    ds_read_b64_tr_b16 a[184:185], v215 offset:16384
    ds_read_b64_tr_b16 a[186:187], v215 offset:16896
    v_mfma_f32_16x16x32_bf16 v[68:71], a[192:195], a[156:159], v[68:71]
    v_mfma_f32_16x16x32_bf16 v[108:111], a[192:195], a[160:163], v[108:111]
    v_mfma_f32_16x16x32_bf16 v[148:151], a[192:195], a[164:167], v[148:151]
    v_mfma_f32_16x16x32_bf16 v[188:191], a[192:195], a[168:171], v[188:191]
    ds_read_b128 a[144:147], v210 offset:6144
    v_mfma_f32_16x16x32_bf16 a[28:31], a[192:195], a[172:175], a[28:31]
    v_mfma_f32_16x16x32_bf16 a[68:71], a[192:195], a[176:179], a[68:71]
    v_mfma_f32_16x16x32_bf16 a[108:111], a[192:195], a[180:183], a[108:111]
    s_waitcnt lgkmcnt(7)
    v_mfma_f32_16x16x32_bf16 v[32:35], a[196:199], a[152:155], v[32:35]
    ds_read_b64_tr_b16 a[188:189], v215 offset:24576
    ds_read_b64_tr_b16 a[190:191], v215 offset:25088
    v_mfma_f32_16x16x32_bf16 v[72:75], a[196:199], a[156:159], v[72:75]
    v_mfma_f32_16x16x32_bf16 v[112:115], a[196:199], a[160:163], v[112:115]
    v_mfma_f32_16x16x32_bf16 v[152:155], a[196:199], a[164:167], v[152:155]
    v_mfma_f32_16x16x32_bf16 v[192:195], a[196:199], a[168:171], v[192:195]
    ds_read_b128 a[148:151], v210 offset:7168
    v_mfma_f32_16x16x32_bf16 a[32:35], a[196:199], a[172:175], a[32:35]
    v_mfma_f32_16x16x32_bf16 a[72:75], a[196:199], a[176:179], a[72:75]
    v_mfma_f32_16x16x32_bf16 a[112:115], a[196:199], a[180:183], a[112:115]
    s_waitcnt lgkmcnt(7)
    v_mfma_f32_16x16x32_bf16 v[36:39], a[200:203], a[152:155], v[36:39]
    ds_read_b64_tr_b16 a[192:193], v216 offset:16384
    ds_read_b64_tr_b16 a[194:195], v216 offset:16896
    v_mfma_f32_16x16x32_bf16 v[76:79], a[200:203], a[156:159], v[76:79]
    v_mfma_f32_16x16x32_bf16 v[116:119], a[200:203], a[160:163], v[116:119]
    v_mfma_f32_16x16x32_bf16 v[156:159], a[200:203], a[164:167], v[156:159]
    v_mfma_f32_16x16x32_bf16 v[196:199], a[200:203], a[168:171], v[196:199]
    v_mfma_f32_16x16x32_bf16 a[36:39], a[200:203], a[172:175], a[36:39]
    v_mfma_f32_16x16x32_bf16 a[76:79], a[200:203], a[176:179], a[76:79]
    v_mfma_f32_16x16x32_bf16 a[116:119], a[200:203], a[180:183], a[116:119]
    s_add_u32 s23, s23, 1024
    s_add_u32 s24, s24, s26
    s_add_u32 s25, s25, s27
    s_waitcnt vmcnt(9)
    s_barrier
    s_waitcnt lgkmcnt(6)
    v_mfma_f32_16x16x32_bf16 v[0:3], a[184:187], a[120:123], v[0:3]
    ds_read_b64_tr_b16 a[196:197], v216 offset:24576
    ds_read_b64_tr_b16 a[198:199], v216 offset:25088
    v_mfma_f32_16x16x32_bf16 v[40:43], a[184:187], a[124:127], v[40:43]
    v_mfma_f32_16x16x32_bf16 v[80:83], a[184:187], a[128:131], v[80:83]
    s_add_u32 m0, s29, 53248
    s_nop 0
    buffer_load_dwordx4 v204, s[8:11], s24 offen lds
    v_mfma_f32_16x16x32_bf16 v[120:123], a[184:187], a[132:135], v[120:123]
    v_mfma_f32_16x16x32_bf16 v[160:163], a[184:187], a[136:139], v[160:163]
    v_mfma_f32_16x16x32_bf16 a[0:3], a[184:187], a[140:143], a[0:3]
    s_waitcnt lgkmcnt(7)
    v_mfma_f32_16x16x32_bf16 a[40:43], a[184:187], a[144:147], a[40:43]
    s_add_u32 m0, s29, 54272
    s_nop 0
    buffer_load_dwordx4 v205, s[8:11], s24 offen lds
    s_waitcnt lgkmcnt(4)
    v_mfma_f32_16x16x32_bf16 a[80:83], a[184:187], a[148:151], a[80:83]
    v_mfma_f32_16x16x32_bf16 v[4:7], a[188:191], a[120:123], v[4:7]
    ds_read_b64_tr_b16 a[200:201], v217 offset:16384
    ds_read_b64_tr_b16 a[202:203], v217 offset:16896
    v_mfma_f32_16x16x32_bf16 v[44:47], a[188:191], a[124:127], v[44:47]
    v_mfma_f32_16x16x32_bf16 v[84:87], a[188:191], a[128:131], v[84:87]
    s_add_u32 m0, s29, 55296
    s_nop 0
    buffer_load_dwordx4 v206, s[8:11], s24 offen lds
    v_mfma_f32_16x16x32_bf16 v[124:127], a[188:191], a[132:135], v[124:127]
    v_mfma_f32_16x16x32_bf16 v[164:167], a[188:191], a[136:139], v[164:167]
    ds_read_b128 a[152:155], v210 offset:36864
    v_mfma_f32_16x16x32_bf16 a[4:7], a[188:191], a[140:143], a[4:7]
    v_mfma_f32_16x16x32_bf16 a[44:47], a[188:191], a[144:147], a[44:47]
    s_add_u32 m0, s29, 56320
    s_nop 0
    buffer_load_dwordx4 v207, s[8:11], s24 offen lds
    v_mfma_f32_16x16x32_bf16 a[84:87], a[188:191], a[148:151], a[84:87]
    s_waitcnt lgkmcnt(5)
    v_mfma_f32_16x16x32_bf16 v[8:11], a[192:195], a[120:123], v[8:11]
    ds_read_b64_tr_b16 a[184:185], v217 offset:24576
    ds_read_b64_tr_b16 a[186:187], v217 offset:25088
    v_mfma_f32_16x16x32_bf16 v[48:51], a[192:195], a[124:127], v[48:51]
    v_mfma_f32_16x16x32_bf16 v[88:91], a[192:195], a[128:131], v[88:91]
    s_add_u32 m0, s31, 69632
    s_nop 0
    buffer_load_dwordx4 v208, s[12:15], s25 offen lds
    v_mfma_f32_16x16x32_bf16 v[128:131], a[192:195], a[132:135], v[128:131]
    v_mfma_f32_16x16x32_bf16 v[168:171], a[192:195], a[136:139], v[168:171]
    ds_read_b128 a[156:159], v210 offset:37888
    v_mfma_f32_16x16x32_bf16 a[8:11], a[192:195], a[140:143], a[8:11]
    v_mfma_f32_16x16x32_bf16 a[48:51], a[192:195], a[144:147], a[48:51]
    s_add_u32 m0, s29, 36864
    s_nop 0
    buffer_load_dwordx4 v200, s[4:7], s23 offen lds
    v_mfma_f32_16x16x32_bf16 a[88:91], a[192:195], a[148:151], a[88:91]
    s_waitcnt lgkmcnt(6)
    v_mfma_f32_16x16x32_bf16 v[12:15], a[196:199], a[120:123], v[12:15]
    ds_read_b64_tr_b16 a[188:189], v218 offset:16384
    ds_read_b64_tr_b16 a[190:191], v218 offset:16896
    v_mfma_f32_16x16x32_bf16 v[52:55], a[196:199], a[124:127], v[52:55]
    v_mfma_f32_16x16x32_bf16 v[92:95], a[196:199], a[128:131], v[92:95]
    s_add_u32 m0, s29, 37888
    s_nop 0
    buffer_load_dwordx4 v201, s[4:7], s23 offen lds
    v_mfma_f32_16x16x32_bf16 v[132:135], a[196:199], a[132:135], v[132:135]
    v_mfma_f32_16x16x32_bf16 v[172:175], a[196:199], a[136:139], v[172:175]
    ds_read_b128 a[160:163], v210 offset:38912
    v_mfma_f32_16x16x32_bf16 a[12:15], a[196:199], a[140:143], a[12:15]
    v_mfma_f32_16x16x32_bf16 a[52:55], a[196:199], a[144:147], a[52:55]
    s_add_u32 m0, s29, 38912
    s_nop 0
    buffer_load_dwordx4 v202, s[4:7], s23 offen lds
    v_mfma_f32_16x16x32_bf16 a[92:95], a[196:199], a[148:151], a[92:95]
    s_waitcnt lgkmcnt(7)
    v_mfma_f32_16x16x32_bf16 v[16:19], a[200:203], a[120:123], v[16:19]
    ds_read_b64_tr_b16 a[192:193], v218 offset:24576
    ds_read_b64_tr_b16 a[194:195], v218 offset:25088
    v_mfma_f32_16x16x32_bf16 v[56:59], a[200:203], a[124:127], v[56:59]
    v_mfma_f32_16x16x32_bf16 v[96:99], a[200:203], a[128:131], v[96:99]
    s_add_u32 m0, s29, 39936
    s_nop 0
    buffer_load_dwordx4 v203, s[4:7], s23 offen lds
    v_mfma_f32_16x16x32_bf16 v[136:139], a[200:203], a[132:135], v[136:139]
    v_mfma_f32_16x16x32_bf16 v[176:179], a[200:203], a[136:139], v[176:179]
    ds_read_b128 a[164:167], v210 offset:39936
    v_mfma_f32_16x16x32_bf16 a[16:19], a[200:203], a[140:143], a[16:19]
    v_mfma_f32_16x16x32_bf16 a[56:59], a[200:203], a[144:147], a[56:59]
    v_mfma_f32_16x16x32_bf16 a[96:99], a[200:203], a[148:151], a[96:99]
    s_waitcnt lgkmcnt(7)
    v_mfma_f32_16x16x32_bf16 v[20:23], a[184:187], a[120:123], v[20:23]
    ds_read_b64_tr_b16 a[196:197], v220 offset:0
    ds_read_b64_tr_b16 a[198:199], v220 offset:256
    v_mfma_f32_16x16x32_bf16 v[60:63], a[184:187], a[124:127], v[60:63]
    v_mfma_f32_16x16x32_bf16 v[100:103], a[184:187], a[128:131], v[100:103]
    v_mfma_f32_16x16x32_bf16 v[140:143], a[184:187], a[132:135], v[140:143]
    v_mfma_f32_16x16x32_bf16 v[180:183], a[184:187], a[136:139], v[180:183]
    ds_read_b128 a[168:171], v210 offset:40960
    v_mfma_f32_16x16x32_bf16 a[20:23], a[184:187], a[140:143], a[20:23]
    v_mfma_f32_16x16x32_bf16 a[60:63], a[184:187], a[144:147], a[60:63]
    v_mfma_f32_16x16x32_bf16 a[100:103], a[184:187], a[148:151], a[100:103]
    s_waitcnt lgkmcnt(7)
    v_mfma_f32_16x16x32_bf16 v[24:27], a[188:191], a[120:123], v[24:27]
    ds_read_b64_tr_b16 a[200:201], v220 offset:2048
    ds_read_b64_tr_b16 a[202:203], v220 offset:2304
    v_mfma_f32_16x16x32_bf16 v[64:67], a[188:191], a[124:127], v[64:67]
    v_mfma_f32_16x16x32_bf16 v[104:107], a[188:191], a[128:131], v[104:107]
    v_mfma_f32_16x16x32_bf16 v[144:147], a[188:191], a[132:135], v[144:147]
    v_mfma_f32_16x16x32_bf16 v[184:187], a[188:191], a[136:139], v[184:187]
    ds_read_b128 a[172:175], v210 offset:41984
    v_mfma_f32_16x16x32_bf16 a[24:27], a[188:191], a[140:143], a[24:27]
    v_mfma_f32_16x16x32_bf16 a[64:67], a[188:191], a[144:147], a[64:67]
    v_mfma_f32_16x16x32_bf16 a[104:107], a[188:191], a[148:151], a[104:107]
    s_waitcnt lgkmcnt(7)
    v_mfma_f32_16x16x32_bf16 v[28:31], a[192:195], a[120:123], v[28:31]
    ds_read_b64_tr_b16 a[184:185], v215 offset:53248
    ds_read_b64_tr_b16 a[186:187], v215 offset:53760
    v_mfma_f32_16x16x32_bf16 v[68:71], a[192:195], a[124:127], v[68:71]
    v_mfma_f32_16x16x32_bf16 v[108:111], a[192:195], a[128:131], v[108:111]
    v_mfma_f32_16x16x32_bf16 v[148:151], a[192:195], a[132:135], v[148:151]
    v_mfma_f32_16x16x32_bf16 v[188:191], a[192:195], a[136:139], v[188:191]
    ds_read_b128 a[176:179], v210 offset:43008
    v_mfma_f32_16x16x32_bf16 a[28:31], a[192:195], a[140:143], a[28:31]
    v_mfma_f32_16x16x32_bf16 a[68:71], a[192:195], a[144:147], a[68:71]
    v_mfma_f32_16x16x32_bf16 a[108:111], a[192:195], a[148:151], a[108:111]
    s_waitcnt lgkmcnt(7)
    v_mfma_f32_16x16x32_bf16 v[32:35], a[196:199], a[120:123], v[32:35]
    ds_read_b64_tr_b16 a[188:189], v215 offset:61440
    ds_read_b64_tr_b16 a[190:191], v215 offset:61952
    v_mfma_f32_16x16x32_bf16 v[72:75], a[196:199], a[124:127], v[72:75]
    v_mfma_f32_16x16x32_bf16 v[112:115], a[196:199], a[128:131], v[112:115]
    v_mfma_f32_16x16x32_bf16 v[152:155], a[196:199], a[132:135], v[152:155]
    v_mfma_f32_16x16x32_bf16 v[192:195], a[196:199], a[136:139], v[192:195]
    ds_read_b128 a[180:183], v210 offset:44032
    v_mfma_f32_16x16x32_bf16 a[32:35], a[196:199], a[140:143], a[32:35]
    v_mfma_f32_16x16x32_bf16 a[72:75], a[196:199], a[144:147], a[72:75]
    v_mfma_f32_16x16x32_bf16 a[112:115], a[196:199], a[148:151], a[112:115]
    s_waitcnt lgkmcnt(7)
    v_mfma_f32_16x16x32_bf16 v[36:39], a[200:203], a[120:123], v[36:39]
    ds_read_b64_tr_b16 a[192:193], v216 offset:53248
    ds_read_b64_tr_b16 a[194:195], v216 offset:53760
    v_mfma_f32_16x16x32_bf16 v[76:79], a[200:203], a[124:127], v[76:79]
    v_mfma_f32_16x16x32_bf16 v[116:119], a[200:203], a[128:131], v[116:119]
    v_mfma_f32_16x16x32_bf16 v[156:159], a[200:203], a[132:135], v[156:159]
    v_mfma_f32_16x16x32_bf16 v[196:199], a[200:203], a[136:139], v[196:199]
    v_mfma_f32_16x16x32_bf16 a[36:39], a[200:203], a[140:143], a[36:39]
    v_mfma_f32_16x16x32_bf16 a[76:79], a[200:203], a[144:147], a[76:79]
    v_mfma_f32_16x16x32_bf16 a[116:119], a[200:203], a[148:151], a[116:119]
    s_add_u32 s23, s23, 1024
    s_add_u32 s24, s24, s26
    s_add_u32 s25, s25, s27
    s_waitcnt vmcnt(9)
    s_barrier
    s_waitcnt lgkmcnt(6)
    v_mfma_f32_16x16x32_bf16 v[0:3], a[184:187], a[152:155], v[0:3]
    ds_read_b64_tr_b16 a[196:197], v216 offset:61440
    ds_read_b64_tr_b16 a[198:199], v216 offset:61952
    v_mfma_f32_16x16x32_bf16 v[40:43], a[184:187], a[156:159], v[40:43]
    v_mfma_f32_16x16x32_bf16 v[80:83], a[184:187], a[160:163], v[80:83]
    s_add_u32 m0, s29, 90112
    s_nop 0
    buffer_load_dwordx4 v204, s[8:11], s24 offen lds
    v_mfma_f32_16x16x32_bf16 v[120:123], a[184:187], a[164:167], v[120:123]
    v_mfma_f32_16x16x32_bf16 v[160:163], a[184:187], a[168:171], v[160:163]
    v_mfma_f32_16x16x32_bf16 a[0:3], a[184:187], a[172:175], a[0:3]
    s_waitcnt lgkmcnt(7)
    v_mfma_f32_16x16x32_bf16 a[40:43], a[184:187], a[176:179], a[40:43]
    s_add_u32 m0, s29, 91136
    s_nop 0
    buffer_load_dwordx4 v205, s[8:11], s24 offen lds
    s_waitcnt lgkmcnt(4)
    v_mfma_f32_16x16x32_bf16 a[80:83], a[184:187], a[180:183], a[80:83]
    v_mfma_f32_16x16x32_bf16 v[4:7], a[188:191], a[152:155], v[4:7]
    ds_read_b64_tr_b16 a[200:201], v217 offset:53248
    ds_read_b64_tr_b16 a[202:203], v217 offset:53760
    v_mfma_f32_16x16x32_bf16 v[44:47], a[188:191], a[156:159], v[44:47]
    v_mfma_f32_16x16x32_bf16 v[84:87], a[188:191], a[160:163], v[84:87]
    s_add_u32 m0, s29, 92160
    s_nop 0
    buffer_load_dwordx4 v206, s[8:11], s24 offen lds
    v_mfma_f32_16x16x32_bf16 v[124:127], a[188:191], a[164:167], v[124:127]
    v_mfma_f32_16x16x32_bf16 v[164:167], a[188:191], a[168:171], v[164:167]
    ds_read_b128 a[120:123], v209 offset:0
    v_mfma_f32_16x16x32_bf16 a[4:7], a[188:191], a[172:175], a[4:7]
    v_mfma_f32_16x16x32_bf16 a[44:47], a[188:191], a[176:179], a[44:47]
    s_add_u32 m0, s29, 93184
    s_nop 0
    buffer_load_dwordx4 v207, s[8:11], s24 offen lds
    v_mfma_f32_16x16x32_bf16 a[84:87], a[188:191], a[180:183], a[84:87]
    s_waitcnt lgkmcnt(5)
    v_mfma_f32_16x16x32_bf16 v[8:11], a[192:195], a[152:155], v[8:11]
    ds_read_b64_tr_b16 a[184:185], v217 offset:61440
    ds_read_b64_tr_b16 a[186:187], v217 offset:61952
    v_mfma_f32_16x16x32_bf16 v[48:51], a[192:195], a[156:159], v[48:51]
    v_mfma_f32_16x16x32_bf16 v[88:91], a[192:195], a[160:163], v[88:91]
    s_add_u32 m0, s31, 106496
    s_nop 0
    buffer_load_dwordx4 v208, s[12:15], s25 offen lds
    v_mfma_f32_16x16x32_bf16 v[128:131], a[192:195], a[164:167], v[128:131]
    v_mfma_f32_16x16x32_bf16 v[168:171], a[192:195], a[168:171], v[168:171]
    ds_read_b128 a[124:127], v209 offset:1024
    v_mfma_f32_16x16x32_bf16 a[8:11], a[192:195], a[172:175], a[8:11]
    v_mfma_f32_16x16x32_bf16 a[48:51], a[192:195], a[176:179], a[48:51]
    s_add_u32 m0, s29, 73728
    s_nop 0
    buffer_load_dwordx4 v200, s[4:7], s23 offen lds
    v_mfma_f32_16x16x32_bf16 a[88:91], a[192:195], a[180:183], a[88:91]
    s_waitcnt lgkmcnt(6)
    v_mfma_f32_16x16x32_bf16 v[12:15], a[196:199], a[152:155], v[12:15]
    ds_read_b64_tr_b16 a[188:189], v218 offset:53248
    ds_read_b64_tr_b16 a[190:191], v218 offset:53760
    v_mfma_f32_16x16x32_bf16 v[52:55], a[196:199], a[156:159], v[52:55]
    v_mfma_f32_16x16x32_bf16 v[92:95], a[196:199], a[160:163], v[92:95]
    s_add_u32 m0, s29, 74752
    s_nop 0
    buffer_load_dwordx4 v201, s[4:7], s23 offen lds
    v_mfma_f32_16x16x32_bf16 v[132:135], a[196:199], a[164:167], v[132:135]
    v_mfma_f32_16x16x32_bf16 v[172:175], a[196:199], a[168:171], v[172:175]
    ds_read_b128 a[128:131], v209 offset:2048
    v_mfma_f32_16x16x32_bf16 a[12:15], a[196:199], a[172:175], a[12:15]
    v_mfma_f32_16x16x32_bf16 a[52:55], a[196:199], a[176:179], a[52:55]
    s_add_u32 m0, s29, 75776
    s_nop 0
    buffer_load_dwordx4 v202, s[4:7], s23 offen lds
    v_mfma_f32_16x16x32_bf16 a[92:95], a[196:199], a[180:183], a[92:95]
    s_waitcnt lgkmcnt(7)
    v_mfma_f32_16x16x32_bf16 v[16:19], a[200:203], a[152:155], v[16:19]
    ds_read_b64_tr_b16 a[192:193], v218 offset:61440
    ds_read_b64_tr_b16 a[194:195], v218 offset:61952
    v_mfma_f32_16x16x32_bf16 v[56:59], a[200:203], a[156:159], v[56:59]
    v_mfma_f32_16x16x32_bf16 v[96:99], a[200:203], a[160:163], v[96:99]
    s_add_u32 m0, s29, 76800
    s_nop 0
    buffer_load_dwordx4 v203, s[4:7], s23 offen lds
    v_mfma_f32_16x16x32_bf16 v[136:139], a[200:203], a[164:167], v[136:139]
    v_mfma_f32_16x16x32_bf16 v[176:179], a[200:203], a[168:171], v[176:179]
    ds_read_b128 a[132:135], v209 offset:3072
    v_mfma_f32_16x16x32_bf16 a[16:19], a[200:203], a[172:175], a[16:19]
    v_mfma_f32_16x16x32_bf16 a[56:59], a[200:203], a[176:179], a[56:59]
    v_mfma_f32_16x16x32_bf16 a[96:99], a[200:203], a[180:183], a[96:99]
    s_waitcnt lgkmcnt(7)
    v_mfma_f32_16x16x32_bf16 v[20:23], a[184:187], a[152:155], v[20:23]
    ds_read_b64_tr_b16 a[196:197], v220 offset:36864
    ds_read_b64_tr_b16 a[198:199], v220 offset:37120
    v_mfma_f32_16x16x32_bf16 v[60:63], a[184:187], a[156:159], v[60:63]
    v_mfma_f32_16x16x32_bf16 v[100:103], a[184:187], a[160:163], v[100:103]
    v_mfma_f32_16x16x32_bf16 v[140:143], a[184:187], a[164:167], v[140:143]
    v_mfma_f32_16x16x32_bf16 v[180:183], a[184:187], a[168:171], v[180:183]
    ds_read_b128 a[136:139], v209 offset:4096
    v_mfma_f32_16x16x32_bf16 a[20:23], a[184:187], a[172:175], a[20:23]
    v_mfma_f32_16x16x32_bf16 a[60:63], a[184:187], a[176:179], a[60:63]
    v_mfma_f32_16x16x32_bf16 a[100:103], a[184:187], a[180:183], a[100:103]
    s_waitcnt lgkmcnt(7)
    v_mfma_f32_16x16x32_bf16 v[24:27], a[188:191], a[152:155], v[24:27]
    ds_read_b64_tr_b16 a[200:201], v220 offset:38912
    ds_read_b64_tr_b16 a[202:203], v220 offset:39168
    v_mfma_f32_16x16x32_bf16 v[64:67], a[188:191], a[156:159], v[64:67]
    v_mfma_f32_16x16x32_bf16 v[104:107], a[188:191], a[160:163], v[104:107]
    v_mfma_f32_16x16x32_bf16 v[144:147], a[188:191], a[164:167], v[144:147]
    v_mfma_f32_16x16x32_bf16 v[184:187], a[188:191], a[168:171], v[184:187]
    ds_read_b128 a[140:143], v209 offset:5120
    v_mfma_f32_16x16x32_bf16 a[24:27], a[188:191], a[172:175], a[24:27]
    v_mfma_f32_16x16x32_bf16 a[64:67], a[188:191], a[176:179], a[64:67]
    v_mfma_f32_16x16x32_bf16 a[104:107], a[188:191], a[180:183], a[104:107]
    s_waitcnt lgkmcnt(7)
    v_mfma_f32_16x16x32_bf16 v[28:31], a[192:195], a[152:155], v[28:31]
    ds_read_b64_tr_b16 a[184:185], v211 offset:16384
    ds_read_b64_tr_b16 a[186:187], v211 offset:16896
    v_mfma_f32_16x16x32_bf16 v[68:71], a[192:195], a[156:159], v[68:71]
    v_mfma_f32_16x16x32_bf16 v[108:111], a[192:195], a[160:163], v[108:111]
    v_mfma_f32_16x16x32_bf16 v[148:151], a[192:195], a[164:167], v[148:151]
    v_mfma_f32_16x16x32_bf16 v[188:191], a[192:195], a[168:171], v[188:191]
    ds_read_b128 a[144:147], v209 offset:6144
    v_mfma_f32_16x16x32_bf16 a[28:31], a[192:195], a[172:175], a[28:31]
    v_mfma_f32_16x16x32_bf16 a[68:71], a[192:195], a[176:179], a[68:71]
    v_mfma_f32_16x16x32_bf16 a[108:111], a[192:195], a[180:183], a[108:111]
    s_waitcnt lgkmcnt(7)
    v_mfma_f32_16x16x32_bf16 v[32:35], a[196:199], a[152:155], v[32:35]
    ds_read_b64_tr_b16 a[188:189], v211 offset:24576
    ds_read_b64_tr_b16 a[190:191], v211 offset:25088
    v_mfma_f32_16x16x32_bf16 v[72:75], a[196:199], a[156:159], v[72:75]
    v_mfma_f32_16x16x32_bf16 v[112:115], a[196:199], a[160:163], v[112:115]
    v_mfma_f32_16x16x32_bf16 v[152:155], a[196:199], a[164:167], v[152:155]
    v_mfma_f32_16x16x32_bf16 v[192:195], a[196:199], a[168:171], v[192:195]
    ds_read_b128 a[148:151], v209 offset:7168
    v_mfma_f32_16x16x32_bf16 a[32:35], a[196:199], a[172:175], a[32:35]
    v_mfma_f32_16x16x32_bf16 a[72:75], a[196:199], a[176:179], a[72:75]
    v_mfma_f32_16x16x32_bf16 a[112:115], a[196:199], a[180:183], a[112:115]
    s_waitcnt lgkmcnt(7)
    v_mfma_f32_16x16x32_bf16 v[36:39], a[200:203], a[152:155], v[36:39]
    ds_read_b64_tr_b16 a[192:193], v212 offset:16384
    ds_read_b64_tr_b16 a[194:195], v212 offset:16896
    v_mfma_f32_16x16x32_bf16 v[76:79], a[200:203], a[156:159], v[76:79]
    v_mfma_f32_16x16x32_bf16 v[116:119], a[200:203], a[160:163], v[116:119]
    v_mfma_f32_16x16x32_bf16 v[156:159], a[200:203], a[164:167], v[156:159]
    v_mfma_f32_16x16x32_bf16 v[196:199], a[200:203], a[168:171], v[196:199]
    v_mfma_f32_16x16x32_bf16 a[36:39], a[200:203], a[172:175], a[36:39]
    v_mfma_f32_16x16x32_bf16 a[76:79], a[200:203], a[176:179], a[76:79]
    v_mfma_f32_16x16x32_bf16 a[116:119], a[200:203], a[180:183], a[116:119]
    s_add_u32 s23, s23, 1024
    s_add_u32 s24, s24, s26
    s_add_u32 s25, s25, s27
    s_cmp_eq_u32 s28, 2
    s_cselect_b32 s72, s68, s72
    s_cselect_b32 s73, s69, s73
    s_cselect_b32 s74, 2097152, s74
    s_cselect_b32 s3, -5, 1
    s_mul_i32 s3, s3, 1310720
    v_add_u32 v232, s3, v232
    buffer_load_dword v233, v232, s[72:75], 0 offen
    s_sub_u32 s28, s28, 1
    s_cmp_lg_u32 s28, 0
    s_cbranch_scc1 g1_kernel_loop
    s_waitcnt vmcnt(10)
    s_barrier
    s_waitcnt lgkmcnt(6)
    v_mfma_f32_16x16x32_bf16 v[0:3], a[184:187], a[120:123], v[0:3]
    ds_read_b64_tr_b16 a[196:197], v212 offset:24576
    ds_read_b64_tr_b16 a[198:199], v212 offset:25088
    v_mfma_f32_16x16x32_bf16 v[40:43], a[184:187], a[124:127], v[40:43]
    v_mfma_f32_16x16x32_bf16 v[80:83], a[184:187], a[128:131], v[80:83]
    s_add_u32 m0, s29, 126976
    s_nop 0
    buffer_load_dwordx4 v204, s[8:11], s24 offen lds
    v_mfma_f32_16x16x32_bf16 v[120:123], a[184:187], a[132:135], v[120:123]
    v_mfma_f32_16x16x32_bf16 v[160:163], a[184:187], a[136:139], v[160:163]
    v_mfma_f32_16x16x32_bf16 a[0:3], a[184:187], a[140:143], a[0:3]
    s_waitcnt lgkmcnt(7)
    v_mfma_f32_16x16x32_bf16 a[40:43], a[184:187], a[144:147], a[40:43]
    s_add_u32 m0, s29, 128000
    s_nop 0
    buffer_load_dwordx4 v205, s[8:11], s24 offen lds
    s_waitcnt lgkmcnt(4)
    v_mfma_f32_16x16x32_bf16 a[80:83], a[184:187], a[148:151], a[80:83]
    v_mfma_f32_16x16x32_bf16 v[4:7], a[188:191], a[120:123], v[4:7]
    ds_read_b64_tr_b16 a[200:201], v213 offset:16384
    ds_read_b64_tr_b16 a[202:203], v213 offset:16896
    v_mfma_f32_16x16x32_bf16 v[44:47], a[188:191], a[124:127], v[44:47]
    v_mfma_f32_16x16x32_bf16 v[84:87], a[188:191], a[128:131], v[84:87]
    s_add_u32 m0, s29, 129024
    s_nop 0
    buffer_load_dwordx4 v206, s[8:11], s24 offen lds
    v_mfma_f32_16x16x32_bf16 v[124:127], a[188:191], a[132:135], v[124:127]
    v_mfma_f32_16x16x32_bf16 v[164:167], a[188:191], a[136:139], v[164:167]
    ds_read_b128 a[152:155], v209 offset:36864
    v_mfma_f32_16x16x32_bf16 a[4:7], a[188:191], a[140:143], a[4:7]
    v_mfma_f32_16x16x32_bf16 a[44:47], a[188:191], a[144:147], a[44:47]
    s_add_u32 m0, s29, 130048
    s_nop 0
    buffer_load_dwordx4 v207, s[8:11], s24 offen lds
    v_mfma_f32_16x16x32_bf16 a[84:87], a[188:191], a[148:151], a[84:87]
    s_waitcnt lgkmcnt(5)
    v_mfma_f32_16x16x32_bf16 v[8:11], a[192:195], a[120:123], v[8:11]
    ds_read_b64_tr_b16 a[184:185], v213 offset:24576
    ds_read_b64_tr_b16 a[186:187], v213 offset:25088
    v_mfma_f32_16x16x32_bf16 v[48:51], a[192:195], a[124:127], v[48:51]
    v_mfma_f32_16x16x32_bf16 v[88:91], a[192:195], a[128:131], v[88:91]
    s_add_u32 m0, s31, 143360
    s_nop 0
    buffer_load_dwordx4 v208, s[12:15], s25 offen lds
    v_mfma_f32_16x16x32_bf16 v[128:131], a[192:195], a[132:135], v[128:131]
    v_mfma_f32_16x16x32_bf16 v[168:171], a[192:195], a[136:139], v[168:171]
    ds_read_b128 a[156:159], v209 offset:37888
    v_mfma_f32_16x16x32_bf16 a[8:11], a[192:195], a[140:143], a[8:11]
    v_mfma_f32_16x16x32_bf16 a[48:51], a[192:195], a[144:147], a[48:51]
    s_add_u32 m0, s29, 110592
    s_nop 0
    buffer_load_dwordx4 v200, s[4:7], s23 offen lds
    v_mfma_f32_16x16x32_bf16 a[88:91], a[192:195], a[148:151], a[88:91]
    s_waitcnt lgkmcnt(6)
    v_mfma_f32_16x16x32_bf16 v[12:15], a[196:199], a[120:123], v[12:15]
    ds_read_b64_tr_b16 a[188:189], v214 offset:16384
    ds_read_b64_tr_b16 a[190:191], v214 offset:16896
    v_mfma_f32_16x16x32_bf16 v[52:55], a[196:199], a[124:127], v[52:55]
    v_mfma_f32_16x16x32_bf16 v[92:95], a[196:199], a[128:131], v[92:95]
    s_add_u32 m0, s29, 111616
    s_nop 0
    buffer_load_dwordx4 v201, s[4:7], s23 offen lds
    v_mfma_f32_16x16x32_bf16 v[132:135], a[196:199], a[132:135], v[132:135]
    v_mfma_f32_16x16x32_bf16 v[172:175], a[196:199], a[136:139], v[172:175]
    ds_read_b128 a[160:163], v209 offset:38912
    v_mfma_f32_16x16x32_bf16 a[12:15], a[196:199], a[140:143], a[12:15]
    v_mfma_f32_16x16x32_bf16 a[52:55], a[196:199], a[144:147], a[52:55]
    s_add_u32 m0, s29, 112640
    s_nop 0
    buffer_load_dwordx4 v202, s[4:7], s23 offen lds
    v_mfma_f32_16x16x32_bf16 a[92:95], a[196:199], a[148:151], a[92:95]
    s_waitcnt lgkmcnt(7)
    v_mfma_f32_16x16x32_bf16 v[16:19], a[200:203], a[120:123], v[16:19]
    ds_read_b64_tr_b16 a[192:193], v214 offset:24576
    ds_read_b64_tr_b16 a[194:195], v214 offset:25088
    v_mfma_f32_16x16x32_bf16 v[56:59], a[200:203], a[124:127], v[56:59]
    v_mfma_f32_16x16x32_bf16 v[96:99], a[200:203], a[128:131], v[96:99]
    s_add_u32 m0, s29, 113664
    s_nop 0
    buffer_load_dwordx4 v203, s[4:7], s23 offen lds
    v_mfma_f32_16x16x32_bf16 v[136:139], a[200:203], a[132:135], v[136:139]
    v_mfma_f32_16x16x32_bf16 v[176:179], a[200:203], a[136:139], v[176:179]
    ds_read_b128 a[164:167], v209 offset:39936
    v_mfma_f32_16x16x32_bf16 a[16:19], a[200:203], a[140:143], a[16:19]
    v_mfma_f32_16x16x32_bf16 a[56:59], a[200:203], a[144:147], a[56:59]
    v_mfma_f32_16x16x32_bf16 a[96:99], a[200:203], a[148:151], a[96:99]
    s_waitcnt lgkmcnt(7)
    v_mfma_f32_16x16x32_bf16 v[20:23], a[184:187], a[120:123], v[20:23]
    ds_read_b64_tr_b16 a[196:197], v219 offset:0
    ds_read_b64_tr_b16 a[198:199], v219 offset:256
    v_mfma_f32_16x16x32_bf16 v[60:63], a[184:187], a[124:127], v[60:63]
    v_mfma_f32_16x16x32_bf16 v[100:103], a[184:187], a[128:131], v[100:103]
    v_mfma_f32_16x16x32_bf16 v[140:143], a[184:187], a[132:135], v[140:143]
    v_mfma_f32_16x16x32_bf16 v[180:183], a[184:187], a[136:139], v[180:183]
    ds_read_b128 a[168:171], v209 offset:40960
    v_mfma_f32_16x16x32_bf16 a[20:23], a[184:187], a[140:143], a[20:23]
    v_mfma_f32_16x16x32_bf16 a[60:63], a[184:187], a[144:147], a[60:63]
    v_mfma_f32_16x16x32_bf16 a[100:103], a[184:187], a[148:151], a[100:103]
    s_waitcnt lgkmcnt(7)
    v_mfma_f32_16x16x32_bf16 v[24:27], a[188:191], a[120:123], v[24:27]
    ds_read_b64_tr_b16 a[200:201], v219 offset:2048
    ds_read_b64_tr_b16 a[202:203], v219 offset:2304
    v_mfma_f32_16x16x32_bf16 v[64:67], a[188:191], a[124:127], v[64:67]
    v_mfma_f32_16x16x32_bf16 v[104:107], a[188:191], a[128:131], v[104:107]
    v_mfma_f32_16x16x32_bf16 v[144:147], a[188:191], a[132:135], v[144:147]
    v_mfma_f32_16x16x32_bf16 v[184:187], a[188:191], a[136:139], v[184:187]
    ds_read_b128 a[172:175], v209 offset:41984
    v_mfma_f32_16x16x32_bf16 a[24:27], a[188:191], a[140:143], a[24:27]
    v_mfma_f32_16x16x32_bf16 a[64:67], a[188:191], a[144:147], a[64:67]
    v_mfma_f32_16x16x32_bf16 a[104:107], a[188:191], a[148:151], a[104:107]
    s_waitcnt lgkmcnt(7)
    v_mfma_f32_16x16x32_bf16 v[28:31], a[192:195], a[120:123], v[28:31]
    ds_read_b64_tr_b16 a[184:185], v211 offset:53248
    ds_read_b64_tr_b16 a[186:187], v211 offset:53760
    v_mfma_f32_16x16x32_bf16 v[68:71], a[192:195], a[124:127], v[68:71]
    v_mfma_f32_16x16x32_bf16 v[108:111], a[192:195], a[128:131], v[108:111]
    v_mfma_f32_16x16x32_bf16 v[148:151], a[192:195], a[132:135], v[148:151]
    v_mfma_f32_16x16x32_bf16 v[188:191], a[192:195], a[136:139], v[188:191]
    ds_read_b128 a[176:179], v209 offset:43008
    v_mfma_f32_16x16x32_bf16 a[28:31], a[192:195], a[140:143], a[28:31]
    v_mfma_f32_16x16x32_bf16 a[68:71], a[192:195], a[144:147], a[68:71]
    v_mfma_f32_16x16x32_bf16 a[108:111], a[192:195], a[148:151], a[108:111]
    s_waitcnt lgkmcnt(7)
    v_mfma_f32_16x16x32_bf16 v[32:35], a[196:199], a[120:123], v[32:35]
    ds_read_b64_tr_b16 a[188:189], v211 offset:61440
    ds_read_b64_tr_b16 a[190:191], v211 offset:61952
    v_mfma_f32_16x16x32_bf16 v[72:75], a[196:199], a[124:127], v[72:75]
    v_mfma_f32_16x16x32_bf16 v[112:115], a[196:199], a[128:131], v[112:115]
    v_mfma_f32_16x16x32_bf16 v[152:155], a[196:199], a[132:135], v[152:155]
    v_mfma_f32_16x16x32_bf16 v[192:195], a[196:199], a[136:139], v[192:195]
    ds_read_b128 a[180:183], v209 offset:44032
    v_mfma_f32_16x16x32_bf16 a[32:35], a[196:199], a[140:143], a[32:35]
    v_mfma_f32_16x16x32_bf16 a[72:75], a[196:199], a[144:147], a[72:75]
    v_mfma_f32_16x16x32_bf16 a[112:115], a[196:199], a[148:151], a[112:115]
    s_waitcnt lgkmcnt(7)
    v_mfma_f32_16x16x32_bf16 v[36:39], a[200:203], a[120:123], v[36:39]
    ds_read_b64_tr_b16 a[192:193], v212 offset:53248
    ds_read_b64_tr_b16 a[194:195], v212 offset:53760
    v_mfma_f32_16x16x32_bf16 v[76:79], a[200:203], a[124:127], v[76:79]
    v_mfma_f32_16x16x32_bf16 v[116:119], a[200:203], a[128:131], v[116:119]
    v_mfma_f32_16x16x32_bf16 v[156:159], a[200:203], a[132:135], v[156:159]
    v_mfma_f32_16x16x32_bf16 v[196:199], a[200:203], a[136:139], v[196:199]
    v_mfma_f32_16x16x32_bf16 a[36:39], a[200:203], a[140:143], a[36:39]
    v_mfma_f32_16x16x32_bf16 a[76:79], a[200:203], a[144:147], a[76:79]
    v_mfma_f32_16x16x32_bf16 a[116:119], a[200:203], a[148:151], a[116:119]
    s_add_u32 s23, s23, 1024
    s_add_u32 s24, s24, s26
    s_add_u32 s25, s25, s27
    s_waitcnt vmcnt(10) lgkmcnt(0)
    s_barrier
    s_cmp_lg_u32 s60, 0
    s_cbranch_scc1 g1_kernel_gu_ab
    v_mfma_f32_16x16x32_bf16 v[0:3], a[184:187], a[152:155], v[0:3]
    v_mfma_f32_16x16x32_bf16 v[40:43], a[184:187], a[156:159], v[40:43]
    v_mfma_f32_16x16x32_bf16 v[80:83], a[184:187], a[160:163], v[80:83]
    ds_read_b128 a[120:123], v210 offset:0
    v_mfma_f32_16x16x32_bf16 v[120:123], a[184:187], a[164:167], v[120:123]
    v_mfma_f32_16x16x32_bf16 v[160:163], a[184:187], a[168:171], v[160:163]
    ds_read_b128 a[124:127], v210 offset:1024
    ds_read_b64_tr_b16 a[196:197], v212 offset:61440
    ds_read_b64_tr_b16 a[198:199], v212 offset:61952
    v_mfma_f32_16x16x32_bf16 a[0:3], a[184:187], a[172:175], a[0:3]
    v_mfma_f32_16x16x32_bf16 a[40:43], a[184:187], a[176:179], a[40:43]
    ds_read_b128 a[128:131], v210 offset:2048
    v_mfma_f32_16x16x32_bf16 a[80:83], a[184:187], a[180:183], a[80:83]
    v_mfma_f32_16x16x32_bf16 v[4:7], a[188:191], a[152:155], v[4:7]
    ds_read_b128 a[132:135], v210 offset:3072
    v_mfma_f32_16x16x32_bf16 v[44:47], a[188:191], a[156:159], v[44:47]
    v_mfma_f32_16x16x32_bf16 v[84:87], a[188:191], a[160:163], v[84:87]
    ds_read_b128 a[136:139], v210 offset:4096
    v_mfma_f32_16x16x32_bf16 v[124:127], a[188:191], a[164:167], v[124:127]
    v_mfma_f32_16x16x32_bf16 v[164:167], a[188:191], a[168:171], v[164:167]
    ds_read_b128 a[140:143], v210 offset:5120
    ds_read_b64_tr_b16 a[200:201], v215 offset:16384
    ds_read_b64_tr_b16 a[202:203], v215 offset:16896
    v_mfma_f32_16x16x32_bf16 a[4:7], a[188:191], a[172:175], a[4:7]
    v_mfma_f32_16x16x32_bf16 a[44:47], a[188:191], a[176:179], a[44:47]
    ds_read_b128 a[144:147], v210 offset:6144
    v_mfma_f32_16x16x32_bf16 a[84:87], a[188:191], a[180:183], a[84:87]
    v_mfma_f32_16x16x32_bf16 v[8:11], a[192:195], a[152:155], v[8:11]
    ds_read_b128 a[148:151], v210 offset:7168
    v_mfma_f32_16x16x32_bf16 v[48:51], a[192:195], a[156:159], v[48:51]
    v_mfma_f32_16x16x32_bf16 v[88:91], a[192:195], a[160:163], v[88:91]
    v_mfma_f32_16x16x32_bf16 v[128:131], a[192:195], a[164:167], v[128:131]
    v_mfma_f32_16x16x32_bf16 v[168:171], a[192:195], a[168:171], v[168:171]
    ds_read_b64_tr_b16 a[236:237], v215 offset:24576
    ds_read_b64_tr_b16 a[238:239], v215 offset:25088
    v_mfma_f32_16x16x32_bf16 a[8:11], a[192:195], a[172:175], a[8:11]
    v_mfma_f32_16x16x32_bf16 a[48:51], a[192:195], a[176:179], a[48:51]
    v_mfma_f32_16x16x32_bf16 a[88:91], a[192:195], a[180:183], a[88:91]
    s_waitcnt lgkmcnt(10)
    v_mfma_f32_16x16x32_bf16 v[12:15], a[196:199], a[152:155], v[12:15]
    v_mfma_f32_16x16x32_bf16 v[52:55], a[196:199], a[156:159], v[52:55]
    v_mfma_f32_16x16x32_bf16 v[92:95], a[196:199], a[160:163], v[92:95]
    v_mfma_f32_16x16x32_bf16 v[132:135], a[196:199], a[164:167], v[132:135]
    v_mfma_f32_16x16x32_bf16 v[172:175], a[196:199], a[168:171], v[172:175]
    ds_read_b64_tr_b16 a[240:241], v216 offset:16384
    ds_read_b64_tr_b16 a[242:243], v216 offset:16896
    v_mfma_f32_16x16x32_bf16 a[12:15], a[196:199], a[172:175], a[12:15]
    v_mfma_f32_16x16x32_bf16 a[52:55], a[196:199], a[176:179], a[52:55]
    v_mfma_f32_16x16x32_bf16 a[92:95], a[196:199], a[180:183], a[92:95]
    s_waitcnt lgkmcnt(6)
    v_mfma_f32_16x16x32_bf16 v[0:3], a[200:203], a[120:123], v[0:3]
    v_mfma_f32_16x16x32_bf16 v[40:43], a[200:203], a[124:127], v[40:43]
    v_mfma_f32_16x16x32_bf16 v[80:83], a[200:203], a[128:131], v[80:83]
    v_mfma_f32_16x16x32_bf16 v[120:123], a[200:203], a[132:135], v[120:123]
    v_mfma_f32_16x16x32_bf16 v[160:163], a[200:203], a[136:139], v[160:163]
    ds_read_b64_tr_b16 a[244:245], v216 offset:24576
    ds_read_b64_tr_b16 a[246:247], v216 offset:25088
    v_mfma_f32_16x16x32_bf16 a[0:3], a[200:203], a[140:143], a[0:3]
    s_waitcnt lgkmcnt(7)
    v_mfma_f32_16x16x32_bf16 a[40:43], a[200:203], a[144:147], a[40:43]
    s_waitcnt lgkmcnt(6)
    v_mfma_f32_16x16x32_bf16 a[80:83], a[200:203], a[148:151], a[80:83]
    s_waitcnt lgkmcnt(4)
    v_mfma_f32_16x16x32_bf16 v[4:7], a[236:239], a[120:123], v[4:7]
    v_mfma_f32_16x16x32_bf16 v[44:47], a[236:239], a[124:127], v[44:47]
    v_mfma_f32_16x16x32_bf16 v[84:87], a[236:239], a[128:131], v[84:87]
    v_mfma_f32_16x16x32_bf16 v[124:127], a[236:239], a[132:135], v[124:127]
    v_mfma_f32_16x16x32_bf16 v[164:167], a[236:239], a[136:139], v[164:167]
    s_waitcnt vmcnt(0)
    s_barrier
    ds_read_b64_tr_b16 a[248:249], v215 offset:53248
    ds_read_b64_tr_b16 a[250:251], v215 offset:53760
    v_lshrrev_b32 v226, 2, v223
    v_mov_b32 v227, 0
    s_lshl_b32 s3, s2, 10
    s_lshl_b32 s47, s20, 8
    s_add_u32 s3, s3, s47
    s_add_u32 s3, s3, 62914560
    v_mfma_f32_16x16x32_bf16 a[4:7], a[236:239], a[140:143], a[4:7]
    ds_read_b128 a[204:207], v210 offset:36864
    buffer_store_dword v227, v226, s[16:19], s3 offen
    v_mfma_f32_16x16x32_bf16 a[44:47], a[236:239], a[144:147], a[44:47]
    ds_read_b64_tr_b16 a[252:253], v215 offset:61440
    ds_read_b64_tr_b16 a[254:255], v215 offset:61952
    v_mfma_f32_16x16x32_bf16 a[84:87], a[236:239], a[148:151], a[84:87]
    ds_read_b64_tr_b16 a[184:185], v216 offset:53248
    ds_read_b64_tr_b16 a[186:187], v216 offset:53760
    s_waitcnt lgkmcnt(9)
    v_mfma_f32_16x16x32_bf16 v[8:11], a[240:243], a[120:123], v[8:11]
    ds_read_b64_tr_b16 a[188:189], v216 offset:61440
    ds_read_b64_tr_b16 a[190:191], v216 offset:61952
    v_mfma_f32_16x16x32_bf16 v[48:51], a[240:243], a[124:127], v[48:51]
    ds_read_b128 a[208:211], v210 offset:37888
    v_mfma_f32_16x16x32_bf16 v[88:91], a[240:243], a[128:131], v[88:91]
    ds_read_b128 a[212:215], v210 offset:38912
    v_mfma_f32_16x16x32_bf16 v[128:131], a[240:243], a[132:135], v[128:131]
    ds_read_b128 a[216:219], v210 offset:39936
    v_mfma_f32_16x16x32_bf16 v[168:171], a[240:243], a[136:139], v[168:171]
    ds_read_b128 a[220:223], v210 offset:40960
    v_mfma_f32_16x16x32_bf16 a[8:11], a[240:243], a[140:143], a[8:11]
    ds_read_b128 a[224:227], v210 offset:41984
    v_mfma_f32_16x16x32_bf16 a[48:51], a[240:243], a[144:147], a[48:51]
    ds_read_b128 a[228:231], v210 offset:43008
    v_mfma_f32_16x16x32_bf16 a[88:91], a[240:243], a[148:151], a[88:91]
    ds_read_b128 a[232:235], v210 offset:44032
    s_waitcnt lgkmcnt(15)
    v_mfma_f32_16x16x32_bf16 v[12:15], a[244:247], a[120:123], v[12:15]
    v_mfma_f32_16x16x32_bf16 v[52:55], a[244:247], a[124:127], v[52:55]
    v_mfma_f32_16x16x32_bf16 v[92:95], a[244:247], a[128:131], v[92:95]
    v_mfma_f32_16x16x32_bf16 v[132:135], a[244:247], a[132:135], v[132:135]
    v_mfma_f32_16x16x32_bf16 v[172:175], a[244:247], a[136:139], v[172:175]
    v_mfma_f32_16x16x32_bf16 a[12:15], a[244:247], a[140:143], a[12:15]
    v_mfma_f32_16x16x32_bf16 a[52:55], a[244:247], a[144:147], a[52:55]
    v_mfma_f32_16x16x32_bf16 a[92:95], a[244:247], a[148:151], a[92:95]
    s_waitcnt lgkmcnt(13)
    v_mfma_f32_16x16x32_bf16 v[0:3], a[248:251], a[204:207], v[0:3]
    s_waitcnt lgkmcnt(11)
    v_mfma_f32_16x16x32_bf16 v[4:7], a[252:255], a[204:207], v[4:7]
    s_waitcnt lgkmcnt(9)
    v_mfma_f32_16x16x32_bf16 v[8:11], a[184:187], a[204:207], v[8:11]
    s_waitcnt lgkmcnt(7)
    v_mfma_f32_16x16x32_bf16 v[12:15], a[188:191], a[204:207], v[12:15]
    s_waitcnt lgkmcnt(6)
    v_mfma_f32_16x16x32_bf16 v[40:43], a[248:251], a[208:211], v[40:43]
    v_mfma_f32_16x16x32_bf16 v[44:47], a[252:255], a[208:211], v[44:47]
    s_add_u32 s47, s61, 0
    s_cmp_lt_u32 s47, 32
    s_cselect_b32 s76, 0x3e8293ee, 1.0
    s_mov_b32 s77, s76
    s_lshl_b32 s74, s47, 17
    s_lshl_b32 s47, s58, 10
    s_add_u32 s74, s74, s47
    s_add_u32 s74, s74, 4194304
    v_pk_mul_f32 v[0:1], v[0:1], s[76:77]
    v_mfma_f32_16x16x32_bf16 v[48:51], a[184:187], a[208:211], v[48:51]
    v_pk_mul_f32 v[2:3], v[2:3], s[76:77]
    v_cvt_pk_bf16_f32 v234, v0, v1
    v_cvt_pk_bf16_f32 v235, v2, v3
    v_mfma_f32_16x16x32_bf16 v[52:55], a[188:191], a[208:211], v[52:55]
    v_pk_mul_f32 v[8:9], v[8:9], s[76:77]
    v_pk_mul_f32 v[10:11], v[10:11], s[76:77]
    v_cvt_pk_bf16_f32 v236, v8, v9
    s_waitcnt lgkmcnt(5)
    v_mfma_f32_16x16x32_bf16 v[80:83], a[248:251], a[212:215], v[80:83]
    v_cvt_pk_bf16_f32 v237, v10, v11
    buffer_store_dwordx4 v[234:237], v223, s[16:19], s74 offen offset:0
    v_mfma_f32_16x16x32_bf16 v[84:87], a[252:255], a[212:215], v[84:87]
    v_pk_mul_f32 v[40:41], v[40:41], s[76:77]
    v_pk_mul_f32 v[42:43], v[42:43], s[76:77]
    v_cvt_pk_bf16_f32 v238, v40, v41
    v_mfma_f32_16x16x32_bf16 v[88:91], a[184:187], a[212:215], v[88:91]
    v_cvt_pk_bf16_f32 v239, v42, v43
    v_pk_mul_f32 v[48:49], v[48:49], s[76:77]
    v_pk_mul_f32 v[50:51], v[50:51], s[76:77]
    v_mfma_f32_16x16x32_bf16 v[92:95], a[188:191], a[212:215], v[92:95]
    v_cvt_pk_bf16_f32 v240, v48, v49
    v_cvt_pk_bf16_f32 v241, v50, v51
    buffer_store_dwordx4 v[238:241], v223, s[16:19], s74 offen offset:1024
    s_waitcnt lgkmcnt(4)
    v_mfma_f32_16x16x32_bf16 v[120:123], a[248:251], a[216:219], v[120:123]
    ds_read_b64_tr_b16 a[192:193], v213 offset:53248
    ds_read_b64_tr_b16 a[194:195], v213 offset:53760
    v_mfma_f32_16x16x32_bf16 v[124:127], a[252:255], a[216:219], v[124:127]
    v_pk_mul_f32 v[80:81], v[80:81], s[76:77]
    v_pk_mul_f32 v[82:83], v[82:83], s[76:77]
    v_cvt_pk_bf16_f32 v234, v80, v81
    v_mfma_f32_16x16x32_bf16 v[128:131], a[184:187], a[216:219], v[128:131]
    v_cvt_pk_bf16_f32 v235, v82, v83
    v_pk_mul_f32 v[88:89], v[88:89], s[76:77]
    v_pk_mul_f32 v[90:91], v[90:91], s[76:77]
    v_mfma_f32_16x16x32_bf16 v[132:135], a[188:191], a[216:219], v[132:135]
    v_cvt_pk_bf16_f32 v236, v88, v89
    v_cvt_pk_bf16_f32 v237, v90, v91
    buffer_store_dwordx4 v[234:237], v223, s[16:19], s74 offen offset:2048
    s_waitcnt lgkmcnt(5)
    v_mfma_f32_16x16x32_bf16 v[160:163], a[248:251], a[220:223], v[160:163]
    v_mfma_f32_16x16x32_bf16 v[164:167], a[252:255], a[220:223], v[164:167]
    v_pk_mul_f32 v[120:121], v[120:121], s[76:77]
    v_pk_mul_f32 v[122:123], v[122:123], s[76:77]
    v_cvt_pk_bf16_f32 v238, v120, v121
    v_mfma_f32_16x16x32_bf16 v[168:171], a[184:187], a[220:223], v[168:171]
    v_cvt_pk_bf16_f32 v239, v122, v123
    v_pk_mul_f32 v[128:129], v[128:129], s[76:77]
    v_pk_mul_f32 v[130:131], v[130:131], s[76:77]
    v_mfma_f32_16x16x32_bf16 v[172:175], a[188:191], a[220:223], v[172:175]
    v_cvt_pk_bf16_f32 v240, v128, v129
    v_cvt_pk_bf16_f32 v241, v130, v131
    buffer_store_dwordx4 v[238:241], v223, s[16:19], s74 offen offset:3072
    s_waitcnt lgkmcnt(4)
    v_mfma_f32_16x16x32_bf16 a[0:3], a[248:251], a[224:227], a[0:3]
    ds_read_b64_tr_b16 a[196:197], v213 offset:61440
    ds_read_b64_tr_b16 a[198:199], v213 offset:61952
    s_add_u32 s74, s74, 4096
    v_mfma_f32_16x16x32_bf16 a[4:7], a[252:255], a[224:227], a[4:7]
    v_pk_mul_f32 v[160:161], v[160:161], s[76:77]
    v_pk_mul_f32 v[162:163], v[162:163], s[76:77]
    v_cvt_pk_bf16_f32 v234, v160, v161
    v_mfma_f32_16x16x32_bf16 a[8:11], a[184:187], a[224:227], a[8:11]
    v_cvt_pk_bf16_f32 v235, v162, v163
    v_pk_mul_f32 v[168:169], v[168:169], s[76:77]
    v_pk_mul_f32 v[170:171], v[170:171], s[76:77]
    v_mfma_f32_16x16x32_bf16 a[12:15], a[188:191], a[224:227], a[12:15]
    v_cvt_pk_bf16_f32 v236, v168, v169
    v_cvt_pk_bf16_f32 v237, v170, v171
    buffer_store_dwordx4 v[234:237], v223, s[16:19], s74 offen offset:0
    s_waitcnt lgkmcnt(5)
    v_mfma_f32_16x16x32_bf16 a[40:43], a[248:251], a[228:231], a[40:43]
    v_mfma_f32_16x16x32_bf16 a[44:47], a[252:255], a[228:231], a[44:47]
    v_accvgpr_read_b32 v226, a0
    v_accvgpr_read_b32 v227, a1
    v_accvgpr_read_b32 v228, a2
    v_mfma_f32_16x16x32_bf16 a[48:51], a[184:187], a[228:231], a[48:51]
    v_accvgpr_read_b32 v229, a3
    v_pk_mul_f32 v[226:227], v[226:227], s[76:77]
    v_pk_mul_f32 v[228:229], v[228:229], s[76:77]
    v_mfma_f32_16x16x32_bf16 a[52:55], a[188:191], a[228:231], a[52:55]
    v_cvt_pk_bf16_f32 v238, v226, v227
    v_cvt_pk_bf16_f32 v239, v228, v229
    v_accvgpr_read_b32 v230, a8
    s_waitcnt lgkmcnt(4)
    v_mfma_f32_16x16x32_bf16 a[80:83], a[248:251], a[232:235], a[80:83]
    ds_read_b64_tr_b16 a[200:201], v214 offset:53248
    ds_read_b64_tr_b16 a[202:203], v214 offset:53760
    v_accvgpr_read_b32 v231, a9
    v_accvgpr_read_b32 v232, a10
    v_accvgpr_read_b32 v233, a11
    v_mfma_f32_16x16x32_bf16 a[84:87], a[252:255], a[232:235], a[84:87]
    v_pk_mul_f32 v[230:231], v[230:231], s[76:77]
    v_pk_mul_f32 v[232:233], v[232:233], s[76:77]
    v_cvt_pk_bf16_f32 v240, v230, v231
    v_mfma_f32_16x16x32_bf16 a[88:91], a[184:187], a[232:235], a[88:91]
    v_cvt_pk_bf16_f32 v241, v232, v233
    buffer_store_dwordx4 v[238:241], v223, s[16:19], s74 offen offset:1024
    v_accvgpr_read_b32 v226, a40
    v_mfma_f32_16x16x32_bf16 a[92:95], a[188:191], a[232:235], a[92:95]
    v_accvgpr_read_b32 v227, a41
    v_accvgpr_read_b32 v228, a42
    v_accvgpr_read_b32 v229, a43
    s_waitcnt lgkmcnt(4)
    v_mfma_f32_16x16x32_bf16 v[16:19], a[192:195], a[152:155], v[16:19]
    v_pk_mul_f32 v[226:227], v[226:227], s[76:77]
    v_pk_mul_f32 v[228:229], v[228:229], s[76:77]
    v_cvt_pk_bf16_f32 v234, v226, v227
    v_mfma_f32_16x16x32_bf16 v[56:59], a[192:195], a[156:159], v[56:59]
    v_cvt_pk_bf16_f32 v235, v228, v229
    v_accvgpr_read_b32 v230, a48
    v_accvgpr_read_b32 v231, a49
    v_mfma_f32_16x16x32_bf16 v[96:99], a[192:195], a[160:163], v[96:99]
    v_accvgpr_read_b32 v232, a50
    v_accvgpr_read_b32 v233, a51
    v_pk_mul_f32 v[230:231], v[230:231], s[76:77]
    v_mfma_f32_16x16x32_bf16 v[136:139], a[192:195], a[164:167], v[136:139]
    v_pk_mul_f32 v[232:233], v[232:233], s[76:77]
    v_cvt_pk_bf16_f32 v236, v230, v231
    v_cvt_pk_bf16_f32 v237, v232, v233
    v_mfma_f32_16x16x32_bf16 v[176:179], a[192:195], a[168:171], v[176:179]
    ds_read_b64_tr_b16 a[236:237], v214 offset:61440
    ds_read_b64_tr_b16 a[238:239], v214 offset:61952
    buffer_store_dwordx4 v[234:237], v223, s[16:19], s74 offen offset:2048
    v_accvgpr_read_b32 v226, a80
    v_accvgpr_read_b32 v227, a81
    v_mfma_f32_16x16x32_bf16 a[16:19], a[192:195], a[172:175], a[16:19]
    v_accvgpr_read_b32 v228, a82
    v_accvgpr_read_b32 v229, a83
    v_pk_mul_f32 v[226:227], v[226:227], s[76:77]
    v_mfma_f32_16x16x32_bf16 a[56:59], a[192:195], a[176:179], a[56:59]
    v_pk_mul_f32 v[228:229], v[228:229], s[76:77]
    v_cvt_pk_bf16_f32 v238, v226, v227
    v_cvt_pk_bf16_f32 v239, v228, v229
    v_mfma_f32_16x16x32_bf16 a[96:99], a[192:195], a[180:183], a[96:99]
    v_accvgpr_read_b32 v230, a88
    v_accvgpr_read_b32 v231, a89
    v_accvgpr_read_b32 v232, a90
    s_waitcnt lgkmcnt(4)
    v_mfma_f32_16x16x32_bf16 v[20:23], a[196:199], a[152:155], v[20:23]
    v_accvgpr_read_b32 v233, a91
    v_pk_mul_f32 v[230:231], v[230:231], s[76:77]
    v_pk_mul_f32 v[232:233], v[232:233], s[76:77]
    v_mfma_f32_16x16x32_bf16 v[60:63], a[196:199], a[156:159], v[60:63]
    v_cvt_pk_bf16_f32 v240, v230, v231
    v_cvt_pk_bf16_f32 v241, v232, v233
    buffer_store_dwordx4 v[238:241], v223, s[16:19], s74 offen offset:3072
    v_mfma_f32_16x16x32_bf16 v[100:103], a[196:199], a[160:163], v[100:103]
    s_add_u32 s47, s62, 0
    s_cmp_lt_u32 s47, 32
    s_cselect_b32 s76, 0x3e8293ee, 1.0
    s_mov_b32 s77, s76
    s_lshl_b32 s74, s47, 17
    s_lshl_b32 s47, s58, 10
    s_add_u32 s74, s74, s47
    s_add_u32 s74, s74, 4194304
    v_pk_mul_f32 v[4:5], v[4:5], s[76:77]
    v_mfma_f32_16x16x32_bf16 v[140:143], a[196:199], a[164:167], v[140:143]
    v_pk_mul_f32 v[6:7], v[6:7], s[76:77]
    v_cvt_pk_bf16_f32 v234, v4, v5
    v_cvt_pk_bf16_f32 v235, v6, v7
    v_mfma_f32_16x16x32_bf16 v[180:183], a[196:199], a[168:171], v[180:183]
    ds_read_b64_tr_b16 a[240:241], v217 offset:16384
    ds_read_b64_tr_b16 a[242:243], v217 offset:16896
    v_pk_mul_f32 v[12:13], v[12:13], s[76:77]
    v_pk_mul_f32 v[14:15], v[14:15], s[76:77]
    v_cvt_pk_bf16_f32 v236, v12, v13
    v_mfma_f32_16x16x32_bf16 a[20:23], a[196:199], a[172:175], a[20:23]
    v_cvt_pk_bf16_f32 v237, v14, v15
    buffer_store_dwordx4 v[234:237], v223, s[16:19], s74 offen offset:0
    v_pk_mul_f32 v[44:45], v[44:45], s[76:77]
    v_mfma_f32_16x16x32_bf16 a[60:63], a[196:199], a[176:179], a[60:63]
    v_pk_mul_f32 v[46:47], v[46:47], s[76:77]
    v_cvt_pk_bf16_f32 v238, v44, v45
    v_cvt_pk_bf16_f32 v239, v46, v47
    v_mfma_f32_16x16x32_bf16 a[100:103], a[196:199], a[180:183], a[100:103]
    v_pk_mul_f32 v[52:53], v[52:53], s[76:77]
    v_pk_mul_f32 v[54:55], v[54:55], s[76:77]
    v_cvt_pk_bf16_f32 v240, v52, v53
    s_waitcnt lgkmcnt(4)
    v_mfma_f32_16x16x32_bf16 v[24:27], a[200:203], a[152:155], v[24:27]
    v_cvt_pk_bf16_f32 v241, v54, v55
    buffer_store_dwordx4 v[238:241], v223, s[16:19], s74 offen offset:1024
    v_pk_mul_f32 v[84:85], v[84:85], s[76:77]
    v_mfma_f32_16x16x32_bf16 v[64:67], a[200:203], a[156:159], v[64:67]
    v_pk_mul_f32 v[86:87], v[86:87], s[76:77]
    v_cvt_pk_bf16_f32 v234, v84, v85
    v_cvt_pk_bf16_f32 v235, v86, v87
    v_mfma_f32_16x16x32_bf16 v[104:107], a[200:203], a[160:163], v[104:107]
    v_pk_mul_f32 v[92:93], v[92:93], s[76:77]
    v_pk_mul_f32 v[94:95], v[94:95], s[76:77]
    v_cvt_pk_bf16_f32 v236, v92, v93
    v_mfma_f32_16x16x32_bf16 v[144:147], a[200:203], a[164:167], v[144:147]
    v_cvt_pk_bf16_f32 v237, v94, v95
    buffer_store_dwordx4 v[234:237], v223, s[16:19], s74 offen offset:2048
    v_pk_mul_f32 v[124:125], v[124:125], s[76:77]
    v_mfma_f32_16x16x32_bf16 v[184:187], a[200:203], a[168:171], v[184:187]
    ds_read_b64_tr_b16 a[244:245], v217 offset:24576
    ds_read_b64_tr_b16 a[246:247], v217 offset:25088
    v_pk_mul_f32 v[126:127], v[126:127], s[76:77]
    v_cvt_pk_bf16_f32 v238, v124, v125
    v_cvt_pk_bf16_f32 v239, v126, v127
    v_mfma_f32_16x16x32_bf16 a[24:27], a[200:203], a[172:175], a[24:27]
    v_pk_mul_f32 v[132:133], v[132:133], s[76:77]
    v_pk_mul_f32 v[134:135], v[134:135], s[76:77]
    v_cvt_pk_bf16_f32 v240, v132, v133
    v_mfma_f32_16x16x32_bf16 a[64:67], a[200:203], a[176:179], a[64:67]
    v_cvt_pk_bf16_f32 v241, v134, v135
    buffer_store_dwordx4 v[238:241], v223, s[16:19], s74 offen offset:3072
    s_add_u32 s74, s74, 4096
    v_pk_mul_f32 v[164:165], v[164:165], s[76:77]
    v_mfma_f32_16x16x32_bf16 a[104:107], a[200:203], a[180:183], a[104:107]
    v_pk_mul_f32 v[166:167], v[166:167], s[76:77]
    v_cvt_pk_bf16_f32 v234, v164, v165
    v_cvt_pk_bf16_f32 v235, v166, v167
    s_waitcnt lgkmcnt(4)
    v_mfma_f32_16x16x32_bf16 v[28:31], a[236:239], a[152:155], v[28:31]
    v_pk_mul_f32 v[172:173], v[172:173], s[76:77]
    v_pk_mul_f32 v[174:175], v[174:175], s[76:77]
    v_cvt_pk_bf16_f32 v236, v172, v173
    v_mfma_f32_16x16x32_bf16 v[68:71], a[236:239], a[156:159], v[68:71]
    v_cvt_pk_bf16_f32 v237, v174, v175
    buffer_store_dwordx4 v[234:237], v223, s[16:19], s74 offen offset:0
    v_accvgpr_read_b32 v226, a4
    v_mfma_f32_16x16x32_bf16 v[108:111], a[236:239], a[160:163], v[108:111]
    v_accvgpr_read_b32 v227, a5
    v_accvgpr_read_b32 v228, a6
    v_accvgpr_read_b32 v229, a7
    v_mfma_f32_16x16x32_bf16 v[148:151], a[236:239], a[164:167], v[148:151]
    v_pk_mul_f32 v[226:227], v[226:227], s[76:77]
    v_pk_mul_f32 v[228:229], v[228:229], s[76:77]
    v_cvt_pk_bf16_f32 v238, v226, v227
    v_mfma_f32_16x16x32_bf16 v[188:191], a[236:239], a[168:171], v[188:191]
    ds_read_b64_tr_b16 a[248:249], v218 offset:16384
    ds_read_b64_tr_b16 a[250:251], v218 offset:16896
    v_cvt_pk_bf16_f32 v239, v228, v229
    v_accvgpr_read_b32 v230, a12
    v_accvgpr_read_b32 v231, a13
    v_mfma_f32_16x16x32_bf16 a[28:31], a[236:239], a[172:175], a[28:31]
    v_accvgpr_read_b32 v232, a14
    v_accvgpr_read_b32 v233, a15
    v_pk_mul_f32 v[230:231], v[230:231], s[76:77]
    v_mfma_f32_16x16x32_bf16 a[68:71], a[236:239], a[176:179], a[68:71]
    v_pk_mul_f32 v[232:233], v[232:233], s[76:77]
    v_cvt_pk_bf16_f32 v240, v230, v231
    v_cvt_pk_bf16_f32 v241, v232, v233
    v_mfma_f32_16x16x32_bf16 a[108:111], a[236:239], a[180:183], a[108:111]
    buffer_store_dwordx4 v[238:241], v223, s[16:19], s74 offen offset:1024
    v_accvgpr_read_b32 v226, a44
    v_accvgpr_read_b32 v227, a45
    s_waitcnt lgkmcnt(4)
    v_mfma_f32_16x16x32_bf16 v[16:19], a[240:243], a[120:123], v[16:19]
    v_accvgpr_read_b32 v228, a46
    v_accvgpr_read_b32 v229, a47
    v_pk_mul_f32 v[226:227], v[226:227], s[76:77]
    v_mfma_f32_16x16x32_bf16 v[56:59], a[240:243], a[124:127], v[56:59]
    v_pk_mul_f32 v[228:229], v[228:229], s[76:77]
    v_cvt_pk_bf16_f32 v234, v226, v227
    v_cvt_pk_bf16_f32 v235, v228, v229
    v_mfma_f32_16x16x32_bf16 v[96:99], a[240:243], a[128:131], v[96:99]
    v_accvgpr_read_b32 v230, a52
    v_accvgpr_read_b32 v231, a53
    v_accvgpr_read_b32 v232, a54
    v_mfma_f32_16x16x32_bf16 v[136:139], a[240:243], a[132:135], v[136:139]
    v_accvgpr_read_b32 v233, a55
    v_pk_mul_f32 v[230:231], v[230:231], s[76:77]
    v_pk_mul_f32 v[232:233], v[232:233], s[76:77]
    v_mfma_f32_16x16x32_bf16 v[176:179], a[240:243], a[136:139], v[176:179]
    ds_read_b64_tr_b16 a[252:253], v218 offset:24576
    ds_read_b64_tr_b16 a[254:255], v218 offset:25088
    v_cvt_pk_bf16_f32 v236, v230, v231
    v_cvt_pk_bf16_f32 v237, v232, v233
    buffer_store_dwordx4 v[234:237], v223, s[16:19], s74 offen offset:2048
    v_mfma_f32_16x16x32_bf16 a[16:19], a[240:243], a[140:143], a[16:19]
    v_accvgpr_read_b32 v226, a84
    v_accvgpr_read_b32 v227, a85
    v_accvgpr_read_b32 v228, a86
    v_mfma_f32_16x16x32_bf16 a[56:59], a[240:243], a[144:147], a[56:59]
    v_accvgpr_read_b32 v229, a87
    v_pk_mul_f32 v[226:227], v[226:227], s[76:77]
    v_pk_mul_f32 v[228:229], v[228:229], s[76:77]
    v_mfma_f32_16x16x32_bf16 a[96:99], a[240:243], a[148:151], a[96:99]
    v_cvt_pk_bf16_f32 v238, v226, v227
    v_cvt_pk_bf16_f32 v239, v228, v229
    v_accvgpr_read_b32 v230, a92
    s_waitcnt lgkmcnt(4)
    v_mfma_f32_16x16x32_bf16 v[20:23], a[244:247], a[120:123], v[20:23]
    v_accvgpr_read_b32 v231, a93
    v_accvgpr_read_b32 v232, a94
    v_accvgpr_read_b32 v233, a95
    v_mfma_f32_16x16x32_bf16 v[60:63], a[244:247], a[124:127], v[60:63]
    v_pk_mul_f32 v[230:231], v[230:231], s[76:77]
    v_pk_mul_f32 v[232:233], v[232:233], s[76:77]
    v_cvt_pk_bf16_f32 v240, v230, v231
    v_mfma_f32_16x16x32_bf16 v[100:103], a[244:247], a[128:131], v[100:103]
    v_cvt_pk_bf16_f32 v241, v232, v233
    buffer_store_dwordx4 v[238:241], v223, s[16:19], s74 offen offset:3072
    v_mfma_f32_16x16x32_bf16 v[140:143], a[244:247], a[132:135], v[140:143]
    v_mfma_f32_16x16x32_bf16 v[180:183], a[244:247], a[136:139], v[180:183]
    ds_read_b64_tr_b16 a[184:185], v217 offset:53248
    ds_read_b64_tr_b16 a[186:187], v217 offset:53760
    v_mfma_f32_16x16x32_bf16 a[20:23], a[244:247], a[140:143], a[20:23]
    ds_read_b64_tr_b16 a[188:189], v217 offset:61440
    ds_read_b64_tr_b16 a[190:191], v217 offset:61952
    v_mfma_f32_16x16x32_bf16 a[60:63], a[244:247], a[144:147], a[60:63]
    ds_read_b64_tr_b16 a[192:193], v218 offset:53248
    ds_read_b64_tr_b16 a[194:195], v218 offset:53760
    v_mfma_f32_16x16x32_bf16 a[100:103], a[244:247], a[148:151], a[100:103]
    ds_read_b64_tr_b16 a[196:197], v218 offset:61440
    ds_read_b64_tr_b16 a[198:199], v218 offset:61952
    s_waitcnt lgkmcnt(10)
    v_mfma_f32_16x16x32_bf16 v[24:27], a[248:251], a[120:123], v[24:27]
    v_mfma_f32_16x16x32_bf16 v[64:67], a[248:251], a[124:127], v[64:67]
    v_mfma_f32_16x16x32_bf16 v[104:107], a[248:251], a[128:131], v[104:107]
    v_mfma_f32_16x16x32_bf16 v[144:147], a[248:251], a[132:135], v[144:147]
    v_mfma_f32_16x16x32_bf16 v[184:187], a[248:251], a[136:139], v[184:187]
    v_mfma_f32_16x16x32_bf16 a[24:27], a[248:251], a[140:143], a[24:27]
    v_mfma_f32_16x16x32_bf16 a[64:67], a[248:251], a[144:147], a[64:67]
    v_mfma_f32_16x16x32_bf16 a[104:107], a[248:251], a[148:151], a[104:107]
    s_waitcnt lgkmcnt(8)
    v_mfma_f32_16x16x32_bf16 v[28:31], a[252:255], a[120:123], v[28:31]
    v_mfma_f32_16x16x32_bf16 v[68:71], a[252:255], a[124:127], v[68:71]
    v_mfma_f32_16x16x32_bf16 v[108:111], a[252:255], a[128:131], v[108:111]
    v_mfma_f32_16x16x32_bf16 v[148:151], a[252:255], a[132:135], v[148:151]
    v_mfma_f32_16x16x32_bf16 v[188:191], a[252:255], a[136:139], v[188:191]
    v_mfma_f32_16x16x32_bf16 a[28:31], a[252:255], a[140:143], a[28:31]
    v_mfma_f32_16x16x32_bf16 a[68:71], a[252:255], a[144:147], a[68:71]
    v_mfma_f32_16x16x32_bf16 a[108:111], a[252:255], a[148:151], a[108:111]
    s_waitcnt lgkmcnt(6)
    v_mfma_f32_16x16x32_bf16 v[16:19], a[184:187], a[204:207], v[16:19]
    s_waitcnt lgkmcnt(4)
    v_mfma_f32_16x16x32_bf16 v[20:23], a[188:191], a[204:207], v[20:23]
    s_waitcnt lgkmcnt(2)
    v_mfma_f32_16x16x32_bf16 v[24:27], a[192:195], a[204:207], v[24:27]
    s_waitcnt lgkmcnt(0)
    v_mfma_f32_16x16x32_bf16 v[28:31], a[196:199], a[204:207], v[28:31]
    v_mfma_f32_16x16x32_bf16 v[56:59], a[184:187], a[208:211], v[56:59]
    v_mfma_f32_16x16x32_bf16 v[60:63], a[188:191], a[208:211], v[60:63]
    s_add_u32 s47, s61, 1
    s_cmp_lt_u32 s47, 32
    s_cselect_b32 s76, 0x3e8293ee, 1.0
    s_mov_b32 s77, s76
    s_lshl_b32 s74, s47, 17
    s_lshl_b32 s47, s58, 10
    s_add_u32 s74, s74, s47
    s_add_u32 s74, s74, 4194304
    v_pk_mul_f32 v[16:17], v[16:17], s[76:77]
    v_mfma_f32_16x16x32_bf16 v[64:67], a[192:195], a[208:211], v[64:67]
    v_pk_mul_f32 v[18:19], v[18:19], s[76:77]
    v_cvt_pk_bf16_f32 v234, v16, v17
    v_cvt_pk_bf16_f32 v235, v18, v19
    v_mfma_f32_16x16x32_bf16 v[68:71], a[196:199], a[208:211], v[68:71]
    v_pk_mul_f32 v[24:25], v[24:25], s[76:77]
    v_pk_mul_f32 v[26:27], v[26:27], s[76:77]
    v_cvt_pk_bf16_f32 v236, v24, v25
    v_mfma_f32_16x16x32_bf16 v[96:99], a[184:187], a[212:215], v[96:99]
    v_cvt_pk_bf16_f32 v237, v26, v27
    buffer_store_dwordx4 v[234:237], v223, s[16:19], s74 offen offset:0
    v_mfma_f32_16x16x32_bf16 v[100:103], a[188:191], a[212:215], v[100:103]
    v_pk_mul_f32 v[56:57], v[56:57], s[76:77]
    v_pk_mul_f32 v[58:59], v[58:59], s[76:77]
    v_cvt_pk_bf16_f32 v238, v56, v57
    v_mfma_f32_16x16x32_bf16 v[104:107], a[192:195], a[212:215], v[104:107]
    v_cvt_pk_bf16_f32 v239, v58, v59
    v_pk_mul_f32 v[64:65], v[64:65], s[76:77]
    v_pk_mul_f32 v[66:67], v[66:67], s[76:77]
    v_mfma_f32_16x16x32_bf16 v[108:111], a[196:199], a[212:215], v[108:111]
    v_cvt_pk_bf16_f32 v240, v64, v65
    v_cvt_pk_bf16_f32 v241, v66, v67
    buffer_store_dwordx4 v[238:241], v223, s[16:19], s74 offen offset:1024
    v_mfma_f32_16x16x32_bf16 v[136:139], a[184:187], a[216:219], v[136:139]
    ds_read_b64_tr_b16 a[200:201], v219 offset:36864
    ds_read_b64_tr_b16 a[202:203], v219 offset:37120
    v_mfma_f32_16x16x32_bf16 v[140:143], a[188:191], a[216:219], v[140:143]
    v_pk_mul_f32 v[96:97], v[96:97], s[76:77]
    v_pk_mul_f32 v[98:99], v[98:99], s[76:77]
    v_cvt_pk_bf16_f32 v234, v96, v97
    v_mfma_f32_16x16x32_bf16 v[144:147], a[192:195], a[216:219], v[144:147]
    v_cvt_pk_bf16_f32 v235, v98, v99
    v_pk_mul_f32 v[104:105], v[104:105], s[76:77]
    v_pk_mul_f32 v[106:107], v[106:107], s[76:77]
    v_mfma_f32_16x16x32_bf16 v[148:151], a[196:199], a[216:219], v[148:151]
    v_cvt_pk_bf16_f32 v236, v104, v105
    v_cvt_pk_bf16_f32 v237, v106, v107
    buffer_store_dwordx4 v[234:237], v223, s[16:19], s74 offen offset:2048
    v_mfma_f32_16x16x32_bf16 v[176:179], a[184:187], a[220:223], v[176:179]
    v_mfma_f32_16x16x32_bf16 v[180:183], a[188:191], a[220:223], v[180:183]
    v_pk_mul_f32 v[136:137], v[136:137], s[76:77]
    v_pk_mul_f32 v[138:139], v[138:139], s[76:77]
    v_cvt_pk_bf16_f32 v238, v136, v137
    v_mfma_f32_16x16x32_bf16 v[184:187], a[192:195], a[220:223], v[184:187]
    v_cvt_pk_bf16_f32 v239, v138, v139
    v_pk_mul_f32 v[144:145], v[144:145], s[76:77]
    v_pk_mul_f32 v[146:147], v[146:147], s[76:77]
    v_mfma_f32_16x16x32_bf16 v[188:191], a[196:199], a[220:223], v[188:191]
    v_cvt_pk_bf16_f32 v240, v144, v145
    v_cvt_pk_bf16_f32 v241, v146, v147
    buffer_store_dwordx4 v[238:241], v223, s[16:19], s74 offen offset:3072
    v_mfma_f32_16x16x32_bf16 a[16:19], a[184:187], a[224:227], a[16:19]
    ds_read_b64_tr_b16 a[236:237], v219 offset:38912
    ds_read_b64_tr_b16 a[238:239], v219 offset:39168
    s_add_u32 s74, s74, 4096
    v_mfma_f32_16x16x32_bf16 a[20:23], a[188:191], a[224:227], a[20:23]
    v_pk_mul_f32 v[176:177], v[176:177], s[76:77]
    v_pk_mul_f32 v[178:179], v[178:179], s[76:77]
    v_cvt_pk_bf16_f32 v234, v176, v177
    v_mfma_f32_16x16x32_bf16 a[24:27], a[192:195], a[224:227], a[24:27]
    v_cvt_pk_bf16_f32 v235, v178, v179
    v_pk_mul_f32 v[184:185], v[184:185], s[76:77]
    v_pk_mul_f32 v[186:187], v[186:187], s[76:77]
    v_mfma_f32_16x16x32_bf16 a[28:31], a[196:199], a[224:227], a[28:31]
    v_cvt_pk_bf16_f32 v236, v184, v185
    v_cvt_pk_bf16_f32 v237, v186, v187
    buffer_store_dwordx4 v[234:237], v223, s[16:19], s74 offen offset:0
    v_mfma_f32_16x16x32_bf16 a[56:59], a[184:187], a[228:231], a[56:59]
    v_mfma_f32_16x16x32_bf16 a[60:63], a[188:191], a[228:231], a[60:63]
    v_accvgpr_read_b32 v226, a16
    v_accvgpr_read_b32 v227, a17
    v_accvgpr_read_b32 v228, a18
    v_mfma_f32_16x16x32_bf16 a[64:67], a[192:195], a[228:231], a[64:67]
    v_accvgpr_read_b32 v229, a19
    v_pk_mul_f32 v[226:227], v[226:227], s[76:77]
    v_pk_mul_f32 v[228:229], v[228:229], s[76:77]
    v_mfma_f32_16x16x32_bf16 a[68:71], a[196:199], a[228:231], a[68:71]
    v_cvt_pk_bf16_f32 v238, v226, v227
    v_cvt_pk_bf16_f32 v239, v228, v229
    v_accvgpr_read_b32 v230, a24
    v_mfma_f32_16x16x32_bf16 a[96:99], a[184:187], a[232:235], a[96:99]
    ds_read_b64_tr_b16 a[240:241], v220 offset:0
    ds_read_b64_tr_b16 a[242:243], v220 offset:256
    v_accvgpr_read_b32 v231, a25
    v_accvgpr_read_b32 v232, a26
    v_accvgpr_read_b32 v233, a27
    v_mfma_f32_16x16x32_bf16 a[100:103], a[188:191], a[232:235], a[100:103]
    v_pk_mul_f32 v[230:231], v[230:231], s[76:77]
    v_pk_mul_f32 v[232:233], v[232:233], s[76:77]
    v_cvt_pk_bf16_f32 v240, v230, v231
    v_mfma_f32_16x16x32_bf16 a[104:107], a[192:195], a[232:235], a[104:107]
    v_cvt_pk_bf16_f32 v241, v232, v233
    buffer_store_dwordx4 v[238:241], v223, s[16:19], s74 offen offset:1024
    v_accvgpr_read_b32 v226, a56
    v_mfma_f32_16x16x32_bf16 a[108:111], a[196:199], a[232:235], a[108:111]
    v_accvgpr_read_b32 v227, a57
    v_accvgpr_read_b32 v228, a58
    v_accvgpr_read_b32 v229, a59
    s_waitcnt lgkmcnt(4)
    v_mfma_f32_16x16x32_bf16 v[32:35], a[200:203], a[152:155], v[32:35]
    v_pk_mul_f32 v[226:227], v[226:227], s[76:77]
    v_pk_mul_f32 v[228:229], v[228:229], s[76:77]
    v_cvt_pk_bf16_f32 v234, v226, v227
    v_mfma_f32_16x16x32_bf16 v[72:75], a[200:203], a[156:159], v[72:75]
    v_cvt_pk_bf16_f32 v235, v228, v229
    v_accvgpr_read_b32 v230, a64
    v_accvgpr_read_b32 v231, a65
    v_mfma_f32_16x16x32_bf16 v[112:115], a[200:203], a[160:163], v[112:115]
    v_accvgpr_read_b32 v232, a66
    v_accvgpr_read_b32 v233, a67
    v_pk_mul_f32 v[230:231], v[230:231], s[76:77]
    v_mfma_f32_16x16x32_bf16 v[152:155], a[200:203], a[164:167], v[152:155]
    v_pk_mul_f32 v[232:233], v[232:233], s[76:77]
    v_cvt_pk_bf16_f32 v236, v230, v231
    v_cvt_pk_bf16_f32 v237, v232, v233
    v_mfma_f32_16x16x32_bf16 v[192:195], a[200:203], a[168:171], v[192:195]
    ds_read_b64_tr_b16 a[244:245], v220 offset:2048
    ds_read_b64_tr_b16 a[246:247], v220 offset:2304
    buffer_store_dwordx4 v[234:237], v223, s[16:19], s74 offen offset:2048
    v_accvgpr_read_b32 v226, a96
    v_accvgpr_read_b32 v227, a97
    v_mfma_f32_16x16x32_bf16 a[32:35], a[200:203], a[172:175], a[32:35]
    v_accvgpr_read_b32 v228, a98
    v_accvgpr_read_b32 v229, a99
    v_pk_mul_f32 v[226:227], v[226:227], s[76:77]
    v_mfma_f32_16x16x32_bf16 a[72:75], a[200:203], a[176:179], a[72:75]
    v_pk_mul_f32 v[228:229], v[228:229], s[76:77]
    v_cvt_pk_bf16_f32 v238, v226, v227
    v_cvt_pk_bf16_f32 v239, v228, v229
    v_mfma_f32_16x16x32_bf16 a[112:115], a[200:203], a[180:183], a[112:115]
    v_accvgpr_read_b32 v230, a104
    v_accvgpr_read_b32 v231, a105
    v_accvgpr_read_b32 v232, a106
    s_waitcnt lgkmcnt(4)
    v_mfma_f32_16x16x32_bf16 v[36:39], a[236:239], a[152:155], v[36:39]
    v_accvgpr_read_b32 v233, a107
    v_pk_mul_f32 v[230:231], v[230:231], s[76:77]
    v_pk_mul_f32 v[232:233], v[232:233], s[76:77]
    v_mfma_f32_16x16x32_bf16 v[76:79], a[236:239], a[156:159], v[76:79]
    v_cvt_pk_bf16_f32 v240, v230, v231
    v_cvt_pk_bf16_f32 v241, v232, v233
    buffer_store_dwordx4 v[238:241], v223, s[16:19], s74 offen offset:3072
    v_mfma_f32_16x16x32_bf16 v[116:119], a[236:239], a[160:163], v[116:119]
    s_add_u32 s47, s62, 1
    s_cmp_lt_u32 s47, 32
    s_cselect_b32 s76, 0x3e8293ee, 1.0
    s_mov_b32 s77, s76
    s_lshl_b32 s74, s47, 17
    s_lshl_b32 s47, s58, 10
    s_add_u32 s74, s74, s47
    s_add_u32 s74, s74, 4194304
    v_pk_mul_f32 v[20:21], v[20:21], s[76:77]
    v_mfma_f32_16x16x32_bf16 v[156:159], a[236:239], a[164:167], v[156:159]
    v_pk_mul_f32 v[22:23], v[22:23], s[76:77]
    v_cvt_pk_bf16_f32 v234, v20, v21
    v_cvt_pk_bf16_f32 v235, v22, v23
    v_mfma_f32_16x16x32_bf16 v[196:199], a[236:239], a[168:171], v[196:199]
    ds_read_b64_tr_b16 a[248:249], v220 offset:36864
    ds_read_b64_tr_b16 a[250:251], v220 offset:37120
    v_pk_mul_f32 v[28:29], v[28:29], s[76:77]
    v_pk_mul_f32 v[30:31], v[30:31], s[76:77]
    v_cvt_pk_bf16_f32 v236, v28, v29
    v_mfma_f32_16x16x32_bf16 a[36:39], a[236:239], a[172:175], a[36:39]
    ds_read_b64_tr_b16 a[252:253], v220 offset:38912
    ds_read_b64_tr_b16 a[254:255], v220 offset:39168
    v_cvt_pk_bf16_f32 v237, v30, v31
    buffer_store_dwordx4 v[234:237], v223, s[16:19], s74 offen offset:0
    v_pk_mul_f32 v[60:61], v[60:61], s[76:77]
    v_mfma_f32_16x16x32_bf16 a[76:79], a[236:239], a[176:179], a[76:79]
    v_pk_mul_f32 v[62:63], v[62:63], s[76:77]
    v_cvt_pk_bf16_f32 v238, v60, v61
    v_cvt_pk_bf16_f32 v239, v62, v63
    v_mfma_f32_16x16x32_bf16 a[116:119], a[236:239], a[180:183], a[116:119]
    v_pk_mul_f32 v[68:69], v[68:69], s[76:77]
    v_pk_mul_f32 v[70:71], v[70:71], s[76:77]
    v_cvt_pk_bf16_f32 v240, v68, v69
    s_waitcnt lgkmcnt(6)
    v_mfma_f32_16x16x32_bf16 v[32:35], a[240:243], a[120:123], v[32:35]
    v_cvt_pk_bf16_f32 v241, v70, v71
    buffer_store_dwordx4 v[238:241], v223, s[16:19], s74 offen offset:1024
    v_pk_mul_f32 v[100:101], v[100:101], s[76:77]
    v_mfma_f32_16x16x32_bf16 v[72:75], a[240:243], a[124:127], v[72:75]
    v_pk_mul_f32 v[102:103], v[102:103], s[76:77]
    v_cvt_pk_bf16_f32 v234, v100, v101
    v_cvt_pk_bf16_f32 v235, v102, v103
    v_mfma_f32_16x16x32_bf16 v[112:115], a[240:243], a[128:131], v[112:115]
    v_pk_mul_f32 v[108:109], v[108:109], s[76:77]
    v_pk_mul_f32 v[110:111], v[110:111], s[76:77]
    v_cvt_pk_bf16_f32 v236, v108, v109
    v_mfma_f32_16x16x32_bf16 v[152:155], a[240:243], a[132:135], v[152:155]
    v_cvt_pk_bf16_f32 v237, v110, v111
    buffer_store_dwordx4 v[234:237], v223, s[16:19], s74 offen offset:2048
    v_pk_mul_f32 v[140:141], v[140:141], s[76:77]
    v_mfma_f32_16x16x32_bf16 v[192:195], a[240:243], a[136:139], v[192:195]
    v_pk_mul_f32 v[142:143], v[142:143], s[76:77]
    v_cvt_pk_bf16_f32 v238, v140, v141
    v_cvt_pk_bf16_f32 v239, v142, v143
    v_mfma_f32_16x16x32_bf16 a[32:35], a[240:243], a[140:143], a[32:35]
    v_pk_mul_f32 v[148:149], v[148:149], s[76:77]
    v_pk_mul_f32 v[150:151], v[150:151], s[76:77]
    v_cvt_pk_bf16_f32 v240, v148, v149
    v_mfma_f32_16x16x32_bf16 a[72:75], a[240:243], a[144:147], a[72:75]
    v_cvt_pk_bf16_f32 v241, v150, v151
    buffer_store_dwordx4 v[238:241], v223, s[16:19], s74 offen offset:3072
    s_add_u32 s74, s74, 4096
    v_pk_mul_f32 v[180:181], v[180:181], s[76:77]
    v_mfma_f32_16x16x32_bf16 a[112:115], a[240:243], a[148:151], a[112:115]
    v_pk_mul_f32 v[182:183], v[182:183], s[76:77]
    v_cvt_pk_bf16_f32 v234, v180, v181
    v_cvt_pk_bf16_f32 v235, v182, v183
    s_waitcnt lgkmcnt(4)
    v_mfma_f32_16x16x32_bf16 v[36:39], a[244:247], a[120:123], v[36:39]
    v_pk_mul_f32 v[188:189], v[188:189], s[76:77]
    v_pk_mul_f32 v[190:191], v[190:191], s[76:77]
    v_cvt_pk_bf16_f32 v236, v188, v189
    v_mfma_f32_16x16x32_bf16 v[76:79], a[244:247], a[124:127], v[76:79]
    v_cvt_pk_bf16_f32 v237, v190, v191
    buffer_store_dwordx4 v[234:237], v223, s[16:19], s74 offen offset:0
    v_accvgpr_read_b32 v226, a20
    v_mfma_f32_16x16x32_bf16 v[116:119], a[244:247], a[128:131], v[116:119]
    v_accvgpr_read_b32 v227, a21
    v_accvgpr_read_b32 v228, a22
    v_accvgpr_read_b32 v229, a23
    v_mfma_f32_16x16x32_bf16 v[156:159], a[244:247], a[132:135], v[156:159]
    v_pk_mul_f32 v[226:227], v[226:227], s[76:77]
    v_pk_mul_f32 v[228:229], v[228:229], s[76:77]
    v_cvt_pk_bf16_f32 v238, v226, v227
    v_mfma_f32_16x16x32_bf16 v[196:199], a[244:247], a[136:139], v[196:199]
    v_cvt_pk_bf16_f32 v239, v228, v229
    v_accvgpr_read_b32 v230, a28
    v_accvgpr_read_b32 v231, a29
    v_mfma_f32_16x16x32_bf16 a[36:39], a[244:247], a[140:143], a[36:39]
    v_accvgpr_read_b32 v232, a30
    v_accvgpr_read_b32 v233, a31
    v_pk_mul_f32 v[230:231], v[230:231], s[76:77]
    v_mfma_f32_16x16x32_bf16 a[76:79], a[244:247], a[144:147], a[76:79]
    v_pk_mul_f32 v[232:233], v[232:233], s[76:77]
    v_cvt_pk_bf16_f32 v240, v230, v231
    v_cvt_pk_bf16_f32 v241, v232, v233
    v_mfma_f32_16x16x32_bf16 a[116:119], a[244:247], a[148:151], a[116:119]
    buffer_store_dwordx4 v[238:241], v223, s[16:19], s74 offen offset:1024
    v_accvgpr_read_b32 v226, a60
    v_accvgpr_read_b32 v227, a61
    s_waitcnt lgkmcnt(2)
    v_mfma_f32_16x16x32_bf16 v[32:35], a[248:251], a[204:207], v[32:35]
    v_accvgpr_read_b32 v228, a62
    v_accvgpr_read_b32 v229, a63
    v_pk_mul_f32 v[226:227], v[226:227], s[76:77]
    s_waitcnt lgkmcnt(0)
    v_mfma_f32_16x16x32_bf16 v[36:39], a[252:255], a[204:207], v[36:39]
    v_pk_mul_f32 v[228:229], v[228:229], s[76:77]
    v_cvt_pk_bf16_f32 v234, v226, v227
    v_cvt_pk_bf16_f32 v235, v228, v229
    v_mfma_f32_16x16x32_bf16 v[72:75], a[248:251], a[208:211], v[72:75]
    v_accvgpr_read_b32 v230, a68
    v_accvgpr_read_b32 v231, a69
    v_accvgpr_read_b32 v232, a70
    v_mfma_f32_16x16x32_bf16 v[76:79], a[252:255], a[208:211], v[76:79]
    v_accvgpr_read_b32 v233, a71
    v_pk_mul_f32 v[230:231], v[230:231], s[76:77]
    v_pk_mul_f32 v[232:233], v[232:233], s[76:77]
    v_mfma_f32_16x16x32_bf16 v[112:115], a[248:251], a[212:215], v[112:115]
    v_cvt_pk_bf16_f32 v236, v230, v231
    v_cvt_pk_bf16_f32 v237, v232, v233
    buffer_store_dwordx4 v[234:237], v223, s[16:19], s74 offen offset:2048
    v_mfma_f32_16x16x32_bf16 v[116:119], a[252:255], a[212:215], v[116:119]
    v_accvgpr_read_b32 v226, a100
    v_accvgpr_read_b32 v227, a101
    v_accvgpr_read_b32 v228, a102
    v_mfma_f32_16x16x32_bf16 v[152:155], a[248:251], a[216:219], v[152:155]
    v_accvgpr_read_b32 v229, a103
    v_pk_mul_f32 v[226:227], v[226:227], s[76:77]
    v_pk_mul_f32 v[228:229], v[228:229], s[76:77]
    v_mfma_f32_16x16x32_bf16 v[156:159], a[252:255], a[216:219], v[156:159]
    v_cvt_pk_bf16_f32 v238, v226, v227
    v_cvt_pk_bf16_f32 v239, v228, v229
    v_accvgpr_read_b32 v230, a108
    v_mfma_f32_16x16x32_bf16 v[192:195], a[248:251], a[220:223], v[192:195]
    v_accvgpr_read_b32 v231, a109
    v_accvgpr_read_b32 v232, a110
    v_accvgpr_read_b32 v233, a111
    v_mfma_f32_16x16x32_bf16 v[196:199], a[252:255], a[220:223], v[196:199]
    v_pk_mul_f32 v[230:231], v[230:231], s[76:77]
    v_pk_mul_f32 v[232:233], v[232:233], s[76:77]
    v_cvt_pk_bf16_f32 v240, v230, v231
    v_mfma_f32_16x16x32_bf16 a[32:35], a[248:251], a[224:227], a[32:35]
    v_cvt_pk_bf16_f32 v241, v232, v233
    buffer_store_dwordx4 v[238:241], v223, s[16:19], s74 offen offset:3072
    v_mfma_f32_16x16x32_bf16 a[36:39], a[252:255], a[224:227], a[36:39]
    v_mfma_f32_16x16x32_bf16 a[72:75], a[248:251], a[228:231], a[72:75]
    v_mfma_f32_16x16x32_bf16 a[76:79], a[252:255], a[228:231], a[76:79]
    v_mfma_f32_16x16x32_bf16 a[112:115], a[248:251], a[232:235], a[112:115]
    v_mfma_f32_16x16x32_bf16 a[116:119], a[252:255], a[232:235], a[116:119]
    s_nop 7
    s_branch g1_kernel_c
g1_kernel_gu_ab:
    v_mfma_f32_16x16x32_bf16 v[0:3], a[184:187], a[152:155], v[0:3]
    v_mfma_f32_16x16x32_bf16 v[40:43], a[184:187], a[156:159], v[40:43]
    v_mfma_f32_16x16x32_bf16 v[80:83], a[184:187], a[160:163], v[80:83]
    ds_read_b128 a[120:123], v210 offset:0
    v_mfma_f32_16x16x32_bf16 v[120:123], a[184:187], a[164:167], v[120:123]
    v_mfma_f32_16x16x32_bf16 v[160:163], a[184:187], a[168:171], v[160:163]
    ds_read_b128 a[124:127], v210 offset:1024
    ds_read_b64_tr_b16 a[196:197], v212 offset:61440
    ds_read_b64_tr_b16 a[198:199], v212 offset:61952
    v_mfma_f32_16x16x32_bf16 a[0:3], a[184:187], a[172:175], a[0:3]
    v_mfma_f32_16x16x32_bf16 a[40:43], a[184:187], a[176:179], a[40:43]
    ds_read_b128 a[128:131], v210 offset:2048
    v_mfma_f32_16x16x32_bf16 a[80:83], a[184:187], a[180:183], a[80:83]
    v_mfma_f32_16x16x32_bf16 v[4:7], a[188:191], a[152:155], v[4:7]
    ds_read_b128 a[132:135], v210 offset:3072
    v_mfma_f32_16x16x32_bf16 v[44:47], a[188:191], a[156:159], v[44:47]
    v_mfma_f32_16x16x32_bf16 v[84:87], a[188:191], a[160:163], v[84:87]
    ds_read_b128 a[136:139], v210 offset:4096
    v_mfma_f32_16x16x32_bf16 v[124:127], a[188:191], a[164:167], v[124:127]
    v_mfma_f32_16x16x32_bf16 v[164:167], a[188:191], a[168:171], v[164:167]
    ds_read_b128 a[140:143], v210 offset:5120
    ds_read_b64_tr_b16 a[200:201], v215 offset:16384
    ds_read_b64_tr_b16 a[202:203], v215 offset:16896
    v_mfma_f32_16x16x32_bf16 a[4:7], a[188:191], a[172:175], a[4:7]
    v_mfma_f32_16x16x32_bf16 a[44:47], a[188:191], a[176:179], a[44:47]
    ds_read_b128 a[144:147], v210 offset:6144
    v_mfma_f32_16x16x32_bf16 a[84:87], a[188:191], a[180:183], a[84:87]
    v_mfma_f32_16x16x32_bf16 v[8:11], a[192:195], a[152:155], v[8:11]
    ds_read_b128 a[148:151], v210 offset:7168
    v_mfma_f32_16x16x32_bf16 v[48:51], a[192:195], a[156:159], v[48:51]
    v_mfma_f32_16x16x32_bf16 v[88:91], a[192:195], a[160:163], v[88:91]
    v_mfma_f32_16x16x32_bf16 v[128:131], a[192:195], a[164:167], v[128:131]
    v_mfma_f32_16x16x32_bf16 v[168:171], a[192:195], a[168:171], v[168:171]
    ds_read_b64_tr_b16 a[236:237], v215 offset:24576
    ds_read_b64_tr_b16 a[238:239], v215 offset:25088
    v_mfma_f32_16x16x32_bf16 a[8:11], a[192:195], a[172:175], a[8:11]
    v_mfma_f32_16x16x32_bf16 a[48:51], a[192:195], a[176:179], a[48:51]
    v_mfma_f32_16x16x32_bf16 a[88:91], a[192:195], a[180:183], a[88:91]
    s_waitcnt lgkmcnt(10)
    v_mfma_f32_16x16x32_bf16 v[12:15], a[196:199], a[152:155], v[12:15]
    v_mfma_f32_16x16x32_bf16 v[52:55], a[196:199], a[156:159], v[52:55]
    v_mfma_f32_16x16x32_bf16 v[92:95], a[196:199], a[160:163], v[92:95]
    v_mfma_f32_16x16x32_bf16 v[132:135], a[196:199], a[164:167], v[132:135]
    v_mfma_f32_16x16x32_bf16 v[172:175], a[196:199], a[168:171], v[172:175]
    ds_read_b64_tr_b16 a[240:241], v216 offset:16384
    ds_read_b64_tr_b16 a[242:243], v216 offset:16896
    v_mfma_f32_16x16x32_bf16 a[12:15], a[196:199], a[172:175], a[12:15]
    v_mfma_f32_16x16x32_bf16 a[52:55], a[196:199], a[176:179], a[52:55]
    v_mfma_f32_16x16x32_bf16 a[92:95], a[196:199], a[180:183], a[92:95]
    s_waitcnt lgkmcnt(6)
    v_mfma_f32_16x16x32_bf16 v[0:3], a[200:203], a[120:123], v[0:3]
    v_mfma_f32_16x16x32_bf16 v[40:43], a[200:203], a[124:127], v[40:43]
    v_mfma_f32_16x16x32_bf16 v[80:83], a[200:203], a[128:131], v[80:83]
    v_mfma_f32_16x16x32_bf16 v[120:123], a[200:203], a[132:135], v[120:123]
    v_mfma_f32_16x16x32_bf16 v[160:163], a[200:203], a[136:139], v[160:163]
    ds_read_b64_tr_b16 a[244:245], v216 offset:24576
    ds_read_b64_tr_b16 a[246:247], v216 offset:25088
    v_mfma_f32_16x16x32_bf16 a[0:3], a[200:203], a[140:143], a[0:3]
    s_waitcnt lgkmcnt(7)
    v_mfma_f32_16x16x32_bf16 a[40:43], a[200:203], a[144:147], a[40:43]
    s_waitcnt lgkmcnt(6)
    v_mfma_f32_16x16x32_bf16 a[80:83], a[200:203], a[148:151], a[80:83]
    s_waitcnt lgkmcnt(4)
    v_mfma_f32_16x16x32_bf16 v[4:7], a[236:239], a[120:123], v[4:7]
    v_mfma_f32_16x16x32_bf16 v[44:47], a[236:239], a[124:127], v[44:47]
    v_mfma_f32_16x16x32_bf16 v[84:87], a[236:239], a[128:131], v[84:87]
    v_mfma_f32_16x16x32_bf16 v[124:127], a[236:239], a[132:135], v[124:127]
    v_mfma_f32_16x16x32_bf16 v[164:167], a[236:239], a[136:139], v[164:167]
    s_waitcnt vmcnt(0)
    s_barrier
    ds_read_b64_tr_b16 a[248:249], v215 offset:53248
    ds_read_b64_tr_b16 a[250:251], v215 offset:53760
    v_lshrrev_b32 v226, 2, v223
    v_mov_b32 v227, 0
    s_lshl_b32 s3, s2, 10
    s_lshl_b32 s47, s20, 8
    s_add_u32 s3, s3, s47
    s_add_u32 s3, s3, 62914560
    v_mfma_f32_16x16x32_bf16 a[4:7], a[236:239], a[140:143], a[4:7]
    ds_read_b128 a[204:207], v210 offset:36864
    buffer_store_dword v227, v226, s[16:19], s3 offen
    v_mfma_f32_16x16x32_bf16 a[44:47], a[236:239], a[144:147], a[44:47]
    ds_read_b64_tr_b16 a[252:253], v215 offset:61440
    ds_read_b64_tr_b16 a[254:255], v215 offset:61952
    v_mfma_f32_16x16x32_bf16 a[84:87], a[236:239], a[148:151], a[84:87]
    ds_read_b64_tr_b16 a[184:185], v216 offset:53248
    ds_read_b64_tr_b16 a[186:187], v216 offset:53760
    s_waitcnt lgkmcnt(9)
    v_mfma_f32_16x16x32_bf16 v[8:11], a[240:243], a[120:123], v[8:11]
    ds_read_b64_tr_b16 a[188:189], v216 offset:61440
    ds_read_b64_tr_b16 a[190:191], v216 offset:61952
    v_mfma_f32_16x16x32_bf16 v[48:51], a[240:243], a[124:127], v[48:51]
    ds_read_b128 a[208:211], v210 offset:37888
    v_mfma_f32_16x16x32_bf16 v[88:91], a[240:243], a[128:131], v[88:91]
    ds_read_b128 a[212:215], v210 offset:38912
    v_mfma_f32_16x16x32_bf16 v[128:131], a[240:243], a[132:135], v[128:131]
    ds_read_b128 a[216:219], v210 offset:39936
    v_mfma_f32_16x16x32_bf16 v[168:171], a[240:243], a[136:139], v[168:171]
    ds_read_b128 a[220:223], v210 offset:40960
    v_mfma_f32_16x16x32_bf16 a[8:11], a[240:243], a[140:143], a[8:11]
    ds_read_b128 a[224:227], v210 offset:41984
    v_mfma_f32_16x16x32_bf16 a[48:51], a[240:243], a[144:147], a[48:51]
    ds_read_b128 a[228:231], v210 offset:43008
    v_mfma_f32_16x16x32_bf16 a[88:91], a[240:243], a[148:151], a[88:91]
    ds_read_b128 a[232:235], v210 offset:44032
    s_waitcnt lgkmcnt(15)
    v_mfma_f32_16x16x32_bf16 v[12:15], a[244:247], a[120:123], v[12:15]
    v_mfma_f32_16x16x32_bf16 v[52:55], a[244:247], a[124:127], v[52:55]
    v_mfma_f32_16x16x32_bf16 v[92:95], a[244:247], a[128:131], v[92:95]
    v_mfma_f32_16x16x32_bf16 v[132:135], a[244:247], a[132:135], v[132:135]
    v_mfma_f32_16x16x32_bf16 v[172:175], a[244:247], a[136:139], v[172:175]
    v_mfma_f32_16x16x32_bf16 a[12:15], a[244:247], a[140:143], a[12:15]
    v_mfma_f32_16x16x32_bf16 a[52:55], a[244:247], a[144:147], a[52:55]
    v_mfma_f32_16x16x32_bf16 a[92:95], a[244:247], a[148:151], a[92:95]
    s_waitcnt lgkmcnt(13)
    v_mfma_f32_16x16x32_bf16 v[0:3], a[248:251], a[204:207], v[0:3]
    s_waitcnt lgkmcnt(11)
    v_mfma_f32_16x16x32_bf16 v[4:7], a[252:255], a[204:207], v[4:7]
    s_waitcnt lgkmcnt(9)
    v_mfma_f32_16x16x32_bf16 v[8:11], a[184:187], a[204:207], v[8:11]
    s_waitcnt lgkmcnt(7)
    v_mfma_f32_16x16x32_bf16 v[12:15], a[188:191], a[204:207], v[12:15]
    s_waitcnt lgkmcnt(6)
    v_mfma_f32_16x16x32_bf16 v[40:43], a[248:251], a[208:211], v[40:43]
    v_mfma_f32_16x16x32_bf16 v[44:47], a[252:255], a[208:211], v[44:47]
    s_add_u32 s47, s61, 32
    s_lshl_b32 s74, s47, 10
    s_mul_i32 s47, s58, 147456
    s_add_u32 s74, s74, s47
    s_add_u32 s74, s74, 16777216
    v_pk_mul_f32 v[234:235], v[0:1], s[70:71]
    v_pk_mul_f32 v[236:237], v[2:3], s[70:71]
    v_mfma_f32_16x16x32_bf16 v[48:51], a[184:187], a[208:211], v[48:51]
    v_exp_f32 v234, v234
    v_exp_f32 v235, v235
    v_mfma_f32_16x16x32_bf16 v[52:55], a[188:191], a[208:211], v[52:55]
    v_exp_f32 v236, v236
    v_exp_f32 v237, v237
    s_waitcnt lgkmcnt(5)
    v_mfma_f32_16x16x32_bf16 v[80:83], a[248:251], a[212:215], v[80:83]
    v_pk_mul_f32 v[0:1], v[0:1], v[4:5]
    v_pk_mul_f32 v[2:3], v[2:3], v[6:7]
    v_pk_add_f32 v[234:235], v[234:235], s[78:79]
    v_mfma_f32_16x16x32_bf16 v[84:87], a[252:255], a[212:215], v[84:87]
    v_pk_add_f32 v[236:237], v[236:237], s[78:79]
    v_rcp_f32 v234, v234
    v_mfma_f32_16x16x32_bf16 v[88:91], a[184:187], a[212:215], v[88:91]
    v_rcp_f32 v235, v235
    v_rcp_f32 v236, v236
    v_mfma_f32_16x16x32_bf16 v[92:95], a[188:191], a[212:215], v[92:95]
    v_rcp_f32 v237, v237
    v_pk_mul_f32 v[0:1], v[0:1], v[234:235]
    s_waitcnt lgkmcnt(4)
    v_mfma_f32_16x16x32_bf16 v[120:123], a[248:251], a[216:219], v[120:123]
    ds_read_b64_tr_b16 a[192:193], v213 offset:53248
    ds_read_b64_tr_b16 a[194:195], v213 offset:53760
    v_pk_mul_f32 v[2:3], v[2:3], v[236:237]
    v_cvt_pk_bf16_f32 v242, v0, v1
    v_cvt_pk_bf16_f32 v243, v2, v3
    v_mfma_f32_16x16x32_bf16 v[124:127], a[252:255], a[216:219], v[124:127]
    v_pk_mul_f32 v[238:239], v[8:9], s[70:71]
    v_pk_mul_f32 v[240:241], v[10:11], s[70:71]
    v_exp_f32 v238, v238
    v_mfma_f32_16x16x32_bf16 v[128:131], a[184:187], a[216:219], v[128:131]
    v_exp_f32 v239, v239
    v_exp_f32 v240, v240
    v_mfma_f32_16x16x32_bf16 v[132:135], a[188:191], a[216:219], v[132:135]
    v_exp_f32 v241, v241
    v_pk_mul_f32 v[8:9], v[8:9], v[12:13]
    s_waitcnt lgkmcnt(5)
    v_mfma_f32_16x16x32_bf16 v[160:163], a[248:251], a[220:223], v[160:163]
    v_pk_mul_f32 v[10:11], v[10:11], v[14:15]
    v_pk_add_f32 v[238:239], v[238:239], s[78:79]
    v_pk_add_f32 v[240:241], v[240:241], s[78:79]
    v_mfma_f32_16x16x32_bf16 v[164:167], a[252:255], a[220:223], v[164:167]
    v_rcp_f32 v238, v238
    v_rcp_f32 v239, v239
    v_mfma_f32_16x16x32_bf16 v[168:171], a[184:187], a[220:223], v[168:171]
    v_rcp_f32 v240, v240
    v_rcp_f32 v241, v241
    v_mfma_f32_16x16x32_bf16 v[172:175], a[188:191], a[220:223], v[172:175]
    v_pk_mul_f32 v[8:9], v[8:9], v[238:239]
    v_pk_mul_f32 v[10:11], v[10:11], v[240:241]
    v_cvt_pk_bf16_f32 v244, v8, v9
    s_waitcnt lgkmcnt(4)
    v_mfma_f32_16x16x32_bf16 a[0:3], a[248:251], a[224:227], a[0:3]
    ds_read_b64_tr_b16 a[196:197], v213 offset:61440
    ds_read_b64_tr_b16 a[198:199], v213 offset:61952
    v_cvt_pk_bf16_f32 v245, v10, v11
    buffer_store_dwordx4 v[242:245], v223, s[16:19], s74 offen
    s_add_u32 s74, s74, 147456
    v_pk_mul_f32 v[234:235], v[40:41], s[70:71]
    v_mfma_f32_16x16x32_bf16 a[4:7], a[252:255], a[224:227], a[4:7]
    v_pk_mul_f32 v[236:237], v[42:43], s[70:71]
    v_exp_f32 v234, v234
    v_mfma_f32_16x16x32_bf16 a[8:11], a[184:187], a[224:227], a[8:11]
    v_exp_f32 v235, v235
    v_exp_f32 v236, v236
    v_mfma_f32_16x16x32_bf16 a[12:15], a[188:191], a[224:227], a[12:15]
    v_exp_f32 v237, v237
    v_pk_mul_f32 v[40:41], v[40:41], v[44:45]
    s_waitcnt lgkmcnt(5)
    v_mfma_f32_16x16x32_bf16 a[40:43], a[248:251], a[228:231], a[40:43]
    v_pk_mul_f32 v[42:43], v[42:43], v[46:47]
    v_pk_add_f32 v[234:235], v[234:235], s[78:79]
    v_pk_add_f32 v[236:237], v[236:237], s[78:79]
    v_mfma_f32_16x16x32_bf16 a[44:47], a[252:255], a[228:231], a[44:47]
    v_rcp_f32 v234, v234
    v_rcp_f32 v235, v235
    v_mfma_f32_16x16x32_bf16 a[48:51], a[184:187], a[228:231], a[48:51]
    v_rcp_f32 v236, v236
    v_rcp_f32 v237, v237
    v_mfma_f32_16x16x32_bf16 a[52:55], a[188:191], a[228:231], a[52:55]
    v_pk_mul_f32 v[40:41], v[40:41], v[234:235]
    v_pk_mul_f32 v[42:43], v[42:43], v[236:237]
    v_cvt_pk_bf16_f32 v246, v40, v41
    s_waitcnt lgkmcnt(4)
    v_mfma_f32_16x16x32_bf16 a[80:83], a[248:251], a[232:235], a[80:83]
    ds_read_b64_tr_b16 a[200:201], v214 offset:53248
    ds_read_b64_tr_b16 a[202:203], v214 offset:53760
    v_cvt_pk_bf16_f32 v247, v42, v43
    v_pk_mul_f32 v[238:239], v[48:49], s[70:71]
    v_pk_mul_f32 v[240:241], v[50:51], s[70:71]
    v_mfma_f32_16x16x32_bf16 a[84:87], a[252:255], a[232:235], a[84:87]
    v_exp_f32 v238, v238
    v_exp_f32 v239, v239
    v_mfma_f32_16x16x32_bf16 a[88:91], a[184:187], a[232:235], a[88:91]
    v_exp_f32 v240, v240
    v_exp_f32 v241, v241
    v_mfma_f32_16x16x32_bf16 a[92:95], a[188:191], a[232:235], a[92:95]
    v_pk_mul_f32 v[48:49], v[48:49], v[52:53]
    v_pk_mul_f32 v[50:51], v[50:51], v[54:55]
    v_pk_add_f32 v[238:239], v[238:239], s[78:79]
    s_waitcnt lgkmcnt(4)
    v_mfma_f32_16x16x32_bf16 v[16:19], a[192:195], a[152:155], v[16:19]
    v_pk_add_f32 v[240:241], v[240:241], s[78:79]
    v_rcp_f32 v238, v238
    v_mfma_f32_16x16x32_bf16 v[56:59], a[192:195], a[156:159], v[56:59]
    v_rcp_f32 v239, v239
    v_rcp_f32 v240, v240
    v_mfma_f32_16x16x32_bf16 v[96:99], a[192:195], a[160:163], v[96:99]
    v_rcp_f32 v241, v241
    v_pk_mul_f32 v[48:49], v[48:49], v[238:239]
    v_mfma_f32_16x16x32_bf16 v[136:139], a[192:195], a[164:167], v[136:139]
    v_pk_mul_f32 v[50:51], v[50:51], v[240:241]
    v_cvt_pk_bf16_f32 v248, v48, v49
    v_cvt_pk_bf16_f32 v249, v50, v51
    v_mfma_f32_16x16x32_bf16 v[176:179], a[192:195], a[168:171], v[176:179]
    ds_read_b64_tr_b16 a[236:237], v214 offset:61440
    ds_read_b64_tr_b16 a[238:239], v214 offset:61952
    buffer_store_dwordx4 v[246:249], v223, s[16:19], s74 offen
    s_add_u32 s74, s74, 147456
    v_pk_mul_f32 v[234:235], v[80:81], s[70:71]
    v_pk_mul_f32 v[236:237], v[82:83], s[70:71]
    v_mfma_f32_16x16x32_bf16 a[16:19], a[192:195], a[172:175], a[16:19]
    v_exp_f32 v234, v234
    v_exp_f32 v235, v235
    v_mfma_f32_16x16x32_bf16 a[56:59], a[192:195], a[176:179], a[56:59]
    v_exp_f32 v236, v236
    v_exp_f32 v237, v237
    v_mfma_f32_16x16x32_bf16 a[96:99], a[192:195], a[180:183], a[96:99]
    v_pk_mul_f32 v[80:81], v[80:81], v[84:85]
    v_pk_mul_f32 v[82:83], v[82:83], v[86:87]
    v_pk_add_f32 v[234:235], v[234:235], s[78:79]
    s_waitcnt lgkmcnt(4)
    v_mfma_f32_16x16x32_bf16 v[20:23], a[196:199], a[152:155], v[20:23]
    v_pk_add_f32 v[236:237], v[236:237], s[78:79]
    v_rcp_f32 v234, v234
    v_mfma_f32_16x16x32_bf16 v[60:63], a[196:199], a[156:159], v[60:63]
    v_rcp_f32 v235, v235
    v_rcp_f32 v236, v236
    v_mfma_f32_16x16x32_bf16 v[100:103], a[196:199], a[160:163], v[100:103]
    v_rcp_f32 v237, v237
    v_pk_mul_f32 v[80:81], v[80:81], v[234:235]
    v_mfma_f32_16x16x32_bf16 v[140:143], a[196:199], a[164:167], v[140:143]
    v_pk_mul_f32 v[82:83], v[82:83], v[236:237]
    v_cvt_pk_bf16_f32 v242, v80, v81
    v_cvt_pk_bf16_f32 v243, v82, v83
    v_mfma_f32_16x16x32_bf16 v[180:183], a[196:199], a[168:171], v[180:183]
    ds_read_b64_tr_b16 a[240:241], v217 offset:16384
    ds_read_b64_tr_b16 a[242:243], v217 offset:16896
    v_pk_mul_f32 v[238:239], v[88:89], s[70:71]
    v_pk_mul_f32 v[240:241], v[90:91], s[70:71]
    v_exp_f32 v238, v238
    v_mfma_f32_16x16x32_bf16 a[20:23], a[196:199], a[172:175], a[20:23]
    v_exp_f32 v239, v239
    v_exp_f32 v240, v240
    v_mfma_f32_16x16x32_bf16 a[60:63], a[196:199], a[176:179], a[60:63]
    v_exp_f32 v241, v241
    v_pk_mul_f32 v[88:89], v[88:89], v[92:93]
    v_mfma_f32_16x16x32_bf16 a[100:103], a[196:199], a[180:183], a[100:103]
    v_pk_mul_f32 v[90:91], v[90:91], v[94:95]
    v_pk_add_f32 v[238:239], v[238:239], s[78:79]
    v_pk_add_f32 v[240:241], v[240:241], s[78:79]
    s_waitcnt lgkmcnt(4)
    v_mfma_f32_16x16x32_bf16 v[24:27], a[200:203], a[152:155], v[24:27]
    v_rcp_f32 v238, v238
    v_rcp_f32 v239, v239
    v_mfma_f32_16x16x32_bf16 v[64:67], a[200:203], a[156:159], v[64:67]
    v_rcp_f32 v240, v240
    v_rcp_f32 v241, v241
    v_mfma_f32_16x16x32_bf16 v[104:107], a[200:203], a[160:163], v[104:107]
    v_pk_mul_f32 v[88:89], v[88:89], v[238:239]
    v_pk_mul_f32 v[90:91], v[90:91], v[240:241]
    v_cvt_pk_bf16_f32 v244, v88, v89
    v_mfma_f32_16x16x32_bf16 v[144:147], a[200:203], a[164:167], v[144:147]
    v_cvt_pk_bf16_f32 v245, v90, v91
    buffer_store_dwordx4 v[242:245], v223, s[16:19], s74 offen
    s_add_u32 s74, s74, 147456
    v_pk_mul_f32 v[234:235], v[120:121], s[70:71]
    v_mfma_f32_16x16x32_bf16 v[184:187], a[200:203], a[168:171], v[184:187]
    ds_read_b64_tr_b16 a[244:245], v217 offset:24576
    ds_read_b64_tr_b16 a[246:247], v217 offset:25088
    v_pk_mul_f32 v[236:237], v[122:123], s[70:71]
    v_exp_f32 v234, v234
    v_mfma_f32_16x16x32_bf16 a[24:27], a[200:203], a[172:175], a[24:27]
    v_exp_f32 v235, v235
    v_exp_f32 v236, v236
    v_mfma_f32_16x16x32_bf16 a[64:67], a[200:203], a[176:179], a[64:67]
    v_exp_f32 v237, v237
    v_pk_mul_f32 v[120:121], v[120:121], v[124:125]
    v_mfma_f32_16x16x32_bf16 a[104:107], a[200:203], a[180:183], a[104:107]
    v_pk_mul_f32 v[122:123], v[122:123], v[126:127]
    v_pk_add_f32 v[234:235], v[234:235], s[78:79]
    v_pk_add_f32 v[236:237], v[236:237], s[78:79]
    s_waitcnt lgkmcnt(4)
    v_mfma_f32_16x16x32_bf16 v[28:31], a[236:239], a[152:155], v[28:31]
    v_rcp_f32 v234, v234
    v_rcp_f32 v235, v235
    v_mfma_f32_16x16x32_bf16 v[68:71], a[236:239], a[156:159], v[68:71]
    v_rcp_f32 v236, v236
    v_rcp_f32 v237, v237
    v_mfma_f32_16x16x32_bf16 v[108:111], a[236:239], a[160:163], v[108:111]
    v_pk_mul_f32 v[120:121], v[120:121], v[234:235]
    v_pk_mul_f32 v[122:123], v[122:123], v[236:237]
    v_cvt_pk_bf16_f32 v246, v120, v121
    v_mfma_f32_16x16x32_bf16 v[148:151], a[236:239], a[164:167], v[148:151]
    v_cvt_pk_bf16_f32 v247, v122, v123
    v_pk_mul_f32 v[238:239], v[128:129], s[70:71]
    v_pk_mul_f32 v[240:241], v[130:131], s[70:71]
    v_mfma_f32_16x16x32_bf16 v[188:191], a[236:239], a[168:171], v[188:191]
    ds_read_b64_tr_b16 a[248:249], v218 offset:16384
    ds_read_b64_tr_b16 a[250:251], v218 offset:16896
    v_exp_f32 v238, v238
    v_exp_f32 v239, v239
    v_mfma_f32_16x16x32_bf16 a[28:31], a[236:239], a[172:175], a[28:31]
    v_exp_f32 v240, v240
    v_exp_f32 v241, v241
    v_mfma_f32_16x16x32_bf16 a[68:71], a[236:239], a[176:179], a[68:71]
    v_pk_mul_f32 v[128:129], v[128:129], v[132:133]
    v_pk_mul_f32 v[130:131], v[130:131], v[134:135]
    v_pk_add_f32 v[238:239], v[238:239], s[78:79]
    v_mfma_f32_16x16x32_bf16 a[108:111], a[236:239], a[180:183], a[108:111]
    v_pk_add_f32 v[240:241], v[240:241], s[78:79]
    v_rcp_f32 v238, v238
    s_waitcnt lgkmcnt(4)
    v_mfma_f32_16x16x32_bf16 v[16:19], a[240:243], a[120:123], v[16:19]
    v_rcp_f32 v239, v239
    v_rcp_f32 v240, v240
    v_mfma_f32_16x16x32_bf16 v[56:59], a[240:243], a[124:127], v[56:59]
    v_rcp_f32 v241, v241
    v_pk_mul_f32 v[128:129], v[128:129], v[238:239]
    v_mfma_f32_16x16x32_bf16 v[96:99], a[240:243], a[128:131], v[96:99]
    v_pk_mul_f32 v[130:131], v[130:131], v[240:241]
    v_cvt_pk_bf16_f32 v248, v128, v129
    v_cvt_pk_bf16_f32 v249, v130, v131
    v_mfma_f32_16x16x32_bf16 v[136:139], a[240:243], a[132:135], v[136:139]
    buffer_store_dwordx4 v[246:249], v223, s[16:19], s74 offen
    s_add_u32 s74, s74, 147456
    v_pk_mul_f32 v[234:235], v[160:161], s[70:71]
    v_pk_mul_f32 v[236:237], v[162:163], s[70:71]
    v_mfma_f32_16x16x32_bf16 v[176:179], a[240:243], a[136:139], v[176:179]
    ds_read_b64_tr_b16 a[252:253], v218 offset:24576
    ds_read_b64_tr_b16 a[254:255], v218 offset:25088
    v_exp_f32 v234, v234
    v_exp_f32 v235, v235
    v_mfma_f32_16x16x32_bf16 a[16:19], a[240:243], a[140:143], a[16:19]
    v_exp_f32 v236, v236
    v_exp_f32 v237, v237
    v_mfma_f32_16x16x32_bf16 a[56:59], a[240:243], a[144:147], a[56:59]
    v_pk_mul_f32 v[160:161], v[160:161], v[164:165]
    v_pk_mul_f32 v[162:163], v[162:163], v[166:167]
    v_pk_add_f32 v[234:235], v[234:235], s[78:79]
    v_mfma_f32_16x16x32_bf16 a[96:99], a[240:243], a[148:151], a[96:99]
    v_pk_add_f32 v[236:237], v[236:237], s[78:79]
    v_rcp_f32 v234, v234
    s_waitcnt lgkmcnt(4)
    v_mfma_f32_16x16x32_bf16 v[20:23], a[244:247], a[120:123], v[20:23]
    v_rcp_f32 v235, v235
    v_rcp_f32 v236, v236
    v_mfma_f32_16x16x32_bf16 v[60:63], a[244:247], a[124:127], v[60:63]
    v_rcp_f32 v237, v237
    v_pk_mul_f32 v[160:161], v[160:161], v[234:235]
    v_mfma_f32_16x16x32_bf16 v[100:103], a[244:247], a[128:131], v[100:103]
    v_pk_mul_f32 v[162:163], v[162:163], v[236:237]
    v_cvt_pk_bf16_f32 v242, v160, v161
    v_cvt_pk_bf16_f32 v243, v162, v163
    v_mfma_f32_16x16x32_bf16 v[140:143], a[244:247], a[132:135], v[140:143]
    v_pk_mul_f32 v[238:239], v[168:169], s[70:71]
    v_pk_mul_f32 v[240:241], v[170:171], s[70:71]
    v_exp_f32 v238, v238
    v_mfma_f32_16x16x32_bf16 v[180:183], a[244:247], a[136:139], v[180:183]
    ds_read_b64_tr_b16 a[184:185], v217 offset:53248
    ds_read_b64_tr_b16 a[186:187], v217 offset:53760
    v_exp_f32 v239, v239
    v_exp_f32 v240, v240
    v_mfma_f32_16x16x32_bf16 a[20:23], a[244:247], a[140:143], a[20:23]
    ds_read_b64_tr_b16 a[188:189], v217 offset:61440
    ds_read_b64_tr_b16 a[190:191], v217 offset:61952
    v_exp_f32 v241, v241
    v_pk_mul_f32 v[168:169], v[168:169], v[172:173]
    v_mfma_f32_16x16x32_bf16 a[60:63], a[244:247], a[144:147], a[60:63]
    ds_read_b64_tr_b16 a[192:193], v218 offset:53248
    ds_read_b64_tr_b16 a[194:195], v218 offset:53760
    v_pk_mul_f32 v[170:171], v[170:171], v[174:175]
    v_pk_add_f32 v[238:239], v[238:239], s[78:79]
    v_pk_add_f32 v[240:241], v[240:241], s[78:79]
    v_mfma_f32_16x16x32_bf16 a[100:103], a[244:247], a[148:151], a[100:103]
    ds_read_b64_tr_b16 a[196:197], v218 offset:61440
    ds_read_b64_tr_b16 a[198:199], v218 offset:61952
    v_rcp_f32 v238, v238
    v_rcp_f32 v239, v239
    s_waitcnt lgkmcnt(10)
    v_mfma_f32_16x16x32_bf16 v[24:27], a[248:251], a[120:123], v[24:27]
    v_rcp_f32 v240, v240
    v_rcp_f32 v241, v241
    v_mfma_f32_16x16x32_bf16 v[64:67], a[248:251], a[124:127], v[64:67]
    v_pk_mul_f32 v[168:169], v[168:169], v[238:239]
    v_pk_mul_f32 v[170:171], v[170:171], v[240:241]
    v_cvt_pk_bf16_f32 v244, v168, v169
    v_mfma_f32_16x16x32_bf16 v[104:107], a[248:251], a[128:131], v[104:107]
    v_cvt_pk_bf16_f32 v245, v170, v171
    buffer_store_dwordx4 v[242:245], v223, s[16:19], s74 offen
    s_add_u32 s74, s74, 147456
    v_accvgpr_read_b32 v226, a0
    v_mfma_f32_16x16x32_bf16 v[144:147], a[248:251], a[132:135], v[144:147]
    v_accvgpr_read_b32 v227, a1
    v_accvgpr_read_b32 v228, a2
    v_accvgpr_read_b32 v229, a3
    v_mfma_f32_16x16x32_bf16 v[184:187], a[248:251], a[136:139], v[184:187]
    v_accvgpr_read_b32 v230, a4
    v_accvgpr_read_b32 v231, a5
    v_accvgpr_read_b32 v232, a6
    v_mfma_f32_16x16x32_bf16 a[24:27], a[248:251], a[140:143], a[24:27]
    v_accvgpr_read_b32 v233, a7
    v_pk_mul_f32 v[234:235], v[226:227], s[70:71]
    v_pk_mul_f32 v[236:237], v[228:229], s[70:71]
    v_mfma_f32_16x16x32_bf16 a[64:67], a[248:251], a[144:147], a[64:67]
    v_exp_f32 v234, v234
    v_exp_f32 v235, v235
    v_mfma_f32_16x16x32_bf16 a[104:107], a[248:251], a[148:151], a[104:107]
    v_exp_f32 v236, v236
    v_exp_f32 v237, v237
    s_waitcnt lgkmcnt(8)
    v_mfma_f32_16x16x32_bf16 v[28:31], a[252:255], a[120:123], v[28:31]
    v_pk_mul_f32 v[226:227], v[226:227], v[230:231]
    v_pk_mul_f32 v[228:229], v[228:229], v[232:233]
    v_pk_add_f32 v[234:235], v[234:235], s[78:79]
    v_mfma_f32_16x16x32_bf16 v[68:71], a[252:255], a[124:127], v[68:71]
    v_pk_add_f32 v[236:237], v[236:237], s[78:79]
    v_rcp_f32 v234, v234
    v_mfma_f32_16x16x32_bf16 v[108:111], a[252:255], a[128:131], v[108:111]
    v_rcp_f32 v235, v235
    v_rcp_f32 v236, v236
    v_mfma_f32_16x16x32_bf16 v[148:151], a[252:255], a[132:135], v[148:151]
    v_rcp_f32 v237, v237
    v_pk_mul_f32 v[226:227], v[226:227], v[234:235]
    v_mfma_f32_16x16x32_bf16 v[188:191], a[252:255], a[136:139], v[188:191]
    v_pk_mul_f32 v[228:229], v[228:229], v[236:237]
    v_cvt_pk_bf16_f32 v246, v226, v227
    v_cvt_pk_bf16_f32 v247, v228, v229
    v_mfma_f32_16x16x32_bf16 a[28:31], a[252:255], a[140:143], a[28:31]
    v_accvgpr_read_b32 v226, a8
    v_accvgpr_read_b32 v227, a9
    v_accvgpr_read_b32 v228, a10
    v_mfma_f32_16x16x32_bf16 a[68:71], a[252:255], a[144:147], a[68:71]
    v_accvgpr_read_b32 v229, a11
    v_accvgpr_read_b32 v230, a12
    v_accvgpr_read_b32 v231, a13
    v_mfma_f32_16x16x32_bf16 a[108:111], a[252:255], a[148:151], a[108:111]
    v_accvgpr_read_b32 v232, a14
    v_accvgpr_read_b32 v233, a15
    v_pk_mul_f32 v[238:239], v[226:227], s[70:71]
    s_waitcnt lgkmcnt(6)
    v_mfma_f32_16x16x32_bf16 v[16:19], a[184:187], a[204:207], v[16:19]
    v_pk_mul_f32 v[240:241], v[228:229], s[70:71]
    v_exp_f32 v238, v238
    s_waitcnt lgkmcnt(4)
    v_mfma_f32_16x16x32_bf16 v[20:23], a[188:191], a[204:207], v[20:23]
    v_exp_f32 v239, v239
    v_exp_f32 v240, v240
    s_waitcnt lgkmcnt(2)
    v_mfma_f32_16x16x32_bf16 v[24:27], a[192:195], a[204:207], v[24:27]
    v_exp_f32 v241, v241
    v_pk_mul_f32 v[226:227], v[226:227], v[230:231]
    s_waitcnt lgkmcnt(0)
    v_mfma_f32_16x16x32_bf16 v[28:31], a[196:199], a[204:207], v[28:31]
    v_pk_mul_f32 v[228:229], v[228:229], v[232:233]
    v_pk_add_f32 v[238:239], v[238:239], s[78:79]
    v_pk_add_f32 v[240:241], v[240:241], s[78:79]
    v_mfma_f32_16x16x32_bf16 v[56:59], a[184:187], a[208:211], v[56:59]
    v_rcp_f32 v238, v238
    v_rcp_f32 v239, v239
    v_mfma_f32_16x16x32_bf16 v[60:63], a[188:191], a[208:211], v[60:63]
    v_rcp_f32 v240, v240
    v_rcp_f32 v241, v241
    v_mfma_f32_16x16x32_bf16 v[64:67], a[192:195], a[208:211], v[64:67]
    v_pk_mul_f32 v[226:227], v[226:227], v[238:239]
    v_pk_mul_f32 v[228:229], v[228:229], v[240:241]
    v_cvt_pk_bf16_f32 v248, v226, v227
    v_mfma_f32_16x16x32_bf16 v[68:71], a[196:199], a[208:211], v[68:71]
    v_cvt_pk_bf16_f32 v249, v228, v229
    buffer_store_dwordx4 v[246:249], v223, s[16:19], s74 offen
    s_add_u32 s74, s74, 147456
    v_accvgpr_read_b32 v226, a40
    v_mfma_f32_16x16x32_bf16 v[96:99], a[184:187], a[212:215], v[96:99]
    v_accvgpr_read_b32 v227, a41
    v_accvgpr_read_b32 v228, a42
    v_accvgpr_read_b32 v229, a43
    v_mfma_f32_16x16x32_bf16 v[100:103], a[188:191], a[212:215], v[100:103]
    v_accvgpr_read_b32 v230, a44
    v_accvgpr_read_b32 v231, a45
    v_accvgpr_read_b32 v232, a46
    v_mfma_f32_16x16x32_bf16 v[104:107], a[192:195], a[212:215], v[104:107]
    v_accvgpr_read_b32 v233, a47
    v_pk_mul_f32 v[234:235], v[226:227], s[70:71]
    v_pk_mul_f32 v[236:237], v[228:229], s[70:71]
    v_mfma_f32_16x16x32_bf16 v[108:111], a[196:199], a[212:215], v[108:111]
    v_exp_f32 v234, v234
    v_exp_f32 v235, v235
    v_mfma_f32_16x16x32_bf16 v[136:139], a[184:187], a[216:219], v[136:139]
    ds_read_b64_tr_b16 a[200:201], v219 offset:36864
    ds_read_b64_tr_b16 a[202:203], v219 offset:37120
    v_exp_f32 v236, v236
    v_exp_f32 v237, v237
    v_mfma_f32_16x16x32_bf16 v[140:143], a[188:191], a[216:219], v[140:143]
    v_pk_mul_f32 v[226:227], v[226:227], v[230:231]
    v_pk_mul_f32 v[228:229], v[228:229], v[232:233]
    v_pk_add_f32 v[234:235], v[234:235], s[78:79]
    v_mfma_f32_16x16x32_bf16 v[144:147], a[192:195], a[216:219], v[144:147]
    v_pk_add_f32 v[236:237], v[236:237], s[78:79]
    v_rcp_f32 v234, v234
    v_mfma_f32_16x16x32_bf16 v[148:151], a[196:199], a[216:219], v[148:151]
    v_rcp_f32 v235, v235
    v_rcp_f32 v236, v236
    v_mfma_f32_16x16x32_bf16 v[176:179], a[184:187], a[220:223], v[176:179]
    v_rcp_f32 v237, v237
    v_pk_mul_f32 v[226:227], v[226:227], v[234:235]
    v_mfma_f32_16x16x32_bf16 v[180:183], a[188:191], a[220:223], v[180:183]
    v_pk_mul_f32 v[228:229], v[228:229], v[236:237]
    v_cvt_pk_bf16_f32 v242, v226, v227
    v_cvt_pk_bf16_f32 v243, v228, v229
    v_mfma_f32_16x16x32_bf16 v[184:187], a[192:195], a[220:223], v[184:187]
    v_accvgpr_read_b32 v226, a48
    v_accvgpr_read_b32 v227, a49
    v_accvgpr_read_b32 v228, a50
    v_mfma_f32_16x16x32_bf16 v[188:191], a[196:199], a[220:223], v[188:191]
    v_accvgpr_read_b32 v229, a51
    v_accvgpr_read_b32 v230, a52
    v_accvgpr_read_b32 v231, a53
    v_mfma_f32_16x16x32_bf16 a[16:19], a[184:187], a[224:227], a[16:19]
    ds_read_b64_tr_b16 a[236:237], v219 offset:38912
    ds_read_b64_tr_b16 a[238:239], v219 offset:39168
    v_accvgpr_read_b32 v232, a54
    v_accvgpr_read_b32 v233, a55
    v_pk_mul_f32 v[238:239], v[226:227], s[70:71]
    v_mfma_f32_16x16x32_bf16 a[20:23], a[188:191], a[224:227], a[20:23]
    v_pk_mul_f32 v[240:241], v[228:229], s[70:71]
    v_exp_f32 v238, v238
    v_mfma_f32_16x16x32_bf16 a[24:27], a[192:195], a[224:227], a[24:27]
    v_exp_f32 v239, v239
    v_exp_f32 v240, v240
    v_mfma_f32_16x16x32_bf16 a[28:31], a[196:199], a[224:227], a[28:31]
    v_exp_f32 v241, v241
    v_pk_mul_f32 v[226:227], v[226:227], v[230:231]
    v_mfma_f32_16x16x32_bf16 a[56:59], a[184:187], a[228:231], a[56:59]
    v_pk_mul_f32 v[228:229], v[228:229], v[232:233]
    v_pk_add_f32 v[238:239], v[238:239], s[78:79]
    v_pk_add_f32 v[240:241], v[240:241], s[78:79]
    v_mfma_f32_16x16x32_bf16 a[60:63], a[188:191], a[228:231], a[60:63]
    v_rcp_f32 v238, v238
    v_rcp_f32 v239, v239
    v_mfma_f32_16x16x32_bf16 a[64:67], a[192:195], a[228:231], a[64:67]
    v_rcp_f32 v240, v240
    v_rcp_f32 v241, v241
    v_mfma_f32_16x16x32_bf16 a[68:71], a[196:199], a[228:231], a[68:71]
    v_pk_mul_f32 v[226:227], v[226:227], v[238:239]
    v_pk_mul_f32 v[228:229], v[228:229], v[240:241]
    v_cvt_pk_bf16_f32 v244, v226, v227
    v_mfma_f32_16x16x32_bf16 a[96:99], a[184:187], a[232:235], a[96:99]
    ds_read_b64_tr_b16 a[240:241], v220 offset:0
    ds_read_b64_tr_b16 a[242:243], v220 offset:256
    v_cvt_pk_bf16_f32 v245, v228, v229
    buffer_store_dwordx4 v[242:245], v223, s[16:19], s74 offen
    s_add_u32 s74, s74, 147456
    v_accvgpr_read_b32 v226, a80
    v_mfma_f32_16x16x32_bf16 a[100:103], a[188:191], a[232:235], a[100:103]
    v_accvgpr_read_b32 v227, a81
    v_accvgpr_read_b32 v228, a82
    v_accvgpr_read_b32 v229, a83
    v_mfma_f32_16x16x32_bf16 a[104:107], a[192:195], a[232:235], a[104:107]
    v_accvgpr_read_b32 v230, a84
    v_accvgpr_read_b32 v231, a85
    v_accvgpr_read_b32 v232, a86
    v_mfma_f32_16x16x32_bf16 a[108:111], a[196:199], a[232:235], a[108:111]
    v_accvgpr_read_b32 v233, a87
    v_pk_mul_f32 v[234:235], v[226:227], s[70:71]
    v_pk_mul_f32 v[236:237], v[228:229], s[70:71]
    s_waitcnt lgkmcnt(4)
    v_mfma_f32_16x16x32_bf16 v[32:35], a[200:203], a[152:155], v[32:35]
    v_exp_f32 v234, v234
    v_exp_f32 v235, v235
    v_mfma_f32_16x16x32_bf16 v[72:75], a[200:203], a[156:159], v[72:75]
    v_exp_f32 v236, v236
    v_exp_f32 v237, v237
    v_mfma_f32_16x16x32_bf16 v[112:115], a[200:203], a[160:163], v[112:115]
    v_pk_mul_f32 v[226:227], v[226:227], v[230:231]
    v_pk_mul_f32 v[228:229], v[228:229], v[232:233]
    v_pk_add_f32 v[234:235], v[234:235], s[78:79]
    v_mfma_f32_16x16x32_bf16 v[152:155], a[200:203], a[164:167], v[152:155]
    v_pk_add_f32 v[236:237], v[236:237], s[78:79]
    v_rcp_f32 v234, v234
    v_mfma_f32_16x16x32_bf16 v[192:195], a[200:203], a[168:171], v[192:195]
    ds_read_b64_tr_b16 a[244:245], v220 offset:2048
    ds_read_b64_tr_b16 a[246:247], v220 offset:2304
    v_rcp_f32 v235, v235
    v_rcp_f32 v236, v236
    v_mfma_f32_16x16x32_bf16 a[32:35], a[200:203], a[172:175], a[32:35]
    v_rcp_f32 v237, v237
    v_pk_mul_f32 v[226:227], v[226:227], v[234:235]
    v_mfma_f32_16x16x32_bf16 a[72:75], a[200:203], a[176:179], a[72:75]
    v_pk_mul_f32 v[228:229], v[228:229], v[236:237]
    v_cvt_pk_bf16_f32 v246, v226, v227
    v_cvt_pk_bf16_f32 v247, v228, v229
    v_mfma_f32_16x16x32_bf16 a[112:115], a[200:203], a[180:183], a[112:115]
    v_accvgpr_read_b32 v226, a88
    v_accvgpr_read_b32 v227, a89
    v_accvgpr_read_b32 v228, a90
    s_waitcnt lgkmcnt(4)
    v_mfma_f32_16x16x32_bf16 v[36:39], a[236:239], a[152:155], v[36:39]
    v_accvgpr_read_b32 v229, a91
    v_accvgpr_read_b32 v230, a92
    v_accvgpr_read_b32 v231, a93
    v_mfma_f32_16x16x32_bf16 v[76:79], a[236:239], a[156:159], v[76:79]
    v_accvgpr_read_b32 v232, a94
    v_accvgpr_read_b32 v233, a95
    v_pk_mul_f32 v[238:239], v[226:227], s[70:71]
    v_mfma_f32_16x16x32_bf16 v[116:119], a[236:239], a[160:163], v[116:119]
    v_pk_mul_f32 v[240:241], v[228:229], s[70:71]
    v_exp_f32 v238, v238
    v_mfma_f32_16x16x32_bf16 v[156:159], a[236:239], a[164:167], v[156:159]
    v_exp_f32 v239, v239
    v_exp_f32 v240, v240
    v_mfma_f32_16x16x32_bf16 v[196:199], a[236:239], a[168:171], v[196:199]
    ds_read_b64_tr_b16 a[248:249], v220 offset:36864
    ds_read_b64_tr_b16 a[250:251], v220 offset:37120
    v_exp_f32 v241, v241
    v_pk_mul_f32 v[226:227], v[226:227], v[230:231]
    v_mfma_f32_16x16x32_bf16 a[36:39], a[236:239], a[172:175], a[36:39]
    ds_read_b64_tr_b16 a[252:253], v220 offset:38912
    ds_read_b64_tr_b16 a[254:255], v220 offset:39168
    v_pk_mul_f32 v[228:229], v[228:229], v[232:233]
    v_pk_add_f32 v[238:239], v[238:239], s[78:79]
    v_pk_add_f32 v[240:241], v[240:241], s[78:79]
    v_mfma_f32_16x16x32_bf16 a[76:79], a[236:239], a[176:179], a[76:79]
    v_rcp_f32 v238, v238
    v_rcp_f32 v239, v239
    v_mfma_f32_16x16x32_bf16 a[116:119], a[236:239], a[180:183], a[116:119]
    v_rcp_f32 v240, v240
    v_rcp_f32 v241, v241
    s_waitcnt lgkmcnt(6)
    v_mfma_f32_16x16x32_bf16 v[32:35], a[240:243], a[120:123], v[32:35]
    v_pk_mul_f32 v[226:227], v[226:227], v[238:239]
    v_pk_mul_f32 v[228:229], v[228:229], v[240:241]
    v_cvt_pk_bf16_f32 v248, v226, v227
    v_mfma_f32_16x16x32_bf16 v[72:75], a[240:243], a[124:127], v[72:75]
    v_cvt_pk_bf16_f32 v249, v228, v229
    buffer_store_dwordx4 v[246:249], v223, s[16:19], s74 offen
    s_add_u32 s47, s61, 33
    s_lshl_b32 s74, s47, 10
    s_mul_i32 s47, s58, 147456
    s_add_u32 s74, s74, s47
    v_mfma_f32_16x16x32_bf16 v[112:115], a[240:243], a[128:131], v[112:115]
    s_add_u32 s74, s74, 16777216
    v_pk_mul_f32 v[234:235], v[16:17], s[70:71]
    v_pk_mul_f32 v[236:237], v[18:19], s[70:71]
    v_exp_f32 v234, v234
    v_mfma_f32_16x16x32_bf16 v[152:155], a[240:243], a[132:135], v[152:155]
    v_exp_f32 v235, v235
    v_exp_f32 v236, v236
    v_mfma_f32_16x16x32_bf16 v[192:195], a[240:243], a[136:139], v[192:195]
    v_exp_f32 v237, v237
    v_pk_mul_f32 v[16:17], v[16:17], v[20:21]
    v_mfma_f32_16x16x32_bf16 a[32:35], a[240:243], a[140:143], a[32:35]
    v_pk_mul_f32 v[18:19], v[18:19], v[22:23]
    v_pk_add_f32 v[234:235], v[234:235], s[78:79]
    v_pk_add_f32 v[236:237], v[236:237], s[78:79]
    v_mfma_f32_16x16x32_bf16 a[72:75], a[240:243], a[144:147], a[72:75]
    v_rcp_f32 v234, v234
    v_rcp_f32 v235, v235
    v_mfma_f32_16x16x32_bf16 a[112:115], a[240:243], a[148:151], a[112:115]
    v_rcp_f32 v236, v236
    v_rcp_f32 v237, v237
    s_waitcnt lgkmcnt(4)
    v_mfma_f32_16x16x32_bf16 v[36:39], a[244:247], a[120:123], v[36:39]
    v_pk_mul_f32 v[16:17], v[16:17], v[234:235]
    v_pk_mul_f32 v[18:19], v[18:19], v[236:237]
    v_cvt_pk_bf16_f32 v242, v16, v17
    v_mfma_f32_16x16x32_bf16 v[76:79], a[244:247], a[124:127], v[76:79]
    v_cvt_pk_bf16_f32 v243, v18, v19
    v_pk_mul_f32 v[238:239], v[24:25], s[70:71]
    v_pk_mul_f32 v[240:241], v[26:27], s[70:71]
    v_mfma_f32_16x16x32_bf16 v[116:119], a[244:247], a[128:131], v[116:119]
    v_exp_f32 v238, v238
    v_exp_f32 v239, v239
    v_mfma_f32_16x16x32_bf16 v[156:159], a[244:247], a[132:135], v[156:159]
    v_exp_f32 v240, v240
    v_exp_f32 v241, v241
    v_mfma_f32_16x16x32_bf16 v[196:199], a[244:247], a[136:139], v[196:199]
    v_pk_mul_f32 v[24:25], v[24:25], v[28:29]
    v_pk_mul_f32 v[26:27], v[26:27], v[30:31]
    v_pk_add_f32 v[238:239], v[238:239], s[78:79]
    v_mfma_f32_16x16x32_bf16 a[36:39], a[244:247], a[140:143], a[36:39]
    v_pk_add_f32 v[240:241], v[240:241], s[78:79]
    v_rcp_f32 v238, v238
    v_mfma_f32_16x16x32_bf16 a[76:79], a[244:247], a[144:147], a[76:79]
    v_rcp_f32 v239, v239
    v_rcp_f32 v240, v240
    v_mfma_f32_16x16x32_bf16 a[116:119], a[244:247], a[148:151], a[116:119]
    v_rcp_f32 v241, v241
    v_pk_mul_f32 v[24:25], v[24:25], v[238:239]
    s_waitcnt lgkmcnt(2)
    v_mfma_f32_16x16x32_bf16 v[32:35], a[248:251], a[204:207], v[32:35]
    v_pk_mul_f32 v[26:27], v[26:27], v[240:241]
    v_cvt_pk_bf16_f32 v244, v24, v25
    v_cvt_pk_bf16_f32 v245, v26, v27
    s_waitcnt lgkmcnt(0)
    v_mfma_f32_16x16x32_bf16 v[36:39], a[252:255], a[204:207], v[36:39]
    buffer_store_dwordx4 v[242:245], v223, s[16:19], s74 offen
    s_add_u32 s74, s74, 147456
    v_pk_mul_f32 v[234:235], v[56:57], s[70:71]
    v_pk_mul_f32 v[236:237], v[58:59], s[70:71]
    v_mfma_f32_16x16x32_bf16 v[72:75], a[248:251], a[208:211], v[72:75]
    v_exp_f32 v234, v234
    v_exp_f32 v235, v235
    v_mfma_f32_16x16x32_bf16 v[76:79], a[252:255], a[208:211], v[76:79]
    v_exp_f32 v236, v236
    v_exp_f32 v237, v237
    v_mfma_f32_16x16x32_bf16 v[112:115], a[248:251], a[212:215], v[112:115]
    v_pk_mul_f32 v[56:57], v[56:57], v[60:61]
    v_pk_mul_f32 v[58:59], v[58:59], v[62:63]
    v_pk_add_f32 v[234:235], v[234:235], s[78:79]
    v_mfma_f32_16x16x32_bf16 v[116:119], a[252:255], a[212:215], v[116:119]
    v_pk_add_f32 v[236:237], v[236:237], s[78:79]
    v_rcp_f32 v234, v234
    v_mfma_f32_16x16x32_bf16 v[152:155], a[248:251], a[216:219], v[152:155]
    v_rcp_f32 v235, v235
    v_rcp_f32 v236, v236
    v_mfma_f32_16x16x32_bf16 v[156:159], a[252:255], a[216:219], v[156:159]
    v_rcp_f32 v237, v237
    v_pk_mul_f32 v[56:57], v[56:57], v[234:235]
    v_mfma_f32_16x16x32_bf16 v[192:195], a[248:251], a[220:223], v[192:195]
    v_pk_mul_f32 v[58:59], v[58:59], v[236:237]
    v_cvt_pk_bf16_f32 v246, v56, v57
    v_cvt_pk_bf16_f32 v247, v58, v59
    v_mfma_f32_16x16x32_bf16 v[196:199], a[252:255], a[220:223], v[196:199]
    v_pk_mul_f32 v[238:239], v[64:65], s[70:71]
    v_pk_mul_f32 v[240:241], v[66:67], s[70:71]
    v_exp_f32 v238, v238
    v_mfma_f32_16x16x32_bf16 a[32:35], a[248:251], a[224:227], a[32:35]
    v_exp_f32 v239, v239
    v_exp_f32 v240, v240
    v_mfma_f32_16x16x32_bf16 a[36:39], a[252:255], a[224:227], a[36:39]
    v_exp_f32 v241, v241
    v_pk_mul_f32 v[64:65], v[64:65], v[68:69]
    v_mfma_f32_16x16x32_bf16 a[72:75], a[248:251], a[228:231], a[72:75]
    v_pk_mul_f32 v[66:67], v[66:67], v[70:71]
    v_pk_add_f32 v[238:239], v[238:239], s[78:79]
    v_pk_add_f32 v[240:241], v[240:241], s[78:79]
    v_mfma_f32_16x16x32_bf16 a[76:79], a[252:255], a[228:231], a[76:79]
    v_rcp_f32 v238, v238
    v_rcp_f32 v239, v239
    v_mfma_f32_16x16x32_bf16 a[112:115], a[248:251], a[232:235], a[112:115]
    v_rcp_f32 v240, v240
    v_rcp_f32 v241, v241
    v_mfma_f32_16x16x32_bf16 a[116:119], a[252:255], a[232:235], a[116:119]
    v_pk_mul_f32 v[64:65], v[64:65], v[238:239]
    v_pk_mul_f32 v[66:67], v[66:67], v[240:241]
    v_cvt_pk_bf16_f32 v248, v64, v65
    v_cvt_pk_bf16_f32 v249, v66, v67
    buffer_store_dwordx4 v[246:249], v223, s[16:19], s74 offen
    s_add_u32 s74, s74, 147456
    v_pk_mul_f32 v[234:235], v[96:97], s[70:71]
    v_pk_mul_f32 v[236:237], v[98:99], s[70:71]
    v_exp_f32 v234, v234
    v_exp_f32 v235, v235
    v_exp_f32 v236, v236
    v_exp_f32 v237, v237
    v_pk_mul_f32 v[96:97], v[96:97], v[100:101]
    v_pk_mul_f32 v[98:99], v[98:99], v[102:103]
    v_pk_add_f32 v[234:235], v[234:235], s[78:79]
    v_pk_add_f32 v[236:237], v[236:237], s[78:79]
    v_rcp_f32 v234, v234
    v_rcp_f32 v235, v235
    v_rcp_f32 v236, v236
    v_rcp_f32 v237, v237
    v_pk_mul_f32 v[96:97], v[96:97], v[234:235]
    v_pk_mul_f32 v[98:99], v[98:99], v[236:237]
    v_cvt_pk_bf16_f32 v242, v96, v97
    v_cvt_pk_bf16_f32 v243, v98, v99
    v_pk_mul_f32 v[238:239], v[104:105], s[70:71]
    v_pk_mul_f32 v[240:241], v[106:107], s[70:71]
    v_exp_f32 v238, v238
    v_exp_f32 v239, v239
    v_exp_f32 v240, v240
    v_exp_f32 v241, v241
    v_pk_mul_f32 v[104:105], v[104:105], v[108:109]
    v_pk_mul_f32 v[106:107], v[106:107], v[110:111]
    v_pk_add_f32 v[238:239], v[238:239], s[78:79]
    v_pk_add_f32 v[240:241], v[240:241], s[78:79]
    v_rcp_f32 v238, v238
    v_rcp_f32 v239, v239
    v_rcp_f32 v240, v240
    v_rcp_f32 v241, v241
    v_pk_mul_f32 v[104:105], v[104:105], v[238:239]
    v_pk_mul_f32 v[106:107], v[106:107], v[240:241]
    v_cvt_pk_bf16_f32 v244, v104, v105
    v_cvt_pk_bf16_f32 v245, v106, v107
    buffer_store_dwordx4 v[242:245], v223, s[16:19], s74 offen
    s_add_u32 s74, s74, 147456
    v_pk_mul_f32 v[234:235], v[136:137], s[70:71]
    v_pk_mul_f32 v[236:237], v[138:139], s[70:71]
    v_exp_f32 v234, v234
    v_exp_f32 v235, v235
    v_exp_f32 v236, v236
    v_exp_f32 v237, v237
    v_pk_mul_f32 v[136:137], v[136:137], v[140:141]
    v_pk_mul_f32 v[138:139], v[138:139], v[142:143]
    v_pk_add_f32 v[234:235], v[234:235], s[78:79]
    v_pk_add_f32 v[236:237], v[236:237], s[78:79]
    v_rcp_f32 v234, v234
    v_rcp_f32 v235, v235
    v_rcp_f32 v236, v236
    v_rcp_f32 v237, v237
    v_pk_mul_f32 v[136:137], v[136:137], v[234:235]
    v_pk_mul_f32 v[138:139], v[138:139], v[236:237]
    v_cvt_pk_bf16_f32 v246, v136, v137
    v_cvt_pk_bf16_f32 v247, v138, v139
    v_pk_mul_f32 v[238:239], v[144:145], s[70:71]
    v_pk_mul_f32 v[240:241], v[146:147], s[70:71]
    v_exp_f32 v238, v238
    v_exp_f32 v239, v239
    v_exp_f32 v240, v240
    v_exp_f32 v241, v241
    v_pk_mul_f32 v[144:145], v[144:145], v[148:149]
    v_pk_mul_f32 v[146:147], v[146:147], v[150:151]
    v_pk_add_f32 v[238:239], v[238:239], s[78:79]
    v_pk_add_f32 v[240:241], v[240:241], s[78:79]
    v_rcp_f32 v238, v238
    v_rcp_f32 v239, v239
    v_rcp_f32 v240, v240
    v_rcp_f32 v241, v241
    v_pk_mul_f32 v[144:145], v[144:145], v[238:239]
    v_pk_mul_f32 v[146:147], v[146:147], v[240:241]
    v_cvt_pk_bf16_f32 v248, v144, v145
    v_cvt_pk_bf16_f32 v249, v146, v147
    buffer_store_dwordx4 v[246:249], v223, s[16:19], s74 offen
    s_add_u32 s74, s74, 147456
    v_pk_mul_f32 v[234:235], v[176:177], s[70:71]
    v_pk_mul_f32 v[236:237], v[178:179], s[70:71]
    v_exp_f32 v234, v234
    v_exp_f32 v235, v235
    v_exp_f32 v236, v236
    v_exp_f32 v237, v237
    v_pk_mul_f32 v[176:177], v[176:177], v[180:181]
    v_pk_mul_f32 v[178:179], v[178:179], v[182:183]
    v_pk_add_f32 v[234:235], v[234:235], s[78:79]
    v_pk_add_f32 v[236:237], v[236:237], s[78:79]
    v_rcp_f32 v234, v234
    v_rcp_f32 v235, v235
    v_rcp_f32 v236, v236
    v_rcp_f32 v237, v237
    v_pk_mul_f32 v[176:177], v[176:177], v[234:235]
    v_pk_mul_f32 v[178:179], v[178:179], v[236:237]
    v_cvt_pk_bf16_f32 v242, v176, v177
    v_cvt_pk_bf16_f32 v243, v178, v179
    v_pk_mul_f32 v[238:239], v[184:185], s[70:71]
    v_pk_mul_f32 v[240:241], v[186:187], s[70:71]
    v_exp_f32 v238, v238
    v_exp_f32 v239, v239
    v_exp_f32 v240, v240
    v_exp_f32 v241, v241
    v_pk_mul_f32 v[184:185], v[184:185], v[188:189]
    v_pk_mul_f32 v[186:187], v[186:187], v[190:191]
    v_pk_add_f32 v[238:239], v[238:239], s[78:79]
    v_pk_add_f32 v[240:241], v[240:241], s[78:79]
    v_rcp_f32 v238, v238
    v_rcp_f32 v239, v239
    v_rcp_f32 v240, v240
    v_rcp_f32 v241, v241
    v_pk_mul_f32 v[184:185], v[184:185], v[238:239]
    v_pk_mul_f32 v[186:187], v[186:187], v[240:241]
    v_cvt_pk_bf16_f32 v244, v184, v185
    v_cvt_pk_bf16_f32 v245, v186, v187
    buffer_store_dwordx4 v[242:245], v223, s[16:19], s74 offen
    s_add_u32 s74, s74, 147456
    v_accvgpr_read_b32 v226, a16
    v_accvgpr_read_b32 v227, a17
    v_accvgpr_read_b32 v228, a18
    v_accvgpr_read_b32 v229, a19
    v_accvgpr_read_b32 v230, a20
    v_accvgpr_read_b32 v231, a21
    v_accvgpr_read_b32 v232, a22
    v_accvgpr_read_b32 v233, a23
    v_pk_mul_f32 v[234:235], v[226:227], s[70:71]
    v_pk_mul_f32 v[236:237], v[228:229], s[70:71]
    v_exp_f32 v234, v234
    v_exp_f32 v235, v235
    v_exp_f32 v236, v236
    v_exp_f32 v237, v237
    v_pk_mul_f32 v[226:227], v[226:227], v[230:231]
    v_pk_mul_f32 v[228:229], v[228:229], v[232:233]
    v_pk_add_f32 v[234:235], v[234:235], s[78:79]
    v_pk_add_f32 v[236:237], v[236:237], s[78:79]
    v_rcp_f32 v234, v234
    v_rcp_f32 v235, v235
    v_rcp_f32 v236, v236
    v_rcp_f32 v237, v237
    v_pk_mul_f32 v[226:227], v[226:227], v[234:235]
    v_pk_mul_f32 v[228:229], v[228:229], v[236:237]
    v_cvt_pk_bf16_f32 v246, v226, v227
    v_cvt_pk_bf16_f32 v247, v228, v229
    v_accvgpr_read_b32 v226, a24
    v_accvgpr_read_b32 v227, a25
    v_accvgpr_read_b32 v228, a26
    v_accvgpr_read_b32 v229, a27
    v_accvgpr_read_b32 v230, a28
    v_accvgpr_read_b32 v231, a29
    v_accvgpr_read_b32 v232, a30
    v_accvgpr_read_b32 v233, a31
    v_pk_mul_f32 v[238:239], v[226:227], s[70:71]
    v_pk_mul_f32 v[240:241], v[228:229], s[70:71]
    v_exp_f32 v238, v238
    v_exp_f32 v239, v239
    v_exp_f32 v240, v240
    v_exp_f32 v241, v241
    v_pk_mul_f32 v[226:227], v[226:227], v[230:231]
    v_pk_mul_f32 v[228:229], v[228:229], v[232:233]
    v_pk_add_f32 v[238:239], v[238:239], s[78:79]
    v_pk_add_f32 v[240:241], v[240:241], s[78:79]
    v_rcp_f32 v238, v238
    v_rcp_f32 v239, v239
    v_rcp_f32 v240, v240
    v_rcp_f32 v241, v241
    v_pk_mul_f32 v[226:227], v[226:227], v[238:239]
    v_pk_mul_f32 v[228:229], v[228:229], v[240:241]
    v_cvt_pk_bf16_f32 v248, v226, v227
    v_cvt_pk_bf16_f32 v249, v228, v229
    buffer_store_dwordx4 v[246:249], v223, s[16:19], s74 offen
    s_add_u32 s74, s74, 147456
    v_accvgpr_read_b32 v226, a56
    v_accvgpr_read_b32 v227, a57
    v_accvgpr_read_b32 v228, a58
    v_accvgpr_read_b32 v229, a59
    v_accvgpr_read_b32 v230, a60
    v_accvgpr_read_b32 v231, a61
    v_accvgpr_read_b32 v232, a62
    v_accvgpr_read_b32 v233, a63
    v_pk_mul_f32 v[234:235], v[226:227], s[70:71]
    v_pk_mul_f32 v[236:237], v[228:229], s[70:71]
    v_exp_f32 v234, v234
    v_exp_f32 v235, v235
    v_exp_f32 v236, v236
    v_exp_f32 v237, v237
    v_pk_mul_f32 v[226:227], v[226:227], v[230:231]
    v_pk_mul_f32 v[228:229], v[228:229], v[232:233]
    v_pk_add_f32 v[234:235], v[234:235], s[78:79]
    v_pk_add_f32 v[236:237], v[236:237], s[78:79]
    v_rcp_f32 v234, v234
    v_rcp_f32 v235, v235
    v_rcp_f32 v236, v236
    v_rcp_f32 v237, v237
    v_pk_mul_f32 v[226:227], v[226:227], v[234:235]
    v_pk_mul_f32 v[228:229], v[228:229], v[236:237]
    v_cvt_pk_bf16_f32 v242, v226, v227
    v_cvt_pk_bf16_f32 v243, v228, v229
    v_accvgpr_read_b32 v226, a64
    v_accvgpr_read_b32 v227, a65
    v_accvgpr_read_b32 v228, a66
    v_accvgpr_read_b32 v229, a67
    v_accvgpr_read_b32 v230, a68
    v_accvgpr_read_b32 v231, a69
    v_accvgpr_read_b32 v232, a70
    v_accvgpr_read_b32 v233, a71
    v_pk_mul_f32 v[238:239], v[226:227], s[70:71]
    v_pk_mul_f32 v[240:241], v[228:229], s[70:71]
    v_exp_f32 v238, v238
    v_exp_f32 v239, v239
    v_exp_f32 v240, v240
    v_exp_f32 v241, v241
    v_pk_mul_f32 v[226:227], v[226:227], v[230:231]
    v_pk_mul_f32 v[228:229], v[228:229], v[232:233]
    v_pk_add_f32 v[238:239], v[238:239], s[78:79]
    v_pk_add_f32 v[240:241], v[240:241], s[78:79]
    v_rcp_f32 v238, v238
    v_rcp_f32 v239, v239
    v_rcp_f32 v240, v240
    v_rcp_f32 v241, v241
    v_pk_mul_f32 v[226:227], v[226:227], v[238:239]
    v_pk_mul_f32 v[228:229], v[228:229], v[240:241]
    v_cvt_pk_bf16_f32 v244, v226, v227
    v_cvt_pk_bf16_f32 v245, v228, v229
    buffer_store_dwordx4 v[242:245], v223, s[16:19], s74 offen
    s_add_u32 s74, s74, 147456
    v_accvgpr_read_b32 v226, a96
    v_accvgpr_read_b32 v227, a97
    v_accvgpr_read_b32 v228, a98
    v_accvgpr_read_b32 v229, a99
    v_accvgpr_read_b32 v230, a100
    v_accvgpr_read_b32 v231, a101
    v_accvgpr_read_b32 v232, a102
    v_accvgpr_read_b32 v233, a103
    v_pk_mul_f32 v[234:235], v[226:227], s[70:71]
    v_pk_mul_f32 v[236:237], v[228:229], s[70:71]
    v_exp_f32 v234, v234
    v_exp_f32 v235, v235
    v_exp_f32 v236, v236
    v_exp_f32 v237, v237
    v_pk_mul_f32 v[226:227], v[226:227], v[230:231]
    v_pk_mul_f32 v[228:229], v[228:229], v[232:233]
    v_pk_add_f32 v[234:235], v[234:235], s[78:79]
    v_pk_add_f32 v[236:237], v[236:237], s[78:79]
    v_rcp_f32 v234, v234
    v_rcp_f32 v235, v235
    v_rcp_f32 v236, v236
    v_rcp_f32 v237, v237
    v_pk_mul_f32 v[226:227], v[226:227], v[234:235]
    v_pk_mul_f32 v[228:229], v[228:229], v[236:237]
    v_cvt_pk_bf16_f32 v246, v226, v227
    v_cvt_pk_bf16_f32 v247, v228, v229
    v_accvgpr_read_b32 v226, a104
    v_accvgpr_read_b32 v227, a105
    v_accvgpr_read_b32 v228, a106
    v_accvgpr_read_b32 v229, a107
    v_accvgpr_read_b32 v230, a108
    v_accvgpr_read_b32 v231, a109
    v_accvgpr_read_b32 v232, a110
    v_accvgpr_read_b32 v233, a111
    v_pk_mul_f32 v[238:239], v[226:227], s[70:71]
    v_pk_mul_f32 v[240:241], v[228:229], s[70:71]
    v_exp_f32 v238, v238
    v_exp_f32 v239, v239
    v_exp_f32 v240, v240
    v_exp_f32 v241, v241
    v_pk_mul_f32 v[226:227], v[226:227], v[230:231]
    v_pk_mul_f32 v[228:229], v[228:229], v[232:233]
    v_pk_add_f32 v[238:239], v[238:239], s[78:79]
    v_pk_add_f32 v[240:241], v[240:241], s[78:79]
    v_rcp_f32 v238, v238
    v_rcp_f32 v239, v239
    v_rcp_f32 v240, v240
    v_rcp_f32 v241, v241
    v_pk_mul_f32 v[226:227], v[226:227], v[238:239]
    v_pk_mul_f32 v[228:229], v[228:229], v[240:241]
    v_cvt_pk_bf16_f32 v248, v226, v227
    v_cvt_pk_bf16_f32 v249, v228, v229
    buffer_store_dwordx4 v[246:249], v223, s[16:19], s74 offen
    s_nop 7
g1_kernel_c:
    s_nop 3
    s_cmp_lg_u32 s63, 0
    s_cbranch_scc1 g1_kernel_gu_c
    s_add_u32 s47, s64, 0
    s_cmp_lt_u32 s47, 32
    s_cselect_b32 s76, 0x3e8293ee, 1.0
    s_mov_b32 s77, s76
    s_lshl_b32 s74, s47, 17
    s_lshl_b32 s47, s58, 10
    s_add_u32 s74, s74, s47
    s_add_u32 s74, s74, 4194304
    v_pk_mul_f32 v[32:33], v[32:33], s[76:77]
    v_pk_mul_f32 v[34:35], v[34:35], s[76:77]
    v_cvt_pk_bf16_f32 v234, v32, v33
    v_cvt_pk_bf16_f32 v235, v34, v35
    ds_write_b64 v225, v[234:235] offset:0
    v_pk_mul_f32 v[72:73], v[72:73], s[76:77]
    v_pk_mul_f32 v[74:75], v[74:75], s[76:77]
    v_cvt_pk_bf16_f32 v238, v72, v73
    v_cvt_pk_bf16_f32 v239, v74, v75
    ds_write_b64 v225, v[238:239] offset:1024
    v_pk_mul_f32 v[112:113], v[112:113], s[76:77]
    v_pk_mul_f32 v[114:115], v[114:115], s[76:77]
    v_cvt_pk_bf16_f32 v234, v112, v113
    v_cvt_pk_bf16_f32 v235, v114, v115
    ds_write_b64 v225, v[234:235] offset:2048
    v_pk_mul_f32 v[152:153], v[152:153], s[76:77]
    v_pk_mul_f32 v[154:155], v[154:155], s[76:77]
    v_cvt_pk_bf16_f32 v238, v152, v153
    v_cvt_pk_bf16_f32 v239, v154, v155
    ds_write_b64 v225, v[238:239] offset:3072
    s_add_u32 s74, s74, 4096
    v_pk_mul_f32 v[192:193], v[192:193], s[76:77]
    v_pk_mul_f32 v[194:195], v[194:195], s[76:77]
    v_cvt_pk_bf16_f32 v234, v192, v193
    v_cvt_pk_bf16_f32 v235, v194, v195
    ds_write_b64 v225, v[234:235] offset:4096
    v_accvgpr_read_b32 v226, a32
    v_accvgpr_read_b32 v227, a33
    v_accvgpr_read_b32 v228, a34
    v_accvgpr_read_b32 v229, a35
    v_pk_mul_f32 v[226:227], v[226:227], s[76:77]
    v_pk_mul_f32 v[228:229], v[228:229], s[76:77]
    v_cvt_pk_bf16_f32 v238, v226, v227
    v_cvt_pk_bf16_f32 v239, v228, v229
    ds_write_b64 v225, v[238:239] offset:5120
    v_accvgpr_read_b32 v226, a72
    v_accvgpr_read_b32 v227, a73
    v_accvgpr_read_b32 v228, a74
    v_accvgpr_read_b32 v229, a75
    v_pk_mul_f32 v[226:227], v[226:227], s[76:77]
    v_pk_mul_f32 v[228:229], v[228:229], s[76:77]
    v_cvt_pk_bf16_f32 v234, v226, v227
    v_cvt_pk_bf16_f32 v235, v228, v229
    ds_write_b64 v225, v[234:235] offset:6144
    v_accvgpr_read_b32 v226, a112
    v_accvgpr_read_b32 v227, a113
    v_accvgpr_read_b32 v228, a114
    v_accvgpr_read_b32 v229, a115
    v_pk_mul_f32 v[226:227], v[226:227], s[76:77]
    v_pk_mul_f32 v[228:229], v[228:229], s[76:77]
    v_cvt_pk_bf16_f32 v238, v226, v227
    v_cvt_pk_bf16_f32 v239, v228, v229
    ds_write_b64 v225, v[238:239] offset:7168
    s_add_u32 s47, s65, 0
    s_cmp_lt_u32 s47, 32
    s_cselect_b32 s76, 0x3e8293ee, 1.0
    s_mov_b32 s77, s76
    s_lshl_b32 s74, s47, 17
    s_lshl_b32 s47, s58, 10
    s_add_u32 s74, s74, s47
    s_add_u32 s74, s74, 4194304
    v_pk_mul_f32 v[36:37], v[36:37], s[76:77]
    v_pk_mul_f32 v[38:39], v[38:39], s[76:77]
    v_cvt_pk_bf16_f32 v234, v36, v37
    v_cvt_pk_bf16_f32 v235, v38, v39
    ds_write_b64 v225, v[234:235] offset:8192
    v_pk_mul_f32 v[76:77], v[76:77], s[76:77]
    v_pk_mul_f32 v[78:79], v[78:79], s[76:77]
    v_cvt_pk_bf16_f32 v238, v76, v77
    v_cvt_pk_bf16_f32 v239, v78, v79
    ds_write_b64 v225, v[238:239] offset:9216
    v_pk_mul_f32 v[116:117], v[116:117], s[76:77]
    v_pk_mul_f32 v[118:119], v[118:119], s[76:77]
    v_cvt_pk_bf16_f32 v234, v116, v117
    v_cvt_pk_bf16_f32 v235, v118, v119
    ds_write_b64 v225, v[234:235] offset:10240
    v_pk_mul_f32 v[156:157], v[156:157], s[76:77]
    v_pk_mul_f32 v[158:159], v[158:159], s[76:77]
    v_cvt_pk_bf16_f32 v238, v156, v157
    v_cvt_pk_bf16_f32 v239, v158, v159
    ds_write_b64 v225, v[238:239] offset:11264
    s_add_u32 s74, s74, 4096
    v_pk_mul_f32 v[196:197], v[196:197], s[76:77]
    v_pk_mul_f32 v[198:199], v[198:199], s[76:77]
    v_cvt_pk_bf16_f32 v234, v196, v197
    v_cvt_pk_bf16_f32 v235, v198, v199
    ds_write_b64 v225, v[234:235] offset:12288
    v_accvgpr_read_b32 v226, a36
    v_accvgpr_read_b32 v227, a37
    v_accvgpr_read_b32 v228, a38
    v_accvgpr_read_b32 v229, a39
    v_pk_mul_f32 v[226:227], v[226:227], s[76:77]
    v_pk_mul_f32 v[228:229], v[228:229], s[76:77]
    v_cvt_pk_bf16_f32 v238, v226, v227
    v_cvt_pk_bf16_f32 v239, v228, v229
    ds_write_b64 v225, v[238:239] offset:13312
    v_accvgpr_read_b32 v226, a76
    v_accvgpr_read_b32 v227, a77
    v_accvgpr_read_b32 v228, a78
    v_accvgpr_read_b32 v229, a79
    v_pk_mul_f32 v[226:227], v[226:227], s[76:77]
    v_pk_mul_f32 v[228:229], v[228:229], s[76:77]
    v_cvt_pk_bf16_f32 v234, v226, v227
    v_cvt_pk_bf16_f32 v235, v228, v229
    ds_write_b64 v225, v[234:235] offset:14336
    v_accvgpr_read_b32 v226, a116
    v_accvgpr_read_b32 v227, a117
    v_accvgpr_read_b32 v228, a118
    v_accvgpr_read_b32 v229, a119
    v_pk_mul_f32 v[226:227], v[226:227], s[76:77]
    v_pk_mul_f32 v[228:229], v[228:229], s[76:77]
    v_cvt_pk_bf16_f32 v238, v226, v227
    v_cvt_pk_bf16_f32 v239, v228, v229
    ds_write_b64 v225, v[238:239] offset:15360
    s_branch g1_kernel_c2
g1_kernel_gu_c:
    s_add_u32 s47, s64, 32
    s_lshl_b32 s74, s47, 10
    s_mul_i32 s47, s58, 147456
    s_add_u32 s74, s74, s47
    s_add_u32 s74, s74, 16777216
    v_pk_mul_f32 v[234:235], v[32:33], s[70:71]
    v_pk_mul_f32 v[236:237], v[34:35], s[70:71]
    v_exp_f32 v234, v234
    v_exp_f32 v235, v235
    v_exp_f32 v236, v236
    v_exp_f32 v237, v237
    v_pk_mul_f32 v[32:33], v[32:33], v[36:37]
    v_pk_mul_f32 v[34:35], v[34:35], v[38:39]
    v_pk_add_f32 v[234:235], v[234:235], s[78:79]
    v_pk_add_f32 v[236:237], v[236:237], s[78:79]
    v_rcp_f32 v234, v234
    v_rcp_f32 v235, v235
    v_rcp_f32 v236, v236
    v_rcp_f32 v237, v237
    v_pk_mul_f32 v[32:33], v[32:33], v[234:235]
    v_pk_mul_f32 v[34:35], v[34:35], v[236:237]
    v_cvt_pk_bf16_f32 v242, v32, v33
    v_cvt_pk_bf16_f32 v243, v34, v35
    ds_write_b64 v225, v[242:243] offset:0
    s_add_u32 s74, s74, 147456
    v_pk_mul_f32 v[234:235], v[72:73], s[70:71]
    v_pk_mul_f32 v[236:237], v[74:75], s[70:71]
    v_exp_f32 v234, v234
    v_exp_f32 v235, v235
    v_exp_f32 v236, v236
    v_exp_f32 v237, v237
    v_pk_mul_f32 v[72:73], v[72:73], v[76:77]
    v_pk_mul_f32 v[74:75], v[74:75], v[78:79]
    v_pk_add_f32 v[234:235], v[234:235], s[78:79]
    v_pk_add_f32 v[236:237], v[236:237], s[78:79]
    v_rcp_f32 v234, v234
    v_rcp_f32 v235, v235
    v_rcp_f32 v236, v236
    v_rcp_f32 v237, v237
    v_pk_mul_f32 v[72:73], v[72:73], v[234:235]
    v_pk_mul_f32 v[74:75], v[74:75], v[236:237]
    v_cvt_pk_bf16_f32 v246, v72, v73
    v_cvt_pk_bf16_f32 v247, v74, v75
    ds_write_b64 v225, v[246:247] offset:1024
    s_add_u32 s74, s74, 147456
    v_pk_mul_f32 v[234:235], v[112:113], s[70:71]
    v_pk_mul_f32 v[236:237], v[114:115], s[70:71]
    v_exp_f32 v234, v234
    v_exp_f32 v235, v235
    v_exp_f32 v236, v236
    v_exp_f32 v237, v237
    v_pk_mul_f32 v[112:113], v[112:113], v[116:117]
    v_pk_mul_f32 v[114:115], v[114:115], v[118:119]
    v_pk_add_f32 v[234:235], v[234:235], s[78:79]
    v_pk_add_f32 v[236:237], v[236:237], s[78:79]
    v_rcp_f32 v234, v234
    v_rcp_f32 v235, v235
    v_rcp_f32 v236, v236
    v_rcp_f32 v237, v237
    v_pk_mul_f32 v[112:113], v[112:113], v[234:235]
    v_pk_mul_f32 v[114:115], v[114:115], v[236:237]
    v_cvt_pk_bf16_f32 v242, v112, v113
    v_cvt_pk_bf16_f32 v243, v114, v115
    ds_write_b64 v225, v[242:243] offset:2048
    s_add_u32 s74, s74, 147456
    v_pk_mul_f32 v[234:235], v[152:153], s[70:71]
    v_pk_mul_f32 v[236:237], v[154:155], s[70:71]
    v_exp_f32 v234, v234
    v_exp_f32 v235, v235
    v_exp_f32 v236, v236
    v_exp_f32 v237, v237
    v_pk_mul_f32 v[152:153], v[152:153], v[156:157]
    v_pk_mul_f32 v[154:155], v[154:155], v[158:159]
    v_pk_add_f32 v[234:235], v[234:235], s[78:79]
    v_pk_add_f32 v[236:237], v[236:237], s[78:79]
    v_rcp_f32 v234, v234
    v_rcp_f32 v235, v235
    v_rcp_f32 v236, v236
    v_rcp_f32 v237, v237
    v_pk_mul_f32 v[152:153], v[152:153], v[234:235]
    v_pk_mul_f32 v[154:155], v[154:155], v[236:237]
    v_cvt_pk_bf16_f32 v246, v152, v153
    v_cvt_pk_bf16_f32 v247, v154, v155
    ds_write_b64 v225, v[246:247] offset:3072
    s_add_u32 s74, s74, 147456
    v_pk_mul_f32 v[234:235], v[192:193], s[70:71]
    v_pk_mul_f32 v[236:237], v[194:195], s[70:71]
    v_exp_f32 v234, v234
    v_exp_f32 v235, v235
    v_exp_f32 v236, v236
    v_exp_f32 v237, v237
    v_pk_mul_f32 v[192:193], v[192:193], v[196:197]
    v_pk_mul_f32 v[194:195], v[194:195], v[198:199]
    v_pk_add_f32 v[234:235], v[234:235], s[78:79]
    v_pk_add_f32 v[236:237], v[236:237], s[78:79]
    v_rcp_f32 v234, v234
    v_rcp_f32 v235, v235
    v_rcp_f32 v236, v236
    v_rcp_f32 v237, v237
    v_pk_mul_f32 v[192:193], v[192:193], v[234:235]
    v_pk_mul_f32 v[194:195], v[194:195], v[236:237]
    v_cvt_pk_bf16_f32 v242, v192, v193
    v_cvt_pk_bf16_f32 v243, v194, v195
    ds_write_b64 v225, v[242:243] offset:4096
    s_add_u32 s74, s74, 147456
    v_accvgpr_read_b32 v226, a32
    v_accvgpr_read_b32 v227, a33
    v_accvgpr_read_b32 v228, a34
    v_accvgpr_read_b32 v229, a35
    v_accvgpr_read_b32 v230, a36
    v_accvgpr_read_b32 v231, a37
    v_accvgpr_read_b32 v232, a38
    v_accvgpr_read_b32 v233, a39
    v_pk_mul_f32 v[234:235], v[226:227], s[70:71]
    v_pk_mul_f32 v[236:237], v[228:229], s[70:71]
    v_exp_f32 v234, v234
    v_exp_f32 v235, v235
    v_exp_f32 v236, v236
    v_exp_f32 v237, v237
    v_pk_mul_f32 v[226:227], v[226:227], v[230:231]
    v_pk_mul_f32 v[228:229], v[228:229], v[232:233]
    v_pk_add_f32 v[234:235], v[234:235], s[78:79]
    v_pk_add_f32 v[236:237], v[236:237], s[78:79]
    v_rcp_f32 v234, v234
    v_rcp_f32 v235, v235
    v_rcp_f32 v236, v236
    v_rcp_f32 v237, v237
    v_pk_mul_f32 v[226:227], v[226:227], v[234:235]
    v_pk_mul_f32 v[228:229], v[228:229], v[236:237]
    v_cvt_pk_bf16_f32 v246, v226, v227
    v_cvt_pk_bf16_f32 v247, v228, v229
    ds_write_b64 v225, v[246:247] offset:5120
    s_add_u32 s74, s74, 147456
    v_accvgpr_read_b32 v226, a72
    v_accvgpr_read_b32 v227, a73
    v_accvgpr_read_b32 v228, a74
    v_accvgpr_read_b32 v229, a75
    v_accvgpr_read_b32 v230, a76
    v_accvgpr_read_b32 v231, a77
    v_accvgpr_read_b32 v232, a78
    v_accvgpr_read_b32 v233, a79
    v_pk_mul_f32 v[234:235], v[226:227], s[70:71]
    v_pk_mul_f32 v[236:237], v[228:229], s[70:71]
    v_exp_f32 v234, v234
    v_exp_f32 v235, v235
    v_exp_f32 v236, v236
    v_exp_f32 v237, v237
    v_pk_mul_f32 v[226:227], v[226:227], v[230:231]
    v_pk_mul_f32 v[228:229], v[228:229], v[232:233]
    v_pk_add_f32 v[234:235], v[234:235], s[78:79]
    v_pk_add_f32 v[236:237], v[236:237], s[78:79]
    v_rcp_f32 v234, v234
    v_rcp_f32 v235, v235
    v_rcp_f32 v236, v236
    v_rcp_f32 v237, v237
    v_pk_mul_f32 v[226:227], v[226:227], v[234:235]
    v_pk_mul_f32 v[228:229], v[228:229], v[236:237]
    v_cvt_pk_bf16_f32 v242, v226, v227
    v_cvt_pk_bf16_f32 v243, v228, v229
    ds_write_b64 v225, v[242:243] offset:6144
    s_add_u32 s74, s74, 147456
    v_accvgpr_read_b32 v226, a112
    v_accvgpr_read_b32 v227, a113
    v_accvgpr_read_b32 v228, a114
    v_accvgpr_read_b32 v229, a115
    v_accvgpr_read_b32 v230, a116
    v_accvgpr_read_b32 v231, a117
    v_accvgpr_read_b32 v232, a118
    v_accvgpr_read_b32 v233, a119
    v_pk_mul_f32 v[234:235], v[226:227], s[70:71]
    v_pk_mul_f32 v[236:237], v[228:229], s[70:71]
    v_exp_f32 v234, v234
    v_exp_f32 v235, v235
    v_exp_f32 v236, v236
    v_exp_f32 v237, v237
    v_pk_mul_f32 v[226:227], v[226:227], v[230:231]
    v_pk_mul_f32 v[228:229], v[228:229], v[232:233]
    v_pk_add_f32 v[234:235], v[234:235], s[78:79]
    v_pk_add_f32 v[236:237], v[236:237], s[78:79]
    v_rcp_f32 v234, v234
    v_rcp_f32 v235, v235
    v_rcp_f32 v236, v236
    v_rcp_f32 v237, v237
    v_pk_mul_f32 v[226:227], v[226:227], v[234:235]
    v_pk_mul_f32 v[228:229], v[228:229], v[236:237]
    v_cvt_pk_bf16_f32 v246, v226, v227
    v_cvt_pk_bf16_f32 v247, v228, v229
    ds_write_b64 v225, v[246:247] offset:7168
g1_kernel_c2:
    s_waitcnt lgkmcnt(0)
    s_barrier
    ds_read_b128 v[32:35], v221 offset:0
    ds_read_b128 v[72:75], v221 offset:1024
    ds_read_b128 v[112:115], v221 offset:2048
    ds_read_b128 v[152:155], v221 offset:3072
    ds_read_b128 v[36:39], v221 offset:8192
    ds_read_b128 v[76:79], v221 offset:9216
    ds_read_b128 v[116:119], v221 offset:10240
    ds_read_b128 v[156:159], v221 offset:11264
    s_cmp_lg_u32 s63, 0
    s_cbranch_scc1 g1_kernel_gu_f
    s_lshl_b32 s74, s64, 17
    s_lshl_b32 s47, s58, 10
    s_add_u32 s74, s74, s47
    s_lshl_b32 s47, s50, 12
    s_add_u32 s74, s74, s47
    s_add_u32 s74, s74, 4194304
    s_waitcnt lgkmcnt(0)
    buffer_store_dwordx4 v[32:35], v223, s[16:19], s74 offen offset:0
    buffer_store_dwordx4 v[72:75], v223, s[16:19], s74 offen offset:1024
    buffer_store_dwordx4 v[112:115], v223, s[16:19], s74 offen offset:2048
    buffer_store_dwordx4 v[152:155], v223, s[16:19], s74 offen offset:3072
    s_lshl_b32 s74, s65, 17
    s_lshl_b32 s47, s58, 10
    s_add_u32 s74, s74, s47
    s_lshl_b32 s47, s50, 12
    s_add_u32 s74, s74, s47
    s_add_u32 s74, s74, 4194304
    s_waitcnt lgkmcnt(0)
    buffer_store_dwordx4 v[36:39], v223, s[16:19], s74 offen offset:0
    buffer_store_dwordx4 v[76:79], v223, s[16:19], s74 offen offset:1024
    buffer_store_dwordx4 v[116:119], v223, s[16:19], s74 offen offset:2048
    buffer_store_dwordx4 v[156:159], v223, s[16:19], s74 offen offset:3072
    s_branch g1_kernel_fin
g1_kernel_gu_f:
    s_add_u32 s47, s64, 32
    s_lshl_b32 s74, s47, 10
    s_lshl_b32 s47, s50, 2
    s_add_u32 s47, s47, s58
    s_mul_i32 s47, s47, 147456
    s_add_u32 s74, s74, s47
    s_add_u32 s74, s74, 16777216
    s_waitcnt lgkmcnt(0)
    buffer_store_dwordx4 v[32:35], v223, s[16:19], s74 offen
    s_add_u32 s74, s74, 147456
    buffer_store_dwordx4 v[72:75], v223, s[16:19], s74 offen
    s_add_u32 s74, s74, 147456
    buffer_store_dwordx4 v[112:115], v223, s[16:19], s74 offen
    s_add_u32 s74, s74, 147456
    buffer_store_dwordx4 v[152:155], v223, s[16:19], s74 offen
g1_kernel_fin:
g1_kernel_end:
    s_endpgm
.section .rodata,"a"
.p2align 6
.amdhsa_kernel g1_kernel
  .amdhsa_next_free_vgpr 512
  .amdhsa_next_free_sgpr 102
  .amdhsa_accum_offset 256
  .amdhsa_group_segment_fixed_size 0
  .amdhsa_kernarg_size 80
  .amdhsa_user_sgpr_count 2
  .amdhsa_user_sgpr_kernarg_segment_ptr 1
  .amdhsa_system_sgpr_workgroup_id_x 1
.end_amdhsa_kernel
.text
.globl k2_kernel
.p2align 8
.type k2_kernel,@function
k2_kernel:
    s_setprio 3
    s_load_dwordx2 s[34:35], s[0:1], 72
    s_load_dwordx2 s[36:37], s[0:1], 48
    s_cmp_ge_u32 s2, 768
    s_cbranch_scc1 k2_kernel_end
    v_lshrrev_b32 v152, 6, v0
    v_and_b32 v153, 63, v0
    v_readfirstlane_b32 s20, v152
    s_lshr_b32 s3, s2, 8
    s_cmp_eq_u32 s3, 2
    s_cbranch_scc1 k2_kernel_gemm
    s_and_b32 s21, s2, 7
    s_lshl_b32 s21, s21, 1
    s_bfe_u32 s3, s2, 0x10003
    s_add_u32 s21, s21, s3
    s_lshr_b32 s41, s2, 8
    s_lshl_b32 s3, s41, 4
    s_add_u32 s21, s21, s3
    s_bfe_u32 s22, s2, 0x40004
    s_and_b32 s23, s20, 1
    s_lshr_b32 s24, s20, 1
    s_mov_b32 s40, 0
    v_lshlrev_b32 v140, 4, v153
    v_lshrrev_b32 v154, 4, v153
    v_lshlrev_b32 v155, 2, v154
    v_xor_b32 v155, v155, v153
    v_lshlrev_b32 v141, 4, v155
    v_add_u32 v141, 4194304, v141
    s_add_u32 s25, s21, 32
    s_lshl_b32 s25, s25, 17
    s_add_u32 s25, s25, 4194304
    s_lshl_b32 s26, s24, 16
    s_add_u32 s25, s25, s26
    s_lshl_b32 s26, s23, 11
    s_add_u32 s25, s25, s26
    s_lshl_b32 s27, s24, 13
    s_add_u32 s27, s27, s26
    s_waitcnt lgkmcnt(0)
    s_mov_b32 s4, s34
    s_and_b32 s5, s35, 0xffff
    s_mov_b32 s6, 0x10000000
    s_mov_b32 s7, 0x00020000
    s_mov_b32 s28, s25
    s_add_u32 s3, s27, 0
    s_add_u32 m0, s3, 0
    s_nop 0
    buffer_load_dwordx4 v140, s[4:7], s28 offen lds
    buffer_load_dwordx4 v140, s[4:7], s28 offen offset:1024 lds
    s_add_u32 m0, s3, 4096
    s_nop 0
    buffer_load_dwordx4 v141, s[4:7], s28 offen lds
    buffer_load_dwordx4 v141, s[4:7], s28 offen offset:1024 lds
    s_add_u32 s28, s28, 4096
    v_bfe_u32 v154, v153, 4, 1
    v_lshrrev_b32 v155, 5, v153
    v_and_b32 v156, 15, v153
    v_lshlrev_b32 v162, 10, v154
    v_lshl_add_u32 v162, v155, 8, v162
    v_lshl_add_u32 v162, v156, 4, v162
    s_lshl_b32 s26, s21, 17
    s_add_u32 s26, s26, 4194304
    s_lshl_b32 s3, s22, 13
    s_add_u32 s26, s26, s3
    s_lshl_b32 s3, s23, 12
    s_add_u32 s26, s26, s3
    buffer_load_dwordx4 v[120:123], v162, s[4:7], s26 offen offset:0
    buffer_load_dwordx4 v[124:127], v162, s[4:7], s26 offen offset:512
    buffer_load_dwordx4 v[128:131], v162, s[4:7], s26 offen offset:2048
    buffer_load_dwordx4 v[132:135], v162, s[4:7], s26 offen offset:2560
    s_add_u32 s3, s27, 16384
    s_add_u32 m0, s3, 0
    s_nop 0
    buffer_load_dwordx4 v140, s[4:7], s28 offen lds
    buffer_load_dwordx4 v140, s[4:7], s28 offen offset:1024 lds
    s_add_u32 m0, s3, 4096
    s_nop 0
    buffer_load_dwordx4 v141, s[4:7], s28 offen lds
    buffer_load_dwordx4 v141, s[4:7], s28 offen offset:1024 lds
    s_add_u32 s28, s28, 4096
    s_lshl_b32 s26, s24, 13
    v_add_u32 v145, s26, v162
    v_and_b32 v157, 3, v153
    v_bfe_u32 v158, v153, 2, 2
    v_xor_b32 v159, v155, v157
    v_lshl_add_u32 v159, v159, 2, v158
    v_lshlrev_b32 v146, 8, v157
    v_lshl_add_u32 v146, v159, 4, v146
    v_lshl_add_u32 v146, v154, 3, v146
    s_add_u32 s26, s26, 4096
    v_add_u32 v146, s26, v146
    v_xor_b32 v147, 128, v146
    v_bfe_u32 v157, v153, 2, 1
    v_cmp_eq_u32 vcc, v157, v154
    v_mov_b32 v158, 0x3f803f80
    s_nop 0
    v_cndmask_b32 v136, 0, v158, vcc
    v_mov_b32 v137, v136
    v_mov_b32 v138, v136
    v_mov_b32 v139, v136
    v_mov_b32 v32, 0
    v_mov_b32 v33, 0
    v_mov_b32 v34, 0
    v_mov_b32 v35, 0
    v_mov_b32 v36, 0
    v_mov_b32 v37, 0
    v_mov_b32 v38, 0
    v_mov_b32 v39, 0
    v_mov_b32 v40, 0
    v_mov_b32 v41, 0
    v_mov_b32 v42, 0
    v_mov_b32 v43, 0
    v_mov_b32 v44, 0
    v_mov_b32 v45, 0
    v_mov_b32 v46, 0
    v_mov_b32 v47, 0
    v_mov_b32 v112, 0
    v_mov_b32 v113, 0
    v_mov_b32 v114, 0
    v_mov_b32 v115, 0
    v_mov_b32 v48, 0
    v_mov_b32 v49, 0
    v_mov_b32 v50, 0
    v_mov_b32 v51, 0
    v_mov_b32 v52, 0
    v_mov_b32 v53, 0
    v_mov_b32 v54, 0
    v_mov_b32 v55, 0
    v_mov_b32 v56, 0
    v_mov_b32 v57, 0
    v_mov_b32 v58, 0
    v_mov_b32 v59, 0
    v_mov_b32 v60, 0
    v_mov_b32 v61, 0
    v_mov_b32 v62, 0
    v_mov_b32 v63, 0
    v_mov_b32 v116, 0
    v_mov_b32 v117, 0
    v_mov_b32 v118, 0
    v_mov_b32 v119, 0
    v_mov_b32 v72, 0
    v_mov_b32 v73, 0
    v_mov_b32 v74, 0
    v_mov_b32 v75, 0
    v_mov_b32 v76, 0
    v_mov_b32 v77, 0
    v_mov_b32 v78, 0
    v_mov_b32 v79, 0
    v_mov_b32 v104, 0
    v_mov_b32 v105, 0
    v_mov_b32 v106, 0
    v_mov_b32 v107, 0
    v_mov_b32 v108, 0
    v_mov_b32 v109, 0
    v_mov_b32 v110, 0
    v_mov_b32 v111, 0
    s_waitcnt vmcnt(4)
    s_barrier
    ds_read_b128 v[80:83], v145 offset:0
    ds_read_b128 v[84:87], v145 offset:512
    s_add_u32 s3, s27, 32768
    s_add_u32 m0, s3, 0
    s_nop 0
    buffer_load_dwordx4 v140, s[4:7], s28 offen lds
    buffer_load_dwordx4 v140, s[4:7], s28 offen offset:1024 lds
    s_add_u32 m0, s3, 4096
    s_nop 0
    buffer_load_dwordx4 v141, s[4:7], s28 offen lds
    buffer_load_dwordx4 v141, s[4:7], s28 offen offset:1024 lds
    s_add_u32 s28, s28, 4096
    s_waitcnt lgkmcnt(1)
    v_mfma_f32_32x32x16_bf16 v[0:15], v[80:83], v[120:123], 0
    s_waitcnt lgkmcnt(0)
    v_mfma_f32_32x32x16_bf16 v[0:15], v[84:87], v[124:127], v[0:15]
    s_mov_b32 s29, 0
    s_mov_b32 s30, 16384
    s_mov_b32 s31, 32768
    s_mov_b32 s33, 16
k2_kernel_aloop:
    s_cmp_lg_u32 s33, 16
    s_cbranch_scc1 k2_kernel_ap0
    s_setprio 3
    s_cmp_eq_u32 s41, 0
    s_cbranch_scc1 k2_kernel_ap0
    s_setprio 1
k2_kernel_ap0:
    v_add_u32 v142, s29, v145
    v_add_u32 v143, s29, v146
    v_add_u32 v144, s29, v147
    v_add_u32 v148, s30, v145
    ds_read_b64_tr_b16 v[96:97], v143 offset:0
    ds_read_b64_tr_b16 v[98:99], v144 offset:0
    ds_read_b64_tr_b16 v[100:101], v143 offset:1024
    ds_read_b64_tr_b16 v[102:103], v144 offset:1024
    v_mfma_f32_32x32x16_bf16 v[16:31], v[80:83], v[128:131], 0
    v_exp_f32 v0, v0
    v_exp_f32 v1, v1
    v_exp_f32 v2, v2
    v_exp_f32 v3, v3
    v_mfma_f32_32x32x16_bf16 v[48:63], v[104:107], v[72:75], v[48:63]
    v_exp_f32 v4, v4
    v_exp_f32 v5, v5
    v_exp_f32 v6, v6
    v_exp_f32 v7, v7
    v_cvt_pk_bf16_f32 v64, v0, v1
    v_cvt_pk_bf16_f32 v65, v2, v3
    v_mfma_f32_16x16x32_bf16 v[116:119], v[136:139], v[72:75], v[116:119]
    v_cvt_pk_bf16_f32 v66, v4, v5
    v_cvt_pk_bf16_f32 v67, v6, v7
    ds_read_b128 v[88:91], v142 offset:2048
    ds_read_b128 v[92:95], v142 offset:2560
    v_mfma_f32_32x32x16_bf16 v[16:31], v[84:87], v[132:135], v[16:31]
    v_exp_f32 v8, v8
    v_exp_f32 v9, v9
    v_exp_f32 v10, v10
    v_exp_f32 v11, v11
    v_mfma_f32_32x32x16_bf16 v[48:63], v[108:111], v[76:79], v[48:63]
    v_exp_f32 v12, v12
    v_exp_f32 v13, v13
    v_exp_f32 v14, v14
    v_exp_f32 v15, v15
    v_cvt_pk_bf16_f32 v68, v8, v9
    v_cvt_pk_bf16_f32 v69, v10, v11
    v_mfma_f32_16x16x32_bf16 v[116:119], v[136:139], v[76:79], v[116:119]
    v_cvt_pk_bf16_f32 v70, v12, v13
    v_cvt_pk_bf16_f32 v71, v14, v15
    s_waitcnt lgkmcnt(1)
    v_mfma_f32_32x32x16_bf16 v[0:15], v[88:91], v[120:123], 0
    v_exp_f32 v16, v16
    v_exp_f32 v17, v17
    v_exp_f32 v18, v18
    v_exp_f32 v19, v19
    v_mfma_f32_32x32x16_bf16 v[32:47], v[96:99], v[64:67], v[32:47]
    v_exp_f32 v20, v20
    v_exp_f32 v21, v21
    v_exp_f32 v22, v22
    v_exp_f32 v23, v23
    v_cvt_pk_bf16_f32 v72, v16, v17
    v_cvt_pk_bf16_f32 v73, v18, v19
    v_mfma_f32_16x16x32_bf16 v[112:115], v[136:139], v[64:67], v[112:115]
    v_cvt_pk_bf16_f32 v74, v20, v21
    v_cvt_pk_bf16_f32 v75, v22, v23
    s_waitcnt lgkmcnt(0)
    v_mfma_f32_32x32x16_bf16 v[0:15], v[92:95], v[124:127], v[0:15]
    v_exp_f32 v24, v24
    v_exp_f32 v25, v25
    v_exp_f32 v26, v26
    v_exp_f32 v27, v27
    v_mfma_f32_32x32x16_bf16 v[32:47], v[100:103], v[68:71], v[32:47]
    v_exp_f32 v28, v28
    v_exp_f32 v29, v29
    v_exp_f32 v30, v30
    v_exp_f32 v31, v31
    v_cvt_pk_bf16_f32 v76, v24, v25
    v_cvt_pk_bf16_f32 v77, v26, v27
    v_mfma_f32_16x16x32_bf16 v[112:115], v[136:139], v[68:71], v[112:115]
    v_cvt_pk_bf16_f32 v78, v28, v29
    v_cvt_pk_bf16_f32 v79, v30, v31
    ds_read_b64_tr_b16 v[104:105], v143 offset:2048
    ds_read_b64_tr_b16 v[106:107], v144 offset:2048
    ds_read_b64_tr_b16 v[108:109], v143 offset:3072
    ds_read_b64_tr_b16 v[110:111], v144 offset:3072
    v_mfma_f32_32x32x16_bf16 v[16:31], v[88:91], v[128:131], 0
    v_exp_f32 v0, v0
    v_exp_f32 v1, v1
    v_exp_f32 v2, v2
    v_exp_f32 v3, v3
    v_mfma_f32_32x32x16_bf16 v[48:63], v[96:99], v[72:75], v[48:63]
    v_exp_f32 v4, v4
    v_exp_f32 v5, v5
    v_exp_f32 v6, v6
    v_exp_f32 v7, v7
    v_cvt_pk_bf16_f32 v64, v0, v1
    v_cvt_pk_bf16_f32 v65, v2, v3
    v_mfma_f32_16x16x32_bf16 v[116:119], v[136:139], v[72:75], v[116:119]
    v_cvt_pk_bf16_f32 v66, v4, v5
    v_cvt_pk_bf16_f32 v67, v6, v7
    s_cmp_le_u32 s33, 3
    s_cbranch_scc1 k2_kernel_anodma
    s_waitcnt vmcnt(4) lgkmcnt(0)
    s_barrier
    s_add_u32 s3, s27, s29
    s_add_u32 m0, s3, 0
    s_nop 0
    buffer_load_dwordx4 v140, s[4:7], s28 offen lds
    buffer_load_dwordx4 v140, s[4:7], s28 offen offset:1024 lds
    s_add_u32 m0, s3, 4096
    s_nop 0
    buffer_load_dwordx4 v141, s[4:7], s28 offen lds
    buffer_load_dwordx4 v141, s[4:7], s28 offen offset:1024 lds
    s_add_u32 s28, s28, 4096
    s_branch k2_kernel_ajoin
k2_kernel_anodma:
    s_waitcnt vmcnt(0) lgkmcnt(0)
    s_barrier
k2_kernel_ajoin:
    ds_read_b128 v[80:83], v148 offset:0
    ds_read_b128 v[84:87], v148 offset:512
    v_mfma_f32_32x32x16_bf16 v[16:31], v[92:95], v[132:135], v[16:31]
    v_exp_f32 v8, v8
    v_exp_f32 v9, v9
    v_exp_f32 v10, v10
    v_exp_f32 v11, v11
    v_mfma_f32_32x32x16_bf16 v[48:63], v[100:103], v[76:79], v[48:63]
    v_exp_f32 v12, v12
    v_exp_f32 v13, v13
    v_exp_f32 v14, v14
    v_exp_f32 v15, v15
    v_cvt_pk_bf16_f32 v68, v8, v9
    v_cvt_pk_bf16_f32 v69, v10, v11
    v_mfma_f32_16x16x32_bf16 v[116:119], v[136:139], v[76:79], v[116:119]
    v_cvt_pk_bf16_f32 v70, v12, v13
    v_cvt_pk_bf16_f32 v71, v14, v15
    s_waitcnt lgkmcnt(1)
    v_mfma_f32_32x32x16_bf16 v[0:15], v[80:83], v[120:123], 0
    v_exp_f32 v16, v16
    v_exp_f32 v17, v17
    v_exp_f32 v18, v18
    v_exp_f32 v19, v19
    v_mfma_f32_32x32x16_bf16 v[32:47], v[104:107], v[64:67], v[32:47]
    v_exp_f32 v20, v20
    v_exp_f32 v21, v21
    v_exp_f32 v22, v22
    v_exp_f32 v23, v23
    v_cvt_pk_bf16_f32 v72, v16, v17
    v_cvt_pk_bf16_f32 v73, v18, v19
    v_mfma_f32_16x16x32_bf16 v[112:115], v[136:139], v[64:67], v[112:115]
    v_cvt_pk_bf16_f32 v74, v20, v21
    v_cvt_pk_bf16_f32 v75, v22, v23
    s_waitcnt lgkmcnt(0)
    v_mfma_f32_32x32x16_bf16 v[0:15], v[84:87], v[124:127], v[0:15]
    v_exp_f32 v24, v24
    v_exp_f32 v25, v25
    v_exp_f32 v26, v26
    v_exp_f32 v27, v27
    v_mfma_f32_32x32x16_bf16 v[32:47], v[108:111], v[68:71], v[32:47]
    v_exp_f32 v28, v28
    v_exp_f32 v29, v29
    v_exp_f32 v30, v30
    v_exp_f32 v31, v31
    v_cvt_pk_bf16_f32 v76, v24, v25
    v_cvt_pk_bf16_f32 v77, v26, v27
    v_mfma_f32_16x16x32_bf16 v[112:115], v[136:139], v[68:71], v[112:115]
    v_cvt_pk_bf16_f32 v78, v28, v29
    v_cvt_pk_bf16_f32 v79, v30, v31
    s_mov_b32 s3, s29
    s_mov_b32 s29, s30
    s_mov_b32 s30, s31
    s_mov_b32 s31, s3
    s_sub_u32 s33, s33, 1
    s_cmp_lg_u32 s33, 0
    s_cbranch_scc1 k2_kernel_aloop
    v_mfma_f32_32x32x16_bf16 v[48:63], v[104:107], v[72:75], v[48:63]
    v_mfma_f32_16x16x32_bf16 v[116:119], v[136:139], v[72:75], v[116:119]
    v_mfma_f32_32x32x16_bf16 v[48:63], v[108:111], v[76:79], v[48:63]
    v_mfma_f32_16x16x32_bf16 v[116:119], v[136:139], v[76:79], v[116:119]
k2_kernel_merge:
    s_setprio 3
    s_mul_i32 s26, s20, 4608
    v_lshlrev_b32 v154, 4, v153
    v_lshlrev_b32 v155, 2, v153
    s_xor_b32 s3, s20, 2
    s_mul_i32 s3, s3, 4608
    v_add_u32 v156, s3, v154
    v_add_u32 v157, s3, v155
    v_add_u32 v154, s26, v154
    v_add_u32 v155, s26, v155
    s_waitcnt lgkmcnt(0)
    s_barrier
    s_cmp_lg_u32 s24, 0
    s_cbranch_scc1 k2_kernel_h1
    s_nop 7
    ds_write_b128 v154, v[48:51] offset:0
    ds_write_b128 v154, v[52:55] offset:1024
    ds_write_b128 v154, v[56:59] offset:2048
    ds_write_b128 v154, v[60:63] offset:3072
    ds_write_b32 v155, v116 offset:4096
    v_bfe_u32 v164, v153, 4, 1
    v_mul_u32_u24 v164, 147456, v164
    v_lshrrev_b32 v165, 5, v153
    v_lshl_add_u32 v164, v165, 8, v164
    v_and_b32 v165, 15, v153
    v_lshl_add_u32 v164, v165, 4, v164
    s_lshl_b32 s3, s22, 3
    s_lshl_b32 s26, s23, 2
    s_add_u32 s3, s3, s26
    s_add_u32 s3, s3, 0
    s_mul_i32 s3, s3, 147456
    s_lshl_b32 s26, s21, 10
    s_add_u32 s3, s3, s26
    s_add_u32 s26, s3, 16777216
    s_waitcnt lgkmcnt(0)
    s_barrier
    ds_read_b32 v16, v157 offset:4096
    ds_read_b128 v[0:3], v156 offset:0
    ds_read_b128 v[4:7], v156 offset:1024
    ds_read_b128 v[8:11], v156 offset:2048
    ds_read_b128 v[12:15], v156 offset:3072
    s_waitcnt lgkmcnt(4)
    v_add_f32 v16, v16, v112
    v_mov_b32 v159, 0x5d800000
    v_cmp_nlt_f32 vcc, v16, v159
    s_nop 0
    s_mov_b64 s[36:37], vcc
    v_mov_b32 v159, 0x21800000
    v_cmp_ngt_f32 vcc, v16, v159
    s_nop 0
    s_or_b64 s[36:37], s[36:37], vcc
    s_cmp_lg_u64 s[36:37], 0
    s_cselect_b32 s38, 1, 0
    v_mov_b32 v158, s38
    s_lshl_b32 s3, s20, 2
    s_add_u32 s3, s3, 49152
    v_mov_b32 v159, s3
    ds_write_b32 v159, v158
    v_rcp_f32 v16, v16
    s_waitcnt lgkmcnt(4)
    v_add_f32 v0, v0, v32
    v_add_f32 v1, v1, v33
    v_add_f32 v2, v2, v34
    v_add_f32 v3, v3, v35
    s_waitcnt lgkmcnt(3)
    v_add_f32 v4, v4, v36
    v_add_f32 v5, v5, v37
    v_add_f32 v6, v6, v38
    v_add_f32 v7, v7, v39
    s_waitcnt lgkmcnt(2)
    v_add_f32 v8, v8, v40
    v_add_f32 v9, v9, v41
    v_add_f32 v10, v10, v42
    v_add_f32 v11, v11, v43
    s_waitcnt lgkmcnt(1)
    v_add_f32 v12, v12, v44
    v_add_f32 v13, v13, v45
    v_add_f32 v14, v14, v46
    v_add_f32 v15, v15, v47
    s_waitcnt lgkmcnt(0)
    s_barrier
    v_mov_b32 v159, 49152
    ds_read_b128 v[80:83], v159
    v_mul_f32 v0, v0, v16
    v_mul_f32 v1, v1, v16
    v_mul_f32 v2, v2, v16
    v_mul_f32 v3, v3, v16
    v_mul_f32 v4, v4, v16
    v_mul_f32 v5, v5, v16
    v_mul_f32 v6, v6, v16
    v_mul_f32 v7, v7, v16
    v_mul_f32 v8, v8, v16
    v_mul_f32 v9, v9, v16
    v_mul_f32 v10, v10, v16
    v_mul_f32 v11, v11, v16
    v_mul_f32 v12, v12, v16
    v_mul_f32 v13, v13, v16
    v_mul_f32 v14, v14, v16
    v_mul_f32 v15, v15, v16
    v_cvt_pk_bf16_f32 v64, v0, v1
    v_cvt_pk_bf16_f32 v65, v2, v3
    v_cvt_pk_bf16_f32 v66, v8, v9
    v_cvt_pk_bf16_f32 v67, v10, v11
    v_cvt_pk_bf16_f32 v68, v4, v5
    v_cvt_pk_bf16_f32 v69, v6, v7
    v_cvt_pk_bf16_f32 v70, v12, v13
    v_cvt_pk_bf16_f32 v71, v14, v15
    s_waitcnt lgkmcnt(0)
    v_or3_b32 v80, v80, v81, v82
    v_or_b32 v80, v80, v83
    s_nop 0
    v_readfirstlane_b32 s38, v80
    s_nop 0
    s_andn2_b32 s38, s38, s40
    s_cmp_lg_u32 s38, 0
    s_cbranch_scc1 k2_kernel_fallback
    buffer_store_dwordx4 v[64:67], v164, s[4:7], s26 offen sc1
    buffer_store_dwordx4 v[68:71], v164, s[4:7], s26 offen offset:512 sc1
    s_lshl_b32 s3, s22, 1
    s_add_u32 s3, s3, s41
    s_lshl_b32 s3, s3, 2
    s_lshl_b32 s26, s23, 1
    s_add_u32 s3, s3, s26
    s_add_u32 s3, s3, 0
    s_lshl_b32 s3, s3, 7
    s_add_u32 s3, s3, 62914560
    v_mov_b32 v165, 1
    v_mov_b32 v166, 0
    s_mov_b64 exec, 1
    s_waitcnt vmcnt(0)
    buffer_atomic_add v165, v166, s[4:7], s3 offen sc1
    s_mov_b64 exec, -1
    s_endpgm
k2_kernel_h1:
    s_nop 7
    ds_write_b128 v154, v[32:35] offset:0
    ds_write_b128 v154, v[36:39] offset:1024
    ds_write_b128 v154, v[40:43] offset:2048
    ds_write_b128 v154, v[44:47] offset:3072
    ds_write_b32 v155, v112 offset:4096
    v_bfe_u32 v164, v153, 4, 1
    v_mul_u32_u24 v164, 147456, v164
    v_lshrrev_b32 v165, 5, v153
    v_lshl_add_u32 v164, v165, 8, v164
    v_and_b32 v165, 15, v153
    v_lshl_add_u32 v164, v165, 4, v164
    s_lshl_b32 s3, s22, 3
    s_lshl_b32 s26, s23, 2
    s_add_u32 s3, s3, s26
    s_add_u32 s3, s3, 2
    s_mul_i32 s3, s3, 147456
    s_lshl_b32 s26, s21, 10
    s_add_u32 s3, s3, s26
    s_add_u32 s26, s3, 16777216
    s_waitcnt lgkmcnt(0)
    s_barrier
    ds_read_b32 v16, v157 offset:4096
    ds_read_b128 v[0:3], v156 offset:0
    ds_read_b128 v[4:7], v156 offset:1024
    ds_read_b128 v[8:11], v156 offset:2048
    ds_read_b128 v[12:15], v156 offset:3072
    s_waitcnt lgkmcnt(4)
    v_add_f32 v16, v16, v116
    v_mov_b32 v159, 0x5d800000
    v_cmp_nlt_f32 vcc, v16, v159
    s_nop 0
    s_mov_b64 s[36:37], vcc
    v_mov_b32 v159, 0x21800000
    v_cmp_ngt_f32 vcc, v16, v159
    s_nop 0
    s_or_b64 s[36:37], s[36:37], vcc
    s_cmp_lg_u64 s[36:37], 0
    s_cselect_b32 s38, 1, 0
    v_mov_b32 v158, s38
    s_lshl_b32 s3, s20, 2
    s_add_u32 s3, s3, 49152
    v_mov_b32 v159, s3
    ds_write_b32 v159, v158
    v_rcp_f32 v16, v16
    s_waitcnt lgkmcnt(4)
    v_add_f32 v0, v0, v48
    v_add_f32 v1, v1, v49
    v_add_f32 v2, v2, v50
    v_add_f32 v3, v3, v51
    s_waitcnt lgkmcnt(3)
    v_add_f32 v4, v4, v52
    v_add_f32 v5, v5, v53
    v_add_f32 v6, v6, v54
    v_add_f32 v7, v7, v55
    s_waitcnt lgkmcnt(2)
    v_add_f32 v8, v8, v56
    v_add_f32 v9, v9, v57
    v_add_f32 v10, v10, v58
    v_add_f32 v11, v11, v59
    s_waitcnt lgkmcnt(1)
    v_add_f32 v12, v12, v60
    v_add_f32 v13, v13, v61
    v_add_f32 v14, v14, v62
    v_add_f32 v15, v15, v63
    s_waitcnt lgkmcnt(0)
    s_barrier
    v_mov_b32 v159, 49152
    ds_read_b128 v[80:83], v159
    v_mul_f32 v0, v0, v16
    v_mul_f32 v1, v1, v16
    v_mul_f32 v2, v2, v16
    v_mul_f32 v3, v3, v16
    v_mul_f32 v4, v4, v16
    v_mul_f32 v5, v5, v16
    v_mul_f32 v6, v6, v16
    v_mul_f32 v7, v7, v16
    v_mul_f32 v8, v8, v16
    v_mul_f32 v9, v9, v16
    v_mul_f32 v10, v10, v16
    v_mul_f32 v11, v11, v16
    v_mul_f32 v12, v12, v16
    v_mul_f32 v13, v13, v16
    v_mul_f32 v14, v14, v16
    v_mul_f32 v15, v15, v16
    v_cvt_pk_bf16_f32 v64, v0, v1
    v_cvt_pk_bf16_f32 v65, v2, v3
    v_cvt_pk_bf16_f32 v66, v8, v9
    v_cvt_pk_bf16_f32 v67, v10, v11
    v_cvt_pk_bf16_f32 v68, v4, v5
    v_cvt_pk_bf16_f32 v69, v6, v7
    v_cvt_pk_bf16_f32 v70, v12, v13
    v_cvt_pk_bf16_f32 v71, v14, v15
    s_waitcnt lgkmcnt(0)
    v_or3_b32 v80, v80, v81, v82
    v_or_b32 v80, v80, v83
    s_nop 0
    v_readfirstlane_b32 s38, v80
    s_nop 0
    s_andn2_b32 s38, s38, s40
    s_cmp_lg_u32 s38, 0
    s_cbranch_scc1 k2_kernel_fallback
    buffer_store_dwordx4 v[64:67], v164, s[4:7], s26 offen sc1
    buffer_store_dwordx4 v[68:71], v164, s[4:7], s26 offen offset:512 sc1
    s_lshl_b32 s3, s22, 1
    s_add_u32 s3, s3, s41
    s_lshl_b32 s3, s3, 2
    s_lshl_b32 s26, s23, 1
    s_add_u32 s3, s3, s26
    s_add_u32 s3, s3, 1
    s_lshl_b32 s3, s3, 7
    s_add_u32 s3, s3, 62914560
    v_mov_b32 v165, 1
    v_mov_b32 v166, 0
    s_mov_b64 exec, 1
    s_waitcnt vmcnt(0)
    buffer_atomic_add v165, v166, s[4:7], s3 offen sc1
    s_mov_b64 exec, -1
    s_endpgm
k2_kernel_fallback:
    s_mov_b32 s40, 1
    v_mov_b32 v150, 0xff800000
    v_mov_b32 v151, 0xff800000
    s_add_u32 s28, s21, 32
    s_lshl_b32 s28, s28, 17
    s_add_u32 s28, s28, 4194304
    s_lshl_b32 s3, s24, 16
    s_add_u32 s28, s28, s3
    s_mov_b32 s33, 32
k2_kernel_fbloop:
    buffer_load_dwordx4 v[80:83], v162, s[4:7], s28 offen
    buffer_load_dwordx4 v[84:87], v162, s[4:7], s28 offen offset:512
    s_waitcnt vmcnt(0)
    v_mfma_f32_32x32x16_bf16 v[0:15], v[80:83], v[120:123], 0
    v_mfma_f32_32x32x16_bf16 v[0:15], v[84:87], v[124:127], v[0:15]
    v_mfma_f32_32x32x16_bf16 v[16:31], v[80:83], v[128:131], 0
    v_mfma_f32_32x32x16_bf16 v[16:31], v[84:87], v[132:135], v[16:31]
    s_nop 9
    v_max3_f32 v150, v150, v0, v1
    v_max3_f32 v150, v150, v2, v3
    v_max3_f32 v150, v150, v4, v5
    v_max3_f32 v150, v150, v6, v7
    v_max3_f32 v150, v150, v8, v9
    v_max3_f32 v150, v150, v10, v11
    v_max3_f32 v150, v150, v12, v13
    v_max3_f32 v150, v150, v14, v15
    v_max3_f32 v151, v151, v16, v17
    v_max3_f32 v151, v151, v18, v19
    v_max3_f32 v151, v151, v20, v21
    v_max3_f32 v151, v151, v22, v23
    v_max3_f32 v151, v151, v24, v25
    v_max3_f32 v151, v151, v26, v27
    v_max3_f32 v151, v151, v28, v29
    v_max3_f32 v151, v151, v30, v31
    s_add_u32 s28, s28, 2048
    s_sub_u32 s33, s33, 1
    s_cmp_lg_u32 s33, 0
    s_cbranch_scc1 k2_kernel_fbloop
    v_mov_b32 v154, v150
    s_nop 1
    v_permlane32_swap_b32 v150, v154
    v_max_f32 v150, v150, v154
    v_mov_b32 v154, v151
    s_nop 1
    v_permlane32_swap_b32 v151, v154
    v_max_f32 v151, v151, v154
    s_lshl_b32 s3, s20, 9
    v_lshlrev_b32 v154, 3, v153
    v_add_u32 v155, s3, v154
    s_xor_b32 s3, s3, 1024
    v_add_u32 v154, s3, v154
    s_barrier
    ds_write_b64 v155, v[150:151]
    s_waitcnt lgkmcnt(0)
    s_barrier
    ds_read_b64 v[156:157], v154
    s_waitcnt lgkmcnt(0)
    v_max_f32 v150, v150, v156
    v_max_f32 v151, v151, v157
    s_barrier
    s_mov_b32 s28, s25
    s_add_u32 s3, s27, 0
    s_add_u32 m0, s3, 0
    s_nop 0
    buffer_load_dwordx4 v140, s[4:7], s28 offen lds
    buffer_load_dwordx4 v140, s[4:7], s28 offen offset:1024 lds
    s_add_u32 m0, s3, 4096
    s_nop 0
    buffer_load_dwordx4 v141, s[4:7], s28 offen lds
    buffer_load_dwordx4 v141, s[4:7], s28 offen offset:1024 lds
    s_add_u32 s28, s28, 4096
    s_add_u32 s3, s27, 16384
    s_add_u32 m0, s3, 0
    s_nop 0
    buffer_load_dwordx4 v140, s[4:7], s28 offen lds
    buffer_load_dwordx4 v140, s[4:7], s28 offen offset:1024 lds
    s_add_u32 m0, s3, 4096
    s_nop 0
    buffer_load_dwordx4 v141, s[4:7], s28 offen lds
    buffer_load_dwordx4 v141, s[4:7], s28 offen offset:1024 lds
    s_add_u32 s28, s28, 4096
    v_mov_b32 v32, 0
    v_mov_b32 v33, 0
    v_mov_b32 v34, 0
    v_mov_b32 v35, 0
    v_mov_b32 v36, 0
    v_mov_b32 v37, 0
    v_mov_b32 v38, 0
    v_mov_b32 v39, 0
    v_mov_b32 v40, 0
    v_mov_b32 v41, 0
    v_mov_b32 v42, 0
    v_mov_b32 v43, 0
    v_mov_b32 v44, 0
    v_mov_b32 v45, 0
    v_mov_b32 v46, 0
    v_mov_b32 v47, 0
    v_mov_b32 v112, 0
    v_mov_b32 v113, 0
    v_mov_b32 v114, 0
    v_mov_b32 v115, 0
    v_mov_b32 v48, 0
    v_mov_b32 v49, 0
    v_mov_b32 v50, 0
    v_mov_b32 v51, 0
    v_mov_b32 v52, 0
    v_mov_b32 v53, 0
    v_mov_b32 v54, 0
    v_mov_b32 v55, 0
    v_mov_b32 v56, 0
    v_mov_b32 v57, 0
    v_mov_b32 v58, 0
    v_mov_b32 v59, 0
    v_mov_b32 v60, 0
    v_mov_b32 v61, 0
    v_mov_b32 v62, 0
    v_mov_b32 v63, 0
    v_mov_b32 v116, 0
    v_mov_b32 v117, 0
    v_mov_b32 v118, 0
    v_mov_b32 v119, 0
    v_mov_b32 v72, 0
    v_mov_b32 v73, 0
    v_mov_b32 v74, 0
    v_mov_b32 v75, 0
    v_mov_b32 v76, 0
    v_mov_b32 v77, 0
    v_mov_b32 v78, 0
    v_mov_b32 v79, 0
    v_mov_b32 v104, 0
    v_mov_b32 v105, 0
    v_mov_b32 v106, 0
    v_mov_b32 v107, 0
    v_mov_b32 v108, 0
    v_mov_b32 v109, 0
    v_mov_b32 v110, 0
    v_mov_b32 v111, 0
    s_waitcnt vmcnt(4)
    s_barrier
    ds_read_b128 v[80:83], v145 offset:0
    ds_read_b128 v[84:87], v145 offset:512
    s_add_u32 s3, s27, 32768
    s_add_u32 m0, s3, 0
    s_nop 0
    buffer_load_dwordx4 v140, s[4:7], s28 offen lds
    buffer_load_dwordx4 v140, s[4:7], s28 offen offset:1024 lds
    s_add_u32 m0, s3, 4096
    s_nop 0
    buffer_load_dwordx4 v141, s[4:7], s28 offen lds
    buffer_load_dwordx4 v141, s[4:7], s28 offen offset:1024 lds
    s_add_u32 s28, s28, 4096
    s_waitcnt lgkmcnt(1)
    v_mfma_f32_32x32x16_bf16 v[0:15], v[80:83], v[120:123], 0
    s_waitcnt lgkmcnt(0)
    v_mfma_f32_32x32x16_bf16 v[0:15], v[84:87], v[124:127], v[0:15]
    s_mov_b32 s29, 0
    s_mov_b32 s30, 16384
    s_mov_b32 s31, 32768
    s_mov_b32 s33, 16
k2_kernel_floop:
    v_add_u32 v142, s29, v145
    v_add_u32 v143, s29, v146
    v_add_u32 v144, s29, v147
    v_add_u32 v148, s30, v145
    ds_read_b64_tr_b16 v[96:97], v143 offset:0
    ds_read_b64_tr_b16 v[98:99], v144 offset:0
    ds_read_b64_tr_b16 v[100:101], v143 offset:1024
    ds_read_b64_tr_b16 v[102:103], v144 offset:1024
    v_mfma_f32_32x32x16_bf16 v[16:31], v[80:83], v[128:131], 0
    v_sub_f32 v0, v0, v150
    v_sub_f32 v1, v1, v150
    v_sub_f32 v2, v2, v150
    v_sub_f32 v3, v3, v150
    v_exp_f32 v0, v0
    v_exp_f32 v1, v1
    v_exp_f32 v2, v2
    v_exp_f32 v3, v3
    v_mfma_f32_32x32x16_bf16 v[48:63], v[104:107], v[72:75], v[48:63]
    v_sub_f32 v4, v4, v150
    v_sub_f32 v5, v5, v150
    v_sub_f32 v6, v6, v150
    v_sub_f32 v7, v7, v150
    v_exp_f32 v4, v4
    v_exp_f32 v5, v5
    v_exp_f32 v6, v6
    v_exp_f32 v7, v7
    v_cvt_pk_bf16_f32 v64, v0, v1
    v_cvt_pk_bf16_f32 v65, v2, v3
    v_mfma_f32_16x16x32_bf16 v[116:119], v[136:139], v[72:75], v[116:119]
    v_cvt_pk_bf16_f32 v66, v4, v5
    v_cvt_pk_bf16_f32 v67, v6, v7
    ds_read_b128 v[88:91], v142 offset:2048
    ds_read_b128 v[92:95], v142 offset:2560
    v_mfma_f32_32x32x16_bf16 v[16:31], v[84:87], v[132:135], v[16:31]
    v_sub_f32 v8, v8, v150
    v_sub_f32 v9, v9, v150
    v_sub_f32 v10, v10, v150
    v_sub_f32 v11, v11, v150
    v_exp_f32 v8, v8
    v_exp_f32 v9, v9
    v_exp_f32 v10, v10
    v_exp_f32 v11, v11
    v_mfma_f32_32x32x16_bf16 v[48:63], v[108:111], v[76:79], v[48:63]
    v_sub_f32 v12, v12, v150
    v_sub_f32 v13, v13, v150
    v_sub_f32 v14, v14, v150
    v_sub_f32 v15, v15, v150
    v_exp_f32 v12, v12
    v_exp_f32 v13, v13
    v_exp_f32 v14, v14
    v_exp_f32 v15, v15
    v_cvt_pk_bf16_f32 v68, v8, v9
    v_cvt_pk_bf16_f32 v69, v10, v11
    v_mfma_f32_16x16x32_bf16 v[116:119], v[136:139], v[76:79], v[116:119]
    v_cvt_pk_bf16_f32 v70, v12, v13
    v_cvt_pk_bf16_f32 v71, v14, v15
    s_waitcnt lgkmcnt(1)
    v_mfma_f32_32x32x16_bf16 v[0:15], v[88:91], v[120:123], 0
    v_sub_f32 v16, v16, v151
    v_sub_f32 v17, v17, v151
    v_sub_f32 v18, v18, v151
    v_sub_f32 v19, v19, v151
    v_exp_f32 v16, v16
    v_exp_f32 v17, v17
    v_exp_f32 v18, v18
    v_exp_f32 v19, v19
    v_mfma_f32_32x32x16_bf16 v[32:47], v[96:99], v[64:67], v[32:47]
    v_sub_f32 v20, v20, v151
    v_sub_f32 v21, v21, v151
    v_sub_f32 v22, v22, v151
    v_sub_f32 v23, v23, v151
    v_exp_f32 v20, v20
    v_exp_f32 v21, v21
    v_exp_f32 v22, v22
    v_exp_f32 v23, v23
    v_cvt_pk_bf16_f32 v72, v16, v17
    v_cvt_pk_bf16_f32 v73, v18, v19
    v_mfma_f32_16x16x32_bf16 v[112:115], v[136:139], v[64:67], v[112:115]
    v_cvt_pk_bf16_f32 v74, v20, v21
    v_cvt_pk_bf16_f32 v75, v22, v23
    s_waitcnt lgkmcnt(0)
    v_mfma_f32_32x32x16_bf16 v[0:15], v[92:95], v[124:127], v[0:15]
    v_sub_f32 v24, v24, v151
    v_sub_f32 v25, v25, v151
    v_sub_f32 v26, v26, v151
    v_sub_f32 v27, v27, v151
    v_exp_f32 v24, v24
    v_exp_f32 v25, v25
    v_exp_f32 v26, v26
    v_exp_f32 v27, v27
    v_mfma_f32_32x32x16_bf16 v[32:47], v[100:103], v[68:71], v[32:47]
    v_sub_f32 v28, v28, v151
    v_sub_f32 v29, v29, v151
    v_sub_f32 v30, v30, v151
    v_sub_f32 v31, v31, v151
    v_exp_f32 v28, v28
    v_exp_f32 v29, v29
    v_exp_f32 v30, v30
    v_exp_f32 v31, v31
    v_cvt_pk_bf16_f32 v76, v24, v25
    v_cvt_pk_bf16_f32 v77, v26, v27
    v_mfma_f32_16x16x32_bf16 v[112:115], v[136:139], v[68:71], v[112:115]
    v_cvt_pk_bf16_f32 v78, v28, v29
    v_cvt_pk_bf16_f32 v79, v30, v31
    ds_read_b64_tr_b16 v[104:105], v143 offset:2048
    ds_read_b64_tr_b16 v[106:107], v144 offset:2048
    ds_read_b64_tr_b16 v[108:109], v143 offset:3072
    ds_read_b64_tr_b16 v[110:111], v144 offset:3072
    v_mfma_f32_32x32x16_bf16 v[16:31], v[88:91], v[128:131], 0
    v_sub_f32 v0, v0, v150
    v_sub_f32 v1, v1, v150
    v_sub_f32 v2, v2, v150
    v_sub_f32 v3, v3, v150
    v_exp_f32 v0, v0
    v_exp_f32 v1, v1
    v_exp_f32 v2, v2
    v_exp_f32 v3, v3
    v_mfma_f32_32x32x16_bf16 v[48:63], v[96:99], v[72:75], v[48:63]
    v_sub_f32 v4, v4, v150
    v_sub_f32 v5, v5, v150
    v_sub_f32 v6, v6, v150
    v_sub_f32 v7, v7, v150
    v_exp_f32 v4, v4
    v_exp_f32 v5, v5
    v_exp_f32 v6, v6
    v_exp_f32 v7, v7
    v_cvt_pk_bf16_f32 v64, v0, v1
    v_cvt_pk_bf16_f32 v65, v2, v3
    v_mfma_f32_16x16x32_bf16 v[116:119], v[136:139], v[72:75], v[116:119]
    v_cvt_pk_bf16_f32 v66, v4, v5
    v_cvt_pk_bf16_f32 v67, v6, v7
    s_cmp_le_u32 s33, 3
    s_cbranch_scc1 k2_kernel_fnodma
    s_waitcnt vmcnt(4) lgkmcnt(0)
    s_barrier
    s_add_u32 s3, s27, s29
    s_add_u32 m0, s3, 0
    s_nop 0
    buffer_load_dwordx4 v140, s[4:7], s28 offen lds
    buffer_load_dwordx4 v140, s[4:7], s28 offen offset:1024 lds
    s_add_u32 m0, s3, 4096
    s_nop 0
    buffer_load_dwordx4 v141, s[4:7], s28 offen lds
    buffer_load_dwordx4 v141, s[4:7], s28 offen offset:1024 lds
    s_add_u32 s28, s28, 4096
    s_branch k2_kernel_fjoin
k2_kernel_fnodma:
    s_waitcnt vmcnt(0) lgkmcnt(0)
    s_barrier
k2_kernel_fjoin:
    ds_read_b128 v[80:83], v148 offset:0
    ds_read_b128 v[84:87], v148 offset:512
    v_mfma_f32_32x32x16_bf16 v[16:31], v[92:95], v[132:135], v[16:31]
    v_sub_f32 v8, v8, v150
    v_sub_f32 v9, v9, v150
    v_sub_f32 v10, v10, v150
    v_sub_f32 v11, v11, v150
    v_exp_f32 v8, v8
    v_exp_f32 v9, v9
    v_exp_f32 v10, v10
    v_exp_f32 v11, v11
    v_mfma_f32_32x32x16_bf16 v[48:63], v[100:103], v[76:79], v[48:63]
    v_sub_f32 v12, v12, v150
    v_sub_f32 v13, v13, v150
    v_sub_f32 v14, v14, v150
    v_sub_f32 v15, v15, v150
    v_exp_f32 v12, v12
    v_exp_f32 v13, v13
    v_exp_f32 v14, v14
    v_exp_f32 v15, v15
    v_cvt_pk_bf16_f32 v68, v8, v9
    v_cvt_pk_bf16_f32 v69, v10, v11
    v_mfma_f32_16x16x32_bf16 v[116:119], v[136:139], v[76:79], v[116:119]
    v_cvt_pk_bf16_f32 v70, v12, v13
    v_cvt_pk_bf16_f32 v71, v14, v15
    s_waitcnt lgkmcnt(1)
    v_mfma_f32_32x32x16_bf16 v[0:15], v[80:83], v[120:123], 0
    v_sub_f32 v16, v16, v151
    v_sub_f32 v17, v17, v151
    v_sub_f32 v18, v18, v151
    v_sub_f32 v19, v19, v151
    v_exp_f32 v16, v16
    v_exp_f32 v17, v17
    v_exp_f32 v18, v18
    v_exp_f32 v19, v19
    v_mfma_f32_32x32x16_bf16 v[32:47], v[104:107], v[64:67], v[32:47]
    v_sub_f32 v20, v20, v151
    v_sub_f32 v21, v21, v151
    v_sub_f32 v22, v22, v151
    v_sub_f32 v23, v23, v151
    v_exp_f32 v20, v20
    v_exp_f32 v21, v21
    v_exp_f32 v22, v22
    v_exp_f32 v23, v23
    v_cvt_pk_bf16_f32 v72, v16, v17
    v_cvt_pk_bf16_f32 v73, v18, v19
    v_mfma_f32_16x16x32_bf16 v[112:115], v[136:139], v[64:67], v[112:115]
    v_cvt_pk_bf16_f32 v74, v20, v21
    v_cvt_pk_bf16_f32 v75, v22, v23
    s_waitcnt lgkmcnt(0)
    v_mfma_f32_32x32x16_bf16 v[0:15], v[84:87], v[124:127], v[0:15]
    v_sub_f32 v24, v24, v151
    v_sub_f32 v25, v25, v151
    v_sub_f32 v26, v26, v151
    v_sub_f32 v27, v27, v151
    v_exp_f32 v24, v24
    v_exp_f32 v25, v25
    v_exp_f32 v26, v26
    v_exp_f32 v27, v27
    v_mfma_f32_32x32x16_bf16 v[32:47], v[108:111], v[68:71], v[32:47]
    v_sub_f32 v28, v28, v151
    v_sub_f32 v29, v29, v151
    v_sub_f32 v30, v30, v151
    v_sub_f32 v31, v31, v151
    v_exp_f32 v28, v28
    v_exp_f32 v29, v29
    v_exp_f32 v30, v30
    v_exp_f32 v31, v31
    v_cvt_pk_bf16_f32 v76, v24, v25
    v_cvt_pk_bf16_f32 v77, v26, v27
    v_mfma_f32_16x16x32_bf16 v[112:115], v[136:139], v[68:71], v[112:115]
    v_cvt_pk_bf16_f32 v78, v28, v29
    v_cvt_pk_bf16_f32 v79, v30, v31
    s_mov_b32 s3, s29
    s_mov_b32 s29, s30
    s_mov_b32 s30, s31
    s_mov_b32 s31, s3
    s_sub_u32 s33, s33, 1
    s_cmp_lg_u32 s33, 0
    s_cbranch_scc1 k2_kernel_floop
    v_mfma_f32_32x32x16_bf16 v[48:63], v[104:107], v[72:75], v[48:63]
    v_mfma_f32_16x16x32_bf16 v[116:119], v[136:139], v[72:75], v[116:119]
    v_mfma_f32_32x32x16_bf16 v[48:63], v[108:111], v[76:79], v[48:63]
    v_mfma_f32_16x16x32_bf16 v[116:119], v[136:139], v[76:79], v[116:119]
    s_branch k2_kernel_merge
k2_kernel_gemm:
    s_load_dwordx2 s[38:39], s[0:1], 16
    s_load_dwordx2 s[40:41], s[0:1], 0
    s_load_dwordx2 s[42:43], s[0:1], 56
    s_and_b32 s24, s2, 1
    s_bfe_u32 s21, s2, 0x20001
    s_lshl_b32 s21, s21, 2
    s_bfe_u32 s3, s2, 0x20003
    s_add_u32 s21, s21, s3
    s_bfe_u32 s22, s2, 0x30005
    s_lshl_b32 s46, s22, 8
    s_lshl_b32 s3, s24, 7
    s_add_u32 s46, s46, s3
    v_lshrrev_b32 v154, 4, v153
    v_lshrrev_b32 v155, 3, v153
    v_bfe_u32 v156, v153, 1, 2
    v_xor_b32 v156, v156, v154
    v_and_b32 v158, 1, v153
    v_lshl_or_b32 v156, v156, 1, v158
    v_lshlrev_b32 v150, 11, v155
    v_lshl_add_u32 v150, v156, 4, v150
    s_lshl_b32 s3, s20, 15
    s_add_u32 s3, s3, s46
    v_add_u32 v150, s3, v150
    v_add_u32 v151, 16384, v150
    s_mov_b32 s25, 0
    s_lshl_b32 s29, s20, 11
    s_lshl_b32 s3, s21, 3
    s_lshl_b32 s26, s20, 1
    s_add_u32 s23, s3, s26
    s_mul_i32 s3, s23, 147456
    s_add_u32 s3, s3, 16777216
    v_lshlrev_b32 v157, 4, v153
    v_add_u32 v148, s3, v157
    v_add_u32 v149, 147456, v148
    s_mov_b32 s26, 32768
    v_and_b32 v162, 15, v153
    v_lshlrev_b32 v162, 11, v162
    v_lshl_add_u32 v162, v154, 3, v162
    s_lshl_b32 s3, s23, 15
    s_add_u32 s3, s3, s46
    v_add_u32 v162, s3, v162
    v_add_u32 v163, 32768, v162
    s_waitcnt lgkmcnt(0)
    s_mov_b32 s4, s34
    s_and_b32 s5, s35, 0xffff
    s_mov_b32 s6, 0x10000000
    s_mov_b32 s7, 0x00020000
    s_mov_b32 s8, s36
    s_and_b32 s9, s37, 0xffff
    s_mov_b32 s10, 0x700000
    s_mov_b32 s11, 0x00020000
    s_mov_b32 s12, s40
    s_and_b32 s13, s41, 0xffff
    s_mov_b32 s14, 0x400000
    s_mov_b32 s15, 0x00020000
    s_add_u32 m0, s29, 0
    s_nop 0
    buffer_load_dwordx4 v150, s[8:11], s25 offen lds
    s_add_u32 m0, s29, 1024
    s_nop 0
    buffer_load_dwordx4 v151, s[8:11], s25 offen lds
    buffer_load_dwordx4 v[32:35], v148, s[4:7], s26 offen offset:0
    buffer_load_dwordx4 v[36:39], v148, s[4:7], s26 offen offset:1024
    buffer_load_dwordx4 v[40:43], v149, s[4:7], s26 offen offset:0
    buffer_load_dwordx4 v[44:47], v149, s[4:7], s26 offen offset:1024
    s_add_u32 s25, s25, 131072
    s_add_u32 s26, s26, 2048
    buffer_load_dwordx2 v[112:113], v162, s[12:15], 0 offen offset:0
    buffer_load_dwordx2 v[114:115], v162, s[12:15], 0 offen offset:32
    buffer_load_dwordx2 v[116:117], v162, s[12:15], 0 offen offset:64
    buffer_load_dwordx2 v[118:119], v162, s[12:15], 0 offen offset:96
    buffer_load_dwordx2 v[120:121], v163, s[12:15], 0 offen offset:0
    buffer_load_dwordx2 v[122:123], v163, s[12:15], 0 offen offset:32
    buffer_load_dwordx2 v[124:125], v163, s[12:15], 0 offen offset:64
    buffer_load_dwordx2 v[126:127], v163, s[12:15], 0 offen offset:96
    s_add_u32 m0, s29, 8192
    s_nop 0
    buffer_load_dwordx4 v150, s[8:11], s25 offen lds
    s_add_u32 m0, s29, 9216
    s_nop 0
    buffer_load_dwordx4 v151, s[8:11], s25 offen lds
    buffer_load_dwordx4 v[48:51], v148, s[4:7], s26 offen offset:0
    buffer_load_dwordx4 v[52:55], v148, s[4:7], s26 offen offset:1024
    buffer_load_dwordx4 v[56:59], v149, s[4:7], s26 offen offset:0
    buffer_load_dwordx4 v[60:63], v149, s[4:7], s26 offen offset:1024
    s_add_u32 s25, s25, 131072
    s_add_u32 s26, s26, 2048
    v_lshlrev_b32 v166, 3, v154
    v_sub_u32 v166, v162, v166
    v_and_b32 v167, 1, v154
    v_lshl_add_u32 v166, v167, 5, v166
    v_lshrrev_b32 v167, 1, v154
    v_lshl_add_u32 v166, v167, 4, v166
    v_add_u32 v167, 32768, v166
    s_lshl_b32 s3, s20, 13
    v_and_b32 v165, 15, v153
    v_mul_u32_u24 v165, 144, v165
    v_lshl_add_u32 v165, v154, 3, v165
    v_add_u32 v165, s3, v165
    v_lshrrev_b32 v167, 3, v153
    v_and_b32 v166, 7, v153
    v_lshlrev_b32 v166, 4, v166
    v_mul_u32_u24 v164, 144, v167
    v_add3_u32 v164, v164, v166, s3
    v_lshl_add_u32 v166, v167, 11, v166
    s_lshl_b32 s60, s23, 15
    s_add_u32 s60, s60, s46
    s_add_u32 s61, s60, 16384
    s_add_u32 s62, s60, 32768
    s_add_u32 s63, s60, 49152
    s_mov_b32 s16, s42
    s_and_b32 s17, s43, 0xffff
    s_mov_b32 s18, 0x400000
    s_mov_b32 s19, 0x00020000
    s_lshl_b32 s44, s21, 3
    s_add_u32 s44, s44, s20
    s_lshl_b32 s44, s44, 7
    s_add_u32 s44, s44, 62914560
    s_add_u32 s52, s44, 512
    v_mov_b32 v161, 0
    v_bfe_u32 v155, v153, 2, 2
    v_lshl_add_u32 v155, v154, 2, v155
    v_bfe_u32 v156, v155, 1, 2
    v_and_b32 v158, 3, v153
    v_lshlrev_b32 v155, 7, v155
    v_lshl_add_u32 v155, v158, 3, v155
    v_xor_b32 v158, 0, v156
    v_lshl_add_u32 v144, v158, 5, v155
    v_xor_b32 v158, 1, v156
    v_lshl_add_u32 v145, v158, 5, v155
    v_xor_b32 v158, 2, v156
    v_lshl_add_u32 v146, v158, 5, v155
    v_xor_b32 v158, 3, v156
    v_lshl_add_u32 v147, v158, 5, v155
    s_waitcnt vmcnt(6)
    s_barrier
    ds_read_b64_tr_b16 v[128:129], v144 offset:0
    ds_read_b64_tr_b16 v[130:131], v144 offset:2048
    ds_read_b64_tr_b16 v[132:133], v145 offset:0
    ds_read_b64_tr_b16 v[134:135], v145 offset:2048
    ds_read_b64_tr_b16 v[136:137], v146 offset:0
    ds_read_b64_tr_b16 v[138:139], v146 offset:2048
    s_add_u32 m0, s29, 16384
    s_nop 0
    buffer_load_dwordx4 v150, s[8:11], s25 offen lds
    s_add_u32 m0, s29, 17408
    s_nop 0
    buffer_load_dwordx4 v151, s[8:11], s25 offen lds
    buffer_load_dwordx4 v[64:67], v148, s[4:7], s26 offen offset:0
    buffer_load_dwordx4 v[68:71], v148, s[4:7], s26 offen offset:1024
    buffer_load_dwordx4 v[72:75], v149, s[4:7], s26 offen offset:0
    buffer_load_dwordx4 v[76:79], v149, s[4:7], s26 offen offset:1024
    s_add_u32 s25, s25, 131072
    s_add_u32 s26, s26, 2048
    s_add_u32 m0, s29, 24576
    s_nop 0
    buffer_load_dwordx4 v150, s[8:11], s25 offen lds
    s_add_u32 m0, s29, 25600
    s_nop 0
    buffer_load_dwordx4 v151, s[8:11], s25 offen lds
    buffer_load_dwordx4 v[80:83], v148, s[4:7], s26 offen offset:0
    buffer_load_dwordx4 v[84:87], v148, s[4:7], s26 offen offset:1024
    buffer_load_dwordx4 v[88:91], v149, s[4:7], s26 offen offset:0
    buffer_load_dwordx4 v[92:95], v149, s[4:7], s26 offen offset:1024
    s_add_u32 s25, s25, 131072
    s_add_u32 s26, s26, 2048
    s_add_u32 m0, s29, 32768
    s_nop 0
    buffer_load_dwordx4 v150, s[8:11], s25 offen lds
    s_add_u32 m0, s29, 33792
    s_nop 0
    buffer_load_dwordx4 v151, s[8:11], s25 offen lds
    buffer_load_dwordx4 v[96:99], v148, s[4:7], s26 offen offset:0
    buffer_load_dwordx4 v[100:103], v148, s[4:7], s26 offen offset:1024
    buffer_load_dwordx4 v[104:107], v149, s[4:7], s26 offen offset:0
    buffer_load_dwordx4 v[108:111], v149, s[4:7], s26 offen offset:1024
    s_add_u32 s25, s25, 131072
    s_add_u32 s26, s26, 2048
    v_lshlrev_b32 v0, 16, v112
    v_and_b32 v1, 0xffff0000, v112
    v_lshlrev_b32 v2, 16, v113
    v_and_b32 v3, 0xffff0000, v113
    v_lshlrev_b32 v4, 16, v114
    v_and_b32 v5, 0xffff0000, v114
    v_lshlrev_b32 v6, 16, v115
    v_and_b32 v7, 0xffff0000, v115
    v_lshlrev_b32 v8, 16, v116
    v_and_b32 v9, 0xffff0000, v116
    v_lshlrev_b32 v10, 16, v117
    v_and_b32 v11, 0xffff0000, v117
    v_lshlrev_b32 v12, 16, v118
    v_and_b32 v13, 0xffff0000, v118
    v_lshlrev_b32 v14, 16, v119
    v_and_b32 v15, 0xffff0000, v119
    v_lshlrev_b32 v16, 16, v120
    v_and_b32 v17, 0xffff0000, v120
    v_lshlrev_b32 v18, 16, v121
    v_and_b32 v19, 0xffff0000, v121
    v_lshlrev_b32 v20, 16, v122
    v_and_b32 v21, 0xffff0000, v122
    v_lshlrev_b32 v22, 16, v123
    v_and_b32 v23, 0xffff0000, v123
    v_lshlrev_b32 v24, 16, v124
    v_and_b32 v25, 0xffff0000, v124
    v_lshlrev_b32 v26, 16, v125
    v_and_b32 v27, 0xffff0000, v125
    v_lshlrev_b32 v28, 16, v126
    v_and_b32 v29, 0xffff0000, v126
    v_lshlrev_b32 v30, 16, v127
    v_and_b32 v31, 0xffff0000, v127
    s_mov_b32 s30, 8
    s_setprio 0
k2_kernel_gloop:
    s_cmp_lg_u32 s30, 2
    s_cbranch_scc1 k2_kernel_gp0
    s_setprio 2
k2_kernel_gp0:
    s_waitcnt vmcnt(22)
    s_barrier
    s_add_u32 m0, s29, 40960
    s_waitcnt lgkmcnt(4)
    v_mfma_f32_16x16x32_bf16 v[0:3], v[128:131], v[32:35], v[0:3]
    buffer_load_dwordx4 v150, s[8:11], s25 offen lds
    v_mfma_f32_16x16x32_bf16 v[16:19], v[128:131], v[40:43], v[16:19]
    ds_read_b64_tr_b16 v[140:141], v147 offset:0
    ds_read_b64_tr_b16 v[142:143], v147 offset:2048
    s_add_u32 m0, s29, 41984
    s_waitcnt lgkmcnt(4)
    v_mfma_f32_16x16x32_bf16 v[4:7], v[132:135], v[32:35], v[4:7]
    buffer_load_dwordx4 v151, s[8:11], s25 offen lds
    s_add_u32 s25, s25, 131072
    v_mfma_f32_16x16x32_bf16 v[20:23], v[132:135], v[40:43], v[20:23]
    ds_read_b64_tr_b16 v[128:129], v144 offset:4096
    ds_read_b64_tr_b16 v[130:131], v144 offset:6144
    s_waitcnt lgkmcnt(4)
    v_mfma_f32_16x16x32_bf16 v[8:11], v[136:139], v[32:35], v[8:11]
    buffer_load_dwordx4 v[112:115], v148, s[4:7], s26 offen offset:0
    v_mfma_f32_16x16x32_bf16 v[24:27], v[136:139], v[40:43], v[24:27]
    ds_read_b64_tr_b16 v[132:133], v145 offset:4096
    ds_read_b64_tr_b16 v[134:135], v145 offset:6144
    s_waitcnt lgkmcnt(4)
    v_mfma_f32_16x16x32_bf16 v[12:15], v[140:143], v[32:35], v[12:15]
    buffer_load_dwordx4 v[116:119], v148, s[4:7], s26 offen offset:1024
    v_mfma_f32_16x16x32_bf16 v[28:31], v[140:143], v[40:43], v[28:31]
    ds_read_b64_tr_b16 v[136:137], v146 offset:4096
    ds_read_b64_tr_b16 v[138:139], v146 offset:6144
    s_waitcnt lgkmcnt(4)
    v_mfma_f32_16x16x32_bf16 v[0:3], v[128:131], v[36:39], v[0:3]
    buffer_load_dwordx4 v[120:123], v149, s[4:7], s26 offen offset:0
    v_mfma_f32_16x16x32_bf16 v[16:19], v[128:131], v[44:47], v[16:19]
    ds_read_b64_tr_b16 v[140:141], v147 offset:4096
    ds_read_b64_tr_b16 v[142:143], v147 offset:6144
    s_waitcnt lgkmcnt(4)
    v_mfma_f32_16x16x32_bf16 v[4:7], v[132:135], v[36:39], v[4:7]
    buffer_load_dwordx4 v[124:127], v149, s[4:7], s26 offen offset:1024
    s_add_u32 s26, s26, 2048
    v_mfma_f32_16x16x32_bf16 v[20:23], v[132:135], v[44:47], v[20:23]
    ds_read_b64_tr_b16 v[128:129], v144 offset:8192
    ds_read_b64_tr_b16 v[130:131], v144 offset:10240
    s_waitcnt lgkmcnt(4)
    v_mfma_f32_16x16x32_bf16 v[8:11], v[136:139], v[36:39], v[8:11]
    v_mfma_f32_16x16x32_bf16 v[24:27], v[136:139], v[44:47], v[24:27]
    ds_read_b64_tr_b16 v[132:133], v145 offset:8192
    ds_read_b64_tr_b16 v[134:135], v145 offset:10240
    s_waitcnt lgkmcnt(4)
    v_mfma_f32_16x16x32_bf16 v[12:15], v[140:143], v[36:39], v[12:15]
    v_mfma_f32_16x16x32_bf16 v[28:31], v[140:143], v[44:47], v[28:31]
    ds_read_b64_tr_b16 v[136:137], v146 offset:8192
    ds_read_b64_tr_b16 v[138:139], v146 offset:10240
    s_waitcnt vmcnt(22)
    s_barrier
    s_add_u32 m0, s29, 0
    s_waitcnt lgkmcnt(4)
    v_mfma_f32_16x16x32_bf16 v[0:3], v[128:131], v[48:51], v[0:3]
    buffer_load_dwordx4 v150, s[8:11], s25 offen lds
    v_mfma_f32_16x16x32_bf16 v[16:19], v[128:131], v[56:59], v[16:19]
    ds_read_b64_tr_b16 v[140:141], v147 offset:8192
    ds_read_b64_tr_b16 v[142:143], v147 offset:10240
    s_add_u32 m0, s29, 1024
    s_waitcnt lgkmcnt(4)
    v_mfma_f32_16x16x32_bf16 v[4:7], v[132:135], v[48:51], v[4:7]
    buffer_load_dwordx4 v151, s[8:11], s25 offen lds
    s_add_u32 s25, s25, 131072
    v_mfma_f32_16x16x32_bf16 v[20:23], v[132:135], v[56:59], v[20:23]
    ds_read_b64_tr_b16 v[128:129], v144 offset:12288
    ds_read_b64_tr_b16 v[130:131], v144 offset:14336
    s_waitcnt lgkmcnt(4)
    v_mfma_f32_16x16x32_bf16 v[8:11], v[136:139], v[48:51], v[8:11]
    buffer_load_dwordx4 v[32:35], v148, s[4:7], s26 offen offset:0
    v_mfma_f32_16x16x32_bf16 v[24:27], v[136:139], v[56:59], v[24:27]
    ds_read_b64_tr_b16 v[132:133], v145 offset:12288
    ds_read_b64_tr_b16 v[134:135], v145 offset:14336
    s_waitcnt lgkmcnt(4)
    v_mfma_f32_16x16x32_bf16 v[12:15], v[140:143], v[48:51], v[12:15]
    buffer_load_dwordx4 v[36:39], v148, s[4:7], s26 offen offset:1024
    v_mfma_f32_16x16x32_bf16 v[28:31], v[140:143], v[56:59], v[28:31]
    ds_read_b64_tr_b16 v[136:137], v146 offset:12288
    ds_read_b64_tr_b16 v[138:139], v146 offset:14336
    s_waitcnt lgkmcnt(4)
    v_mfma_f32_16x16x32_bf16 v[0:3], v[128:131], v[52:55], v[0:3]
    buffer_load_dwordx4 v[40:43], v149, s[4:7], s26 offen offset:0
    v_mfma_f32_16x16x32_bf16 v[16:19], v[128:131], v[60:63], v[16:19]
    ds_read_b64_tr_b16 v[140:141], v147 offset:12288
    ds_read_b64_tr_b16 v[142:143], v147 offset:14336
    s_waitcnt lgkmcnt(4)
    v_mfma_f32_16x16x32_bf16 v[4:7], v[132:135], v[52:55], v[4:7]
    buffer_load_dwordx4 v[44:47], v149, s[4:7], s26 offen offset:1024
    s_add_u32 s26, s26, 2048
    v_mfma_f32_16x16x32_bf16 v[20:23], v[132:135], v[60:63], v[20:23]
    ds_read_b64_tr_b16 v[128:129], v144 offset:16384
    ds_read_b64_tr_b16 v[130:131], v144 offset:18432
    s_waitcnt lgkmcnt(4)
    v_mfma_f32_16x16x32_bf16 v[8:11], v[136:139], v[52:55], v[8:11]
    v_mfma_f32_16x16x32_bf16 v[24:27], v[136:139], v[60:63], v[24:27]
    ds_read_b64_tr_b16 v[132:133], v145 offset:16384
    ds_read_b64_tr_b16 v[134:135], v145 offset:18432
    s_waitcnt lgkmcnt(4)
    v_mfma_f32_16x16x32_bf16 v[12:15], v[140:143], v[52:55], v[12:15]
    v_mfma_f32_16x16x32_bf16 v[28:31], v[140:143], v[60:63], v[28:31]
    ds_read_b64_tr_b16 v[136:137], v146 offset:16384
    ds_read_b64_tr_b16 v[138:139], v146 offset:18432
    s_waitcnt vmcnt(22)
    s_barrier
    s_add_u32 m0, s29, 8192
    s_waitcnt lgkmcnt(4)
    v_mfma_f32_16x16x32_bf16 v[0:3], v[128:131], v[64:67], v[0:3]
    buffer_load_dwordx4 v150, s[8:11], s25 offen lds
    v_mfma_f32_16x16x32_bf16 v[16:19], v[128:131], v[72:75], v[16:19]
    ds_read_b64_tr_b16 v[140:141], v147 offset:16384
    ds_read_b64_tr_b16 v[142:143], v147 offset:18432
    s_add_u32 m0, s29, 9216
    s_waitcnt lgkmcnt(4)
    v_mfma_f32_16x16x32_bf16 v[4:7], v[132:135], v[64:67], v[4:7]
    buffer_load_dwordx4 v151, s[8:11], s25 offen lds
    s_add_u32 s25, s25, 131072
    v_mfma_f32_16x16x32_bf16 v[20:23], v[132:135], v[72:75], v[20:23]
    ds_read_b64_tr_b16 v[128:129], v144 offset:20480
    ds_read_b64_tr_b16 v[130:131], v144 offset:22528
    s_waitcnt lgkmcnt(4)
    v_mfma_f32_16x16x32_bf16 v[8:11], v[136:139], v[64:67], v[8:11]
    buffer_load_dwordx4 v[48:51], v148, s[4:7], s26 offen offset:0
    v_mfma_f32_16x16x32_bf16 v[24:27], v[136:139], v[72:75], v[24:27]
    ds_read_b64_tr_b16 v[132:133], v145 offset:20480
    ds_read_b64_tr_b16 v[134:135], v145 offset:22528
    s_waitcnt lgkmcnt(4)
    v_mfma_f32_16x16x32_bf16 v[12:15], v[140:143], v[64:67], v[12:15]
    buffer_load_dwordx4 v[52:55], v148, s[4:7], s26 offen offset:1024
    v_mfma_f32_16x16x32_bf16 v[28:31], v[140:143], v[72:75], v[28:31]
    ds_read_b64_tr_b16 v[136:137], v146 offset:20480
    ds_read_b64_tr_b16 v[138:139], v146 offset:22528
    s_waitcnt lgkmcnt(4)
    v_mfma_f32_16x16x32_bf16 v[0:3], v[128:131], v[68:71], v[0:3]
    buffer_load_dwordx4 v[56:59], v149, s[4:7], s26 offen offset:0
    v_mfma_f32_16x16x32_bf16 v[16:19], v[128:131], v[76:79], v[16:19]
    ds_read_b64_tr_b16 v[140:141], v147 offset:20480
    ds_read_b64_tr_b16 v[142:143], v147 offset:22528
    s_waitcnt lgkmcnt(4)
    v_mfma_f32_16x16x32_bf16 v[4:7], v[132:135], v[68:71], v[4:7]
    buffer_load_dwordx4 v[60:63], v149, s[4:7], s26 offen offset:1024
    s_add_u32 s26, s26, 2048
    v_mfma_f32_16x16x32_bf16 v[20:23], v[132:135], v[76:79], v[20:23]
    ds_read_b64_tr_b16 v[128:129], v144 offset:24576
    ds_read_b64_tr_b16 v[130:131], v144 offset:26624
    s_waitcnt lgkmcnt(4)
    v_mfma_f32_16x16x32_bf16 v[8:11], v[136:139], v[68:71], v[8:11]
    v_mfma_f32_16x16x32_bf16 v[24:27], v[136:139], v[76:79], v[24:27]
    ds_read_b64_tr_b16 v[132:133], v145 offset:24576
    ds_read_b64_tr_b16 v[134:135], v145 offset:26624
    s_waitcnt lgkmcnt(4)
    v_mfma_f32_16x16x32_bf16 v[12:15], v[140:143], v[68:71], v[12:15]
    v_mfma_f32_16x16x32_bf16 v[28:31], v[140:143], v[76:79], v[28:31]
    ds_read_b64_tr_b16 v[136:137], v146 offset:24576
    ds_read_b64_tr_b16 v[138:139], v146 offset:26624
    s_waitcnt vmcnt(22)
    s_barrier
    s_add_u32 m0, s29, 16384
    s_waitcnt lgkmcnt(4)
    v_mfma_f32_16x16x32_bf16 v[0:3], v[128:131], v[80:83], v[0:3]
    buffer_load_dwordx4 v150, s[8:11], s25 offen lds
    v_mfma_f32_16x16x32_bf16 v[16:19], v[128:131], v[88:91], v[16:19]
    ds_read_b64_tr_b16 v[140:141], v147 offset:24576
    ds_read_b64_tr_b16 v[142:143], v147 offset:26624
    s_add_u32 m0, s29, 17408
    s_waitcnt lgkmcnt(4)
    v_mfma_f32_16x16x32_bf16 v[4:7], v[132:135], v[80:83], v[4:7]
    buffer_load_dwordx4 v151, s[8:11], s25 offen lds
    s_add_u32 s25, s25, 131072
    v_mfma_f32_16x16x32_bf16 v[20:23], v[132:135], v[88:91], v[20:23]
    ds_read_b64_tr_b16 v[128:129], v144 offset:28672
    ds_read_b64_tr_b16 v[130:131], v144 offset:30720
    s_waitcnt lgkmcnt(4)
    v_mfma_f32_16x16x32_bf16 v[8:11], v[136:139], v[80:83], v[8:11]
    buffer_load_dwordx4 v[64:67], v148, s[4:7], s26 offen offset:0
    v_mfma_f32_16x16x32_bf16 v[24:27], v[136:139], v[88:91], v[24:27]
    ds_read_b64_tr_b16 v[132:133], v145 offset:28672
    ds_read_b64_tr_b16 v[134:135], v145 offset:30720
    s_waitcnt lgkmcnt(4)
    v_mfma_f32_16x16x32_bf16 v[12:15], v[140:143], v[80:83], v[12:15]
    buffer_load_dwordx4 v[68:71], v148, s[4:7], s26 offen offset:1024
    v_mfma_f32_16x16x32_bf16 v[28:31], v[140:143], v[88:91], v[28:31]
    ds_read_b64_tr_b16 v[136:137], v146 offset:28672
    ds_read_b64_tr_b16 v[138:139], v146 offset:30720
    s_waitcnt lgkmcnt(4)
    v_mfma_f32_16x16x32_bf16 v[0:3], v[128:131], v[84:87], v[0:3]
    buffer_load_dwordx4 v[72:75], v149, s[4:7], s26 offen offset:0
    v_mfma_f32_16x16x32_bf16 v[16:19], v[128:131], v[92:95], v[16:19]
    ds_read_b64_tr_b16 v[140:141], v147 offset:28672
    ds_read_b64_tr_b16 v[142:143], v147 offset:30720
    s_waitcnt lgkmcnt(4)
    v_mfma_f32_16x16x32_bf16 v[4:7], v[132:135], v[84:87], v[4:7]
    buffer_load_dwordx4 v[76:79], v149, s[4:7], s26 offen offset:1024
    s_add_u32 s26, s26, 2048
    v_mfma_f32_16x16x32_bf16 v[20:23], v[132:135], v[92:95], v[20:23]
    ds_read_b64_tr_b16 v[128:129], v144 offset:32768
    ds_read_b64_tr_b16 v[130:131], v144 offset:34816
    s_waitcnt lgkmcnt(4)
    v_mfma_f32_16x16x32_bf16 v[8:11], v[136:139], v[84:87], v[8:11]
    v_mfma_f32_16x16x32_bf16 v[24:27], v[136:139], v[92:95], v[24:27]
    ds_read_b64_tr_b16 v[132:133], v145 offset:32768
    ds_read_b64_tr_b16 v[134:135], v145 offset:34816
    s_waitcnt lgkmcnt(4)
    v_mfma_f32_16x16x32_bf16 v[12:15], v[140:143], v[84:87], v[12:15]
    v_mfma_f32_16x16x32_bf16 v[28:31], v[140:143], v[92:95], v[28:31]
    ds_read_b64_tr_b16 v[136:137], v146 offset:32768
    ds_read_b64_tr_b16 v[138:139], v146 offset:34816
    s_waitcnt vmcnt(22)
    s_barrier
    s_add_u32 m0, s29, 24576
    s_waitcnt lgkmcnt(4)
    v_mfma_f32_16x16x32_bf16 v[0:3], v[128:131], v[96:99], v[0:3]
    buffer_load_dwordx4 v150, s[8:11], s25 offen lds
    v_mfma_f32_16x16x32_bf16 v[16:19], v[128:131], v[104:107], v[16:19]
    ds_read_b64_tr_b16 v[140:141], v147 offset:32768
    ds_read_b64_tr_b16 v[142:143], v147 offset:34816
    s_add_u32 m0, s29, 25600
    s_waitcnt lgkmcnt(4)
    v_mfma_f32_16x16x32_bf16 v[4:7], v[132:135], v[96:99], v[4:7]
    buffer_load_dwordx4 v151, s[8:11], s25 offen lds
    s_add_u32 s25, s25, 131072
    v_mfma_f32_16x16x32_bf16 v[20:23], v[132:135], v[104:107], v[20:23]
    ds_read_b64_tr_b16 v[128:129], v144 offset:36864
    ds_read_b64_tr_b16 v[130:131], v144 offset:38912
    s_waitcnt lgkmcnt(4)
    v_mfma_f32_16x16x32_bf16 v[8:11], v[136:139], v[96:99], v[8:11]
    buffer_load_dwordx4 v[80:83], v148, s[4:7], s26 offen offset:0
    v_mfma_f32_16x16x32_bf16 v[24:27], v[136:139], v[104:107], v[24:27]
    ds_read_b64_tr_b16 v[132:133], v145 offset:36864
    ds_read_b64_tr_b16 v[134:135], v145 offset:38912
    s_waitcnt lgkmcnt(4)
    v_mfma_f32_16x16x32_bf16 v[12:15], v[140:143], v[96:99], v[12:15]
    buffer_load_dwordx4 v[84:87], v148, s[4:7], s26 offen offset:1024
    v_mfma_f32_16x16x32_bf16 v[28:31], v[140:143], v[104:107], v[28:31]
    ds_read_b64_tr_b16 v[136:137], v146 offset:36864
    ds_read_b64_tr_b16 v[138:139], v146 offset:38912
    s_waitcnt lgkmcnt(4)
    v_mfma_f32_16x16x32_bf16 v[0:3], v[128:131], v[100:103], v[0:3]
    buffer_load_dwordx4 v[88:91], v149, s[4:7], s26 offen offset:0
    v_mfma_f32_16x16x32_bf16 v[16:19], v[128:131], v[108:111], v[16:19]
    ds_read_b64_tr_b16 v[140:141], v147 offset:36864
    ds_read_b64_tr_b16 v[142:143], v147 offset:38912
    s_waitcnt lgkmcnt(4)
    v_mfma_f32_16x16x32_bf16 v[4:7], v[132:135], v[100:103], v[4:7]
    buffer_load_dwordx4 v[92:95], v149, s[4:7], s26 offen offset:1024
    s_add_u32 s26, s26, 2048
    v_mfma_f32_16x16x32_bf16 v[20:23], v[132:135], v[108:111], v[20:23]
    ds_read_b64_tr_b16 v[128:129], v144 offset:40960
    ds_read_b64_tr_b16 v[130:131], v144 offset:43008
    s_waitcnt lgkmcnt(4)
    v_mfma_f32_16x16x32_bf16 v[8:11], v[136:139], v[100:103], v[8:11]
    v_mfma_f32_16x16x32_bf16 v[24:27], v[136:139], v[108:111], v[24:27]
    ds_read_b64_tr_b16 v[132:133], v145 offset:40960
    ds_read_b64_tr_b16 v[134:135], v145 offset:43008
    s_waitcnt lgkmcnt(4)
    v_mfma_f32_16x16x32_bf16 v[12:15], v[140:143], v[100:103], v[12:15]
    v_mfma_f32_16x16x32_bf16 v[28:31], v[140:143], v[108:111], v[28:31]
    ds_read_b64_tr_b16 v[136:137], v146 offset:40960
    ds_read_b64_tr_b16 v[138:139], v146 offset:43008
    s_waitcnt vmcnt(22)
    s_barrier
    s_add_u32 m0, s29, 32768
    s_waitcnt lgkmcnt(4)
    v_mfma_f32_16x16x32_bf16 v[0:3], v[128:131], v[112:115], v[0:3]
    buffer_load_dwordx4 v150, s[8:11], s25 offen lds
    v_mfma_f32_16x16x32_bf16 v[16:19], v[128:131], v[120:123], v[16:19]
    ds_read_b64_tr_b16 v[140:141], v147 offset:40960
    ds_read_b64_tr_b16 v[142:143], v147 offset:43008
    s_add_u32 m0, s29, 33792
    s_waitcnt lgkmcnt(4)
    v_mfma_f32_16x16x32_bf16 v[4:7], v[132:135], v[112:115], v[4:7]
    buffer_load_dwordx4 v151, s[8:11], s25 offen lds
    s_add_u32 s25, s25, 131072
    v_mfma_f32_16x16x32_bf16 v[20:23], v[132:135], v[120:123], v[20:23]
    ds_read_b64_tr_b16 v[128:129], v144 offset:45056
    ds_read_b64_tr_b16 v[130:131], v144 offset:47104
    s_waitcnt lgkmcnt(4)
    v_mfma_f32_16x16x32_bf16 v[8:11], v[136:139], v[112:115], v[8:11]
    buffer_load_dwordx4 v[96:99], v148, s[4:7], s26 offen offset:0
    v_mfma_f32_16x16x32_bf16 v[24:27], v[136:139], v[120:123], v[24:27]
    ds_read_b64_tr_b16 v[132:133], v145 offset:45056
    ds_read_b64_tr_b16 v[134:135], v145 offset:47104
    s_waitcnt lgkmcnt(4)
    v_mfma_f32_16x16x32_bf16 v[12:15], v[140:143], v[112:115], v[12:15]
    buffer_load_dwordx4 v[100:103], v148, s[4:7], s26 offen offset:1024
    v_mfma_f32_16x16x32_bf16 v[28:31], v[140:143], v[120:123], v[28:31]
    ds_read_b64_tr_b16 v[136:137], v146 offset:45056
    ds_read_b64_tr_b16 v[138:139], v146 offset:47104
    s_waitcnt lgkmcnt(4)
    v_mfma_f32_16x16x32_bf16 v[0:3], v[128:131], v[116:119], v[0:3]
    buffer_load_dwordx4 v[104:107], v149, s[4:7], s26 offen offset:0
    v_mfma_f32_16x16x32_bf16 v[16:19], v[128:131], v[124:127], v[16:19]
    ds_read_b64_tr_b16 v[140:141], v147 offset:45056
    ds_read_b64_tr_b16 v[142:143], v147 offset:47104
    s_waitcnt lgkmcnt(4)
    v_mfma_f32_16x16x32_bf16 v[4:7], v[132:135], v[116:119], v[4:7]
    buffer_load_dwordx4 v[108:111], v149, s[4:7], s26 offen offset:1024
    s_add_u32 s26, s26, 2048
    v_mfma_f32_16x16x32_bf16 v[20:23], v[132:135], v[124:127], v[20:23]
    ds_read_b64_tr_b16 v[128:129], v144 offset:0
    ds_read_b64_tr_b16 v[130:131], v144 offset:2048
    s_waitcnt lgkmcnt(4)
    v_mfma_f32_16x16x32_bf16 v[8:11], v[136:139], v[116:119], v[8:11]
    v_mfma_f32_16x16x32_bf16 v[24:27], v[136:139], v[124:127], v[24:27]
    ds_read_b64_tr_b16 v[132:133], v145 offset:0
    ds_read_b64_tr_b16 v[134:135], v145 offset:2048
    s_waitcnt lgkmcnt(4)
    v_mfma_f32_16x16x32_bf16 v[12:15], v[140:143], v[116:119], v[12:15]
    v_mfma_f32_16x16x32_bf16 v[28:31], v[140:143], v[124:127], v[28:31]
    ds_read_b64_tr_b16 v[136:137], v146 offset:0
    ds_read_b64_tr_b16 v[138:139], v146 offset:2048
    s_sub_u32 s30, s30, 1
    s_cmp_lg_u32 s30, 0
    s_cbranch_scc1 k2_kernel_gloop
    s_waitcnt vmcnt(22)
    s_barrier
    s_add_u32 m0, s29, 40960
    s_waitcnt lgkmcnt(4)
    v_mfma_f32_16x16x32_bf16 v[0:3], v[128:131], v[32:35], v[0:3]
    buffer_load_dwordx4 v150, s[8:11], s25 offen lds
    v_mfma_f32_16x16x32_bf16 v[16:19], v[128:131], v[40:43], v[16:19]
    ds_read_b64_tr_b16 v[140:141], v147 offset:0
    ds_read_b64_tr_b16 v[142:143], v147 offset:2048
    s_add_u32 m0, s29, 41984
    s_waitcnt lgkmcnt(4)
    v_mfma_f32_16x16x32_bf16 v[4:7], v[132:135], v[32:35], v[4:7]
    buffer_load_dwordx4 v151, s[8:11], s25 offen lds
    s_add_u32 s25, s25, 131072
    v_mfma_f32_16x16x32_bf16 v[20:23], v[132:135], v[40:43], v[20:23]
    ds_read_b64_tr_b16 v[128:129], v144 offset:4096
    ds_read_b64_tr_b16 v[130:131], v144 offset:6144
    s_waitcnt lgkmcnt(4)
    v_mfma_f32_16x16x32_bf16 v[8:11], v[136:139], v[32:35], v[8:11]
    buffer_load_dwordx4 v[112:115], v148, s[4:7], s26 offen offset:0
    v_mfma_f32_16x16x32_bf16 v[24:27], v[136:139], v[40:43], v[24:27]
    ds_read_b64_tr_b16 v[132:133], v145 offset:4096
    ds_read_b64_tr_b16 v[134:135], v145 offset:6144
    s_waitcnt lgkmcnt(4)
    v_mfma_f32_16x16x32_bf16 v[12:15], v[140:143], v[32:35], v[12:15]
    buffer_load_dwordx4 v[116:119], v148, s[4:7], s26 offen offset:1024
    v_mfma_f32_16x16x32_bf16 v[28:31], v[140:143], v[40:43], v[28:31]
    ds_read_b64_tr_b16 v[136:137], v146 offset:4096
    ds_read_b64_tr_b16 v[138:139], v146 offset:6144
    s_waitcnt lgkmcnt(4)
    v_mfma_f32_16x16x32_bf16 v[0:3], v[128:131], v[36:39], v[0:3]
    buffer_load_dwordx4 v[120:123], v149, s[4:7], s26 offen offset:0
    v_mfma_f32_16x16x32_bf16 v[16:19], v[128:131], v[44:47], v[16:19]
    ds_read_b64_tr_b16 v[140:141], v147 offset:4096
    ds_read_b64_tr_b16 v[142:143], v147 offset:6144
    s_waitcnt lgkmcnt(4)
    v_mfma_f32_16x16x32_bf16 v[4:7], v[132:135], v[36:39], v[4:7]
    buffer_load_dwordx4 v[124:127], v149, s[4:7], s26 offen offset:1024
    s_add_u32 s26, s26, 2048
    v_mfma_f32_16x16x32_bf16 v[20:23], v[132:135], v[44:47], v[20:23]
    ds_read_b64_tr_b16 v[128:129], v144 offset:8192
    ds_read_b64_tr_b16 v[130:131], v144 offset:10240
    s_waitcnt lgkmcnt(4)
    v_mfma_f32_16x16x32_bf16 v[8:11], v[136:139], v[36:39], v[8:11]
    v_mfma_f32_16x16x32_bf16 v[24:27], v[136:139], v[44:47], v[24:27]
    ds_read_b64_tr_b16 v[132:133], v145 offset:8192
    ds_read_b64_tr_b16 v[134:135], v145 offset:10240
    s_waitcnt lgkmcnt(4)
    v_mfma_f32_16x16x32_bf16 v[12:15], v[140:143], v[36:39], v[12:15]
    v_mfma_f32_16x16x32_bf16 v[28:31], v[140:143], v[44:47], v[28:31]
    ds_read_b64_tr_b16 v[136:137], v146 offset:8192
    ds_read_b64_tr_b16 v[138:139], v146 offset:10240
    s_waitcnt vmcnt(22)
    s_barrier
    s_add_u32 m0, s29, 0
    s_waitcnt lgkmcnt(4)
    v_mfma_f32_16x16x32_bf16 v[0:3], v[128:131], v[48:51], v[0:3]
    buffer_load_dwordx4 v150, s[8:11], s25 offen lds
    v_mfma_f32_16x16x32_bf16 v[16:19], v[128:131], v[56:59], v[16:19]
    ds_read_b64_tr_b16 v[140:141], v147 offset:8192
    ds_read_b64_tr_b16 v[142:143], v147 offset:10240
    s_add_u32 m0, s29, 1024
    s_waitcnt lgkmcnt(4)
    v_mfma_f32_16x16x32_bf16 v[4:7], v[132:135], v[48:51], v[4:7]
    buffer_load_dwordx4 v151, s[8:11], s25 offen lds
    s_add_u32 s25, s25, 131072
    v_mfma_f32_16x16x32_bf16 v[20:23], v[132:135], v[56:59], v[20:23]
    ds_read_b64_tr_b16 v[128:129], v144 offset:12288
    ds_read_b64_tr_b16 v[130:131], v144 offset:14336
    s_waitcnt lgkmcnt(4)
    v_mfma_f32_16x16x32_bf16 v[8:11], v[136:139], v[48:51], v[8:11]
    buffer_load_dwordx4 v[32:35], v148, s[4:7], s26 offen offset:0
    v_mfma_f32_16x16x32_bf16 v[24:27], v[136:139], v[56:59], v[24:27]
    ds_read_b64_tr_b16 v[132:133], v145 offset:12288
    ds_read_b64_tr_b16 v[134:135], v145 offset:14336
    s_waitcnt lgkmcnt(4)
    v_mfma_f32_16x16x32_bf16 v[12:15], v[140:143], v[48:51], v[12:15]
    buffer_load_dwordx4 v[36:39], v148, s[4:7], s26 offen offset:1024
    v_mfma_f32_16x16x32_bf16 v[28:31], v[140:143], v[56:59], v[28:31]
    ds_read_b64_tr_b16 v[136:137], v146 offset:12288
    ds_read_b64_tr_b16 v[138:139], v146 offset:14336
    s_waitcnt lgkmcnt(4)
    v_mfma_f32_16x16x32_bf16 v[0:3], v[128:131], v[52:55], v[0:3]
    buffer_load_dwordx4 v[40:43], v149, s[4:7], s26 offen offset:0
    v_mfma_f32_16x16x32_bf16 v[16:19], v[128:131], v[60:63], v[16:19]
    ds_read_b64_tr_b16 v[140:141], v147 offset:12288
    ds_read_b64_tr_b16 v[142:143], v147 offset:14336
    s_waitcnt lgkmcnt(4)
    v_mfma_f32_16x16x32_bf16 v[4:7], v[132:135], v[52:55], v[4:7]
    buffer_load_dwordx4 v[44:47], v149, s[4:7], s26 offen offset:1024
    s_add_u32 s26, s26, 2048
    v_mfma_f32_16x16x32_bf16 v[20:23], v[132:135], v[60:63], v[20:23]
    ds_read_b64_tr_b16 v[128:129], v144 offset:16384
    ds_read_b64_tr_b16 v[130:131], v144 offset:18432
    s_waitcnt lgkmcnt(4)
    v_mfma_f32_16x16x32_bf16 v[8:11], v[136:139], v[52:55], v[8:11]
    buffer_load_dword v160, v161, s[4:7], s44 offen sc1
    v_mfma_f32_16x16x32_bf16 v[24:27], v[136:139], v[60:63], v[24:27]
    ds_read_b64_tr_b16 v[132:133], v145 offset:16384
    ds_read_b64_tr_b16 v[134:135], v145 offset:18432
    s_waitcnt lgkmcnt(4)
    v_mfma_f32_16x16x32_bf16 v[12:15], v[140:143], v[52:55], v[12:15]
    v_mfma_f32_16x16x32_bf16 v[28:31], v[140:143], v[60:63], v[28:31]
    ds_read_b64_tr_b16 v[136:137], v146 offset:16384
    ds_read_b64_tr_b16 v[138:139], v146 offset:18432
    s_waitcnt vmcnt(23)
    s_barrier
    s_add_u32 m0, s29, 8192
    s_waitcnt lgkmcnt(4)
    v_mfma_f32_16x16x32_bf16 v[0:3], v[128:131], v[64:67], v[0:3]
    buffer_load_dwordx4 v150, s[8:11], s25 offen lds
    v_mfma_f32_16x16x32_bf16 v[16:19], v[128:131], v[72:75], v[16:19]
    ds_read_b64_tr_b16 v[140:141], v147 offset:16384
    ds_read_b64_tr_b16 v[142:143], v147 offset:18432
    s_add_u32 m0, s29, 9216
    s_waitcnt lgkmcnt(4)
    v_mfma_f32_16x16x32_bf16 v[4:7], v[132:135], v[64:67], v[4:7]
    buffer_load_dwordx4 v151, s[8:11], s25 offen lds
    s_add_u32 s25, s25, 131072
    v_mfma_f32_16x16x32_bf16 v[20:23], v[132:135], v[72:75], v[20:23]
    ds_read_b64_tr_b16 v[128:129], v144 offset:20480
    ds_read_b64_tr_b16 v[130:131], v144 offset:22528
    s_waitcnt lgkmcnt(4)
    v_mfma_f32_16x16x32_bf16 v[8:11], v[136:139], v[64:67], v[8:11]
    buffer_load_dwordx4 v[48:51], v148, s[4:7], s26 offen offset:0
    v_mfma_f32_16x16x32_bf16 v[24:27], v[136:139], v[72:75], v[24:27]
    ds_read_b64_tr_b16 v[132:133], v145 offset:20480
    ds_read_b64_tr_b16 v[134:135], v145 offset:22528
    s_waitcnt lgkmcnt(4)
    v_mfma_f32_16x16x32_bf16 v[12:15], v[140:143], v[64:67], v[12:15]
    buffer_load_dwordx4 v[52:55], v148, s[4:7], s26 offen offset:1024
    v_mfma_f32_16x16x32_bf16 v[28:31], v[140:143], v[72:75], v[28:31]
    ds_read_b64_tr_b16 v[136:137], v146 offset:20480
    ds_read_b64_tr_b16 v[138:139], v146 offset:22528
    s_waitcnt lgkmcnt(4)
    v_mfma_f32_16x16x32_bf16 v[0:3], v[128:131], v[68:71], v[0:3]
    buffer_load_dwordx4 v[56:59], v149, s[4:7], s26 offen offset:0
    v_mfma_f32_16x16x32_bf16 v[16:19], v[128:131], v[76:79], v[16:19]
    ds_read_b64_tr_b16 v[140:141], v147 offset:20480
    ds_read_b64_tr_b16 v[142:143], v147 offset:22528
    s_waitcnt lgkmcnt(4)
    v_mfma_f32_16x16x32_bf16 v[4:7], v[132:135], v[68:71], v[4:7]
    buffer_load_dwordx4 v[60:63], v149, s[4:7], s26 offen offset:1024
    s_add_u32 s26, s26, 2048
    v_mfma_f32_16x16x32_bf16 v[20:23], v[132:135], v[76:79], v[20:23]
    ds_read_b64_tr_b16 v[128:129], v144 offset:24576
    ds_read_b64_tr_b16 v[130:131], v144 offset:26624
    s_waitcnt lgkmcnt(4)
    v_mfma_f32_16x16x32_bf16 v[8:11], v[136:139], v[68:71], v[8:11]
    v_mfma_f32_16x16x32_bf16 v[24:27], v[136:139], v[76:79], v[24:27]
    ds_read_b64_tr_b16 v[132:133], v145 offset:24576
    ds_read_b64_tr_b16 v[134:135], v145 offset:26624
    s_waitcnt lgkmcnt(4)
    v_mfma_f32_16x16x32_bf16 v[12:15], v[140:143], v[68:71], v[12:15]
    v_mfma_f32_16x16x32_bf16 v[28:31], v[140:143], v[76:79], v[28:31]
    ds_read_b64_tr_b16 v[136:137], v146 offset:24576
    ds_read_b64_tr_b16 v[138:139], v146 offset:26624
    s_mov_b32 s8, s38
    s_and_b32 s9, s39, 0xffff
    s_mov_b32 s10, 2097152
    s_mov_b32 s25, 0
    s_waitcnt vmcnt(6)
    v_readfirstlane_b32 s3, v160
    s_nop 0
    s_cmp_ge_u32 s3, 16
    s_cbranch_scc1 k2_kernel_o0_ok
k2_kernel_o0_spin:
    s_sleep 1
    buffer_load_dword v160, v161, s[4:7], s44 offen sc1
    s_waitcnt vmcnt(0)
    v_readfirstlane_b32 s3, v160
    s_nop 0
    s_cmp_lt_u32 s3, 16
    s_cbranch_scc1 k2_kernel_o0_spin
k2_kernel_o0_ok:
    s_mov_b32 s26, 0
    s_waitcnt vmcnt(23)
    s_barrier
    s_add_u32 m0, s29, 16384
    s_waitcnt lgkmcnt(4)
    v_mfma_f32_16x16x32_bf16 v[0:3], v[128:131], v[80:83], v[0:3]
    buffer_load_dwordx4 v150, s[8:11], s25 offen lds
    v_mfma_f32_16x16x32_bf16 v[16:19], v[128:131], v[88:91], v[16:19]
    ds_read_b64_tr_b16 v[140:141], v147 offset:24576
    ds_read_b64_tr_b16 v[142:143], v147 offset:26624
    s_add_u32 m0, s29, 17408
    s_waitcnt lgkmcnt(4)
    v_mfma_f32_16x16x32_bf16 v[4:7], v[132:135], v[80:83], v[4:7]
    buffer_load_dwordx4 v151, s[8:11], s25 offen lds
    s_add_u32 s25, s25, 131072
    v_mfma_f32_16x16x32_bf16 v[20:23], v[132:135], v[88:91], v[20:23]
    ds_read_b64_tr_b16 v[128:129], v144 offset:28672
    ds_read_b64_tr_b16 v[130:131], v144 offset:30720
    s_waitcnt lgkmcnt(4)
    v_mfma_f32_16x16x32_bf16 v[8:11], v[136:139], v[80:83], v[8:11]
    buffer_load_dwordx4 v[64:67], v148, s[4:7], s26 offen offset:0
    v_mfma_f32_16x16x32_bf16 v[24:27], v[136:139], v[88:91], v[24:27]
    ds_read_b64_tr_b16 v[132:133], v145 offset:28672
    ds_read_b64_tr_b16 v[134:135], v145 offset:30720
    s_waitcnt lgkmcnt(4)
    v_mfma_f32_16x16x32_bf16 v[12:15], v[140:143], v[80:83], v[12:15]
    buffer_load_dwordx4 v[68:71], v148, s[4:7], s26 offen offset:1024
    v_mfma_f32_16x16x32_bf16 v[28:31], v[140:143], v[88:91], v[28:31]
    ds_read_b64_tr_b16 v[136:137], v146 offset:28672
    ds_read_b64_tr_b16 v[138:139], v146 offset:30720
    s_waitcnt lgkmcnt(4)
    v_mfma_f32_16x16x32_bf16 v[0:3], v[128:131], v[84:87], v[0:3]
    buffer_load_dwordx4 v[72:75], v149, s[4:7], s26 offen offset:0
    v_mfma_f32_16x16x32_bf16 v[16:19], v[128:131], v[92:95], v[16:19]
    ds_read_b64_tr_b16 v[140:141], v147 offset:28672
    ds_read_b64_tr_b16 v[142:143], v147 offset:30720
    s_waitcnt lgkmcnt(4)
    v_mfma_f32_16x16x32_bf16 v[4:7], v[132:135], v[84:87], v[4:7]
    buffer_load_dwordx4 v[76:79], v149, s[4:7], s26 offen offset:1024
    s_add_u32 s26, s26, 2048
    v_mfma_f32_16x16x32_bf16 v[20:23], v[132:135], v[92:95], v[20:23]
    ds_read_b64_tr_b16 v[128:129], v144 offset:32768
    ds_read_b64_tr_b16 v[130:131], v144 offset:34816
    s_waitcnt lgkmcnt(4)
    v_mfma_f32_16x16x32_bf16 v[8:11], v[136:139], v[84:87], v[8:11]
    v_mfma_f32_16x16x32_bf16 v[24:27], v[136:139], v[92:95], v[24:27]
    ds_read_b64_tr_b16 v[132:133], v145 offset:32768
    ds_read_b64_tr_b16 v[134:135], v145 offset:34816
    s_waitcnt lgkmcnt(4)
    v_mfma_f32_16x16x32_bf16 v[12:15], v[140:143], v[84:87], v[12:15]
    v_mfma_f32_16x16x32_bf16 v[28:31], v[140:143], v[92:95], v[28:31]
    ds_read_b64_tr_b16 v[136:137], v146 offset:32768
    ds_read_b64_tr_b16 v[138:139], v146 offset:34816
    s_waitcnt vmcnt(23)
    s_barrier
    s_add_u32 m0, s29, 24576
    s_waitcnt lgkmcnt(4)
    v_mfma_f32_16x16x32_bf16 v[0:3], v[128:131], v[96:99], v[0:3]
    buffer_load_dwordx4 v150, s[8:11], s25 offen lds
    v_mfma_f32_16x16x32_bf16 v[16:19], v[128:131], v[104:107], v[16:19]
    ds_read_b64_tr_b16 v[140:141], v147 offset:32768
    ds_read_b64_tr_b16 v[142:143], v147 offset:34816
    s_add_u32 m0, s29, 25600
    s_waitcnt lgkmcnt(4)
    v_mfma_f32_16x16x32_bf16 v[4:7], v[132:135], v[96:99], v[4:7]
    buffer_load_dwordx4 v151, s[8:11], s25 offen lds
    s_add_u32 s25, s25, 131072
    v_mfma_f32_16x16x32_bf16 v[20:23], v[132:135], v[104:107], v[20:23]
    ds_read_b64_tr_b16 v[128:129], v144 offset:36864
    ds_read_b64_tr_b16 v[130:131], v144 offset:38912
    s_waitcnt lgkmcnt(4)
    v_mfma_f32_16x16x32_bf16 v[8:11], v[136:139], v[96:99], v[8:11]
    buffer_load_dwordx4 v[80:83], v148, s[4:7], s26 offen offset:0
    v_mfma_f32_16x16x32_bf16 v[24:27], v[136:139], v[104:107], v[24:27]
    ds_read_b64_tr_b16 v[132:133], v145 offset:36864
    ds_read_b64_tr_b16 v[134:135], v145 offset:38912
    s_waitcnt lgkmcnt(4)
    v_mfma_f32_16x16x32_bf16 v[12:15], v[140:143], v[96:99], v[12:15]
    buffer_load_dwordx4 v[84:87], v148, s[4:7], s26 offen offset:1024
    v_mfma_f32_16x16x32_bf16 v[28:31], v[140:143], v[104:107], v[28:31]
    ds_read_b64_tr_b16 v[136:137], v146 offset:36864
    ds_read_b64_tr_b16 v[138:139], v146 offset:38912
    s_waitcnt lgkmcnt(4)
    v_mfma_f32_16x16x32_bf16 v[0:3], v[128:131], v[100:103], v[0:3]
    buffer_load_dwordx4 v[88:91], v149, s[4:7], s26 offen offset:0
    v_mfma_f32_16x16x32_bf16 v[16:19], v[128:131], v[108:111], v[16:19]
    ds_read_b64_tr_b16 v[140:141], v147 offset:36864
    ds_read_b64_tr_b16 v[142:143], v147 offset:38912
    s_waitcnt lgkmcnt(4)
    v_mfma_f32_16x16x32_bf16 v[4:7], v[132:135], v[100:103], v[4:7]
    buffer_load_dwordx4 v[92:95], v149, s[4:7], s26 offen offset:1024
    s_add_u32 s26, s26, 2048
    v_mfma_f32_16x16x32_bf16 v[20:23], v[132:135], v[108:111], v[20:23]
    ds_read_b64_tr_b16 v[128:129], v144 offset:40960
    ds_read_b64_tr_b16 v[130:131], v144 offset:43008
    s_waitcnt lgkmcnt(4)
    v_mfma_f32_16x16x32_bf16 v[8:11], v[136:139], v[100:103], v[8:11]
    v_mfma_f32_16x16x32_bf16 v[24:27], v[136:139], v[108:111], v[24:27]
    ds_read_b64_tr_b16 v[132:133], v145 offset:40960
    ds_read_b64_tr_b16 v[134:135], v145 offset:43008
    s_waitcnt lgkmcnt(4)
    v_mfma_f32_16x16x32_bf16 v[12:15], v[140:143], v[100:103], v[12:15]
    v_mfma_f32_16x16x32_bf16 v[28:31], v[140:143], v[108:111], v[28:31]
    ds_read_b64_tr_b16 v[136:137], v146 offset:40960
    ds_read_b64_tr_b16 v[138:139], v146 offset:43008
    s_waitcnt vmcnt(23)
    s_barrier
    s_add_u32 m0, s29, 32768
    s_waitcnt lgkmcnt(4)
    v_mfma_f32_16x16x32_bf16 v[0:3], v[128:131], v[112:115], v[0:3]
    buffer_load_dwordx4 v150, s[8:11], s25 offen lds
    v_mfma_f32_16x16x32_bf16 v[16:19], v[128:131], v[120:123], v[16:19]
    ds_read_b64_tr_b16 v[140:141], v147 offset:40960
    ds_read_b64_tr_b16 v[142:143], v147 offset:43008
    s_add_u32 m0, s29, 33792
    s_waitcnt lgkmcnt(4)
    v_mfma_f32_16x16x32_bf16 v[4:7], v[132:135], v[112:115], v[4:7]
    buffer_load_dwordx4 v151, s[8:11], s25 offen lds
    s_add_u32 s25, s25, 131072
    v_mfma_f32_16x16x32_bf16 v[20:23], v[132:135], v[120:123], v[20:23]
    ds_read_b64_tr_b16 v[128:129], v144 offset:45056
    ds_read_b64_tr_b16 v[130:131], v144 offset:47104
    s_waitcnt lgkmcnt(4)
    v_mfma_f32_16x16x32_bf16 v[8:11], v[136:139], v[112:115], v[8:11]
    buffer_load_dwordx4 v[96:99], v148, s[4:7], s26 offen offset:0
    v_mfma_f32_16x16x32_bf16 v[24:27], v[136:139], v[120:123], v[24:27]
    ds_read_b64_tr_b16 v[132:133], v145 offset:45056
    ds_read_b64_tr_b16 v[134:135], v145 offset:47104
    s_waitcnt lgkmcnt(4)
    v_mfma_f32_16x16x32_bf16 v[12:15], v[140:143], v[112:115], v[12:15]
    buffer_load_dwordx4 v[100:103], v148, s[4:7], s26 offen offset:1024
    v_mfma_f32_16x16x32_bf16 v[28:31], v[140:143], v[120:123], v[28:31]
    ds_read_b64_tr_b16 v[136:137], v146 offset:45056
    ds_read_b64_tr_b16 v[138:139], v146 offset:47104
    s_waitcnt lgkmcnt(4)
    v_mfma_f32_16x16x32_bf16 v[0:3], v[128:131], v[116:119], v[0:3]
    buffer_load_dwordx4 v[104:107], v149, s[4:7], s26 offen offset:0
    v_mfma_f32_16x16x32_bf16 v[16:19], v[128:131], v[124:127], v[16:19]
    ds_read_b64_tr_b16 v[140:141], v147 offset:45056
    ds_read_b64_tr_b16 v[142:143], v147 offset:47104
    s_waitcnt lgkmcnt(4)
    v_mfma_f32_16x16x32_bf16 v[4:7], v[132:135], v[116:119], v[4:7]
    buffer_load_dwordx4 v[108:111], v149, s[4:7], s26 offen offset:1024
    s_add_u32 s26, s26, 2048
    v_mfma_f32_16x16x32_bf16 v[20:23], v[132:135], v[124:127], v[20:23]
    ds_read_b64_tr_b16 v[128:129], v144 offset:0
    ds_read_b64_tr_b16 v[130:131], v144 offset:2048
    s_waitcnt lgkmcnt(4)
    v_mfma_f32_16x16x32_bf16 v[8:11], v[136:139], v[116:119], v[8:11]
    v_mfma_f32_16x16x32_bf16 v[24:27], v[136:139], v[124:127], v[24:27]
    ds_read_b64_tr_b16 v[132:133], v145 offset:0
    ds_read_b64_tr_b16 v[134:135], v145 offset:2048
    s_waitcnt lgkmcnt(4)
    v_mfma_f32_16x16x32_bf16 v[12:15], v[140:143], v[116:119], v[12:15]
    v_mfma_f32_16x16x32_bf16 v[28:31], v[140:143], v[124:127], v[28:31]
    ds_read_b64_tr_b16 v[136:137], v146 offset:0
    ds_read_b64_tr_b16 v[138:139], v146 offset:2048
    s_waitcnt vmcnt(22)
    s_barrier
    s_add_u32 m0, s29, 40960
    s_waitcnt lgkmcnt(4)
    v_mfma_f32_16x16x32_bf16 v[0:3], v[128:131], v[32:35], v[0:3]
    buffer_load_dwordx4 v150, s[8:11], s25 offen lds
    v_mfma_f32_16x16x32_bf16 v[16:19], v[128:131], v[40:43], v[16:19]
    ds_read_b64_tr_b16 v[140:141], v147 offset:0
    ds_read_b64_tr_b16 v[142:143], v147 offset:2048
    s_add_u32 m0, s29, 41984
    s_waitcnt lgkmcnt(4)
    v_mfma_f32_16x16x32_bf16 v[4:7], v[132:135], v[32:35], v[4:7]
    buffer_load_dwordx4 v151, s[8:11], s25 offen lds
    s_add_u32 s25, s25, 131072
    v_mfma_f32_16x16x32_bf16 v[20:23], v[132:135], v[40:43], v[20:23]
    ds_read_b64_tr_b16 v[128:129], v144 offset:4096
    ds_read_b64_tr_b16 v[130:131], v144 offset:6144
    s_waitcnt lgkmcnt(4)
    v_mfma_f32_16x16x32_bf16 v[8:11], v[136:139], v[32:35], v[8:11]
    buffer_load_dwordx4 v[112:115], v148, s[4:7], s26 offen offset:0
    v_mfma_f32_16x16x32_bf16 v[24:27], v[136:139], v[40:43], v[24:27]
    ds_read_b64_tr_b16 v[132:133], v145 offset:4096
    ds_read_b64_tr_b16 v[134:135], v145 offset:6144
    s_waitcnt lgkmcnt(4)
    v_mfma_f32_16x16x32_bf16 v[12:15], v[140:143], v[32:35], v[12:15]
    buffer_load_dwordx4 v[116:119], v148, s[4:7], s26 offen offset:1024
    v_mfma_f32_16x16x32_bf16 v[28:31], v[140:143], v[40:43], v[28:31]
    ds_read_b64_tr_b16 v[136:137], v146 offset:4096
    ds_read_b64_tr_b16 v[138:139], v146 offset:6144
    s_waitcnt lgkmcnt(4)
    v_mfma_f32_16x16x32_bf16 v[0:3], v[128:131], v[36:39], v[0:3]
    buffer_load_dwordx4 v[120:123], v149, s[4:7], s26 offen offset:0
    v_mfma_f32_16x16x32_bf16 v[16:19], v[128:131], v[44:47], v[16:19]
    ds_read_b64_tr_b16 v[140:141], v147 offset:4096
    ds_read_b64_tr_b16 v[142:143], v147 offset:6144
    s_waitcnt lgkmcnt(4)
    v_mfma_f32_16x16x32_bf16 v[4:7], v[132:135], v[36:39], v[4:7]
    buffer_load_dwordx4 v[124:127], v149, s[4:7], s26 offen offset:1024
    s_add_u32 s26, s26, 2048
    v_mfma_f32_16x16x32_bf16 v[20:23], v[132:135], v[44:47], v[20:23]
    ds_read_b64_tr_b16 v[128:129], v144 offset:8192
    ds_read_b64_tr_b16 v[130:131], v144 offset:10240
    s_waitcnt lgkmcnt(4)
    v_mfma_f32_16x16x32_bf16 v[8:11], v[136:139], v[36:39], v[8:11]
    v_mfma_f32_16x16x32_bf16 v[24:27], v[136:139], v[44:47], v[24:27]
    ds_read_b64_tr_b16 v[132:133], v145 offset:8192
    ds_read_b64_tr_b16 v[134:135], v145 offset:10240
    s_waitcnt lgkmcnt(4)
    v_mfma_f32_16x16x32_bf16 v[12:15], v[140:143], v[36:39], v[12:15]
    v_mfma_f32_16x16x32_bf16 v[28:31], v[140:143], v[44:47], v[28:31]
    ds_read_b64_tr_b16 v[136:137], v146 offset:8192
    ds_read_b64_tr_b16 v[138:139], v146 offset:10240
    s_waitcnt vmcnt(22)
    s_barrier
    s_add_u32 m0, s29, 0
    s_waitcnt lgkmcnt(4)
    v_mfma_f32_16x16x32_bf16 v[0:3], v[128:131], v[48:51], v[0:3]
    buffer_load_dwordx4 v150, s[8:11], s25 offen lds
    v_mfma_f32_16x16x32_bf16 v[16:19], v[128:131], v[56:59], v[16:19]
    ds_read_b64_tr_b16 v[140:141], v147 offset:8192
    ds_read_b64_tr_b16 v[142:143], v147 offset:10240
    s_add_u32 m0, s29, 1024
    s_waitcnt lgkmcnt(4)
    v_mfma_f32_16x16x32_bf16 v[4:7], v[132:135], v[48:51], v[4:7]
    buffer_load_dwordx4 v151, s[8:11], s25 offen lds
    s_add_u32 s25, s25, 131072
    v_mfma_f32_16x16x32_bf16 v[20:23], v[132:135], v[56:59], v[20:23]
    ds_read_b64_tr_b16 v[128:129], v144 offset:12288
    ds_read_b64_tr_b16 v[130:131], v144 offset:14336
    s_waitcnt lgkmcnt(4)
    v_mfma_f32_16x16x32_bf16 v[8:11], v[136:139], v[48:51], v[8:11]
    buffer_load_dwordx4 v[32:35], v148, s[4:7], s26 offen offset:0
    v_mfma_f32_16x16x32_bf16 v[24:27], v[136:139], v[56:59], v[24:27]
    ds_read_b64_tr_b16 v[132:133], v145 offset:12288
    ds_read_b64_tr_b16 v[134:135], v145 offset:14336
    s_waitcnt lgkmcnt(4)
    v_mfma_f32_16x16x32_bf16 v[12:15], v[140:143], v[48:51], v[12:15]
    buffer_load_dwordx4 v[36:39], v148, s[4:7], s26 offen offset:1024
    v_mfma_f32_16x16x32_bf16 v[28:31], v[140:143], v[56:59], v[28:31]
    ds_read_b64_tr_b16 v[136:137], v146 offset:12288
    ds_read_b64_tr_b16 v[138:139], v146 offset:14336
    s_waitcnt lgkmcnt(4)
    v_mfma_f32_16x16x32_bf16 v[0:3], v[128:131], v[52:55], v[0:3]
    buffer_load_dwordx4 v[40:43], v149, s[4:7], s26 offen offset:0
    v_mfma_f32_16x16x32_bf16 v[16:19], v[128:131], v[60:63], v[16:19]
    ds_read_b64_tr_b16 v[140:141], v147 offset:12288
    ds_read_b64_tr_b16 v[142:143], v147 offset:14336
    s_waitcnt lgkmcnt(4)
    v_mfma_f32_16x16x32_bf16 v[4:7], v[132:135], v[52:55], v[4:7]
    buffer_load_dwordx4 v[44:47], v149, s[4:7], s26 offen offset:1024
    s_add_u32 s26, s26, 2048
    v_mfma_f32_16x16x32_bf16 v[20:23], v[132:135], v[60:63], v[20:23]
    ds_read_b64_tr_b16 v[128:129], v144 offset:16384
    ds_read_b64_tr_b16 v[130:131], v144 offset:18432
    s_waitcnt lgkmcnt(4)
    v_mfma_f32_16x16x32_bf16 v[8:11], v[136:139], v[52:55], v[8:11]
    v_mfma_f32_16x16x32_bf16 v[24:27], v[136:139], v[60:63], v[24:27]
    ds_read_b64_tr_b16 v[132:133], v145 offset:16384
    ds_read_b64_tr_b16 v[134:135], v145 offset:18432
    s_waitcnt lgkmcnt(4)
    v_mfma_f32_16x16x32_bf16 v[12:15], v[140:143], v[52:55], v[12:15]
    v_mfma_f32_16x16x32_bf16 v[28:31], v[140:143], v[60:63], v[28:31]
    ds_read_b64_tr_b16 v[136:137], v146 offset:16384
    ds_read_b64_tr_b16 v[138:139], v146 offset:18432
    s_waitcnt vmcnt(22)
    s_barrier
    s_add_u32 m0, s29, 8192
    s_waitcnt lgkmcnt(4)
    v_mfma_f32_16x16x32_bf16 v[0:3], v[128:131], v[64:67], v[0:3]
    buffer_load_dwordx4 v150, s[8:11], s25 offen lds
    v_mfma_f32_16x16x32_bf16 v[16:19], v[128:131], v[72:75], v[16:19]
    ds_read_b64_tr_b16 v[140:141], v147 offset:16384
    ds_read_b64_tr_b16 v[142:143], v147 offset:18432
    s_add_u32 m0, s29, 9216
    s_waitcnt lgkmcnt(4)
    v_mfma_f32_16x16x32_bf16 v[4:7], v[132:135], v[64:67], v[4:7]
    buffer_load_dwordx4 v151, s[8:11], s25 offen lds
    s_add_u32 s25, s25, 131072
    v_mfma_f32_16x16x32_bf16 v[20:23], v[132:135], v[72:75], v[20:23]
    ds_read_b64_tr_b16 v[128:129], v144 offset:20480
    ds_read_b64_tr_b16 v[130:131], v144 offset:22528
    s_waitcnt lgkmcnt(4)
    v_mfma_f32_16x16x32_bf16 v[8:11], v[136:139], v[64:67], v[8:11]
    buffer_load_dwordx4 v[48:51], v148, s[4:7], s26 offen offset:0
    v_mfma_f32_16x16x32_bf16 v[24:27], v[136:139], v[72:75], v[24:27]
    ds_read_b64_tr_b16 v[132:133], v145 offset:20480
    ds_read_b64_tr_b16 v[134:135], v145 offset:22528
    s_waitcnt lgkmcnt(4)
    v_mfma_f32_16x16x32_bf16 v[12:15], v[140:143], v[64:67], v[12:15]
    buffer_load_dwordx4 v[52:55], v148, s[4:7], s26 offen offset:1024
    v_mfma_f32_16x16x32_bf16 v[28:31], v[140:143], v[72:75], v[28:31]
    ds_read_b64_tr_b16 v[136:137], v146 offset:20480
    ds_read_b64_tr_b16 v[138:139], v146 offset:22528
    s_waitcnt lgkmcnt(4)
    v_mfma_f32_16x16x32_bf16 v[0:3], v[128:131], v[68:71], v[0:3]
    buffer_load_dwordx4 v[56:59], v149, s[4:7], s26 offen offset:0
    v_mfma_f32_16x16x32_bf16 v[16:19], v[128:131], v[76:79], v[16:19]
    ds_read_b64_tr_b16 v[140:141], v147 offset:20480
    ds_read_b64_tr_b16 v[142:143], v147 offset:22528
    s_waitcnt lgkmcnt(4)
    v_mfma_f32_16x16x32_bf16 v[4:7], v[132:135], v[68:71], v[4:7]
    buffer_load_dwordx4 v[60:63], v149, s[4:7], s26 offen offset:1024
    s_add_u32 s26, s26, 2048
    v_mfma_f32_16x16x32_bf16 v[20:23], v[132:135], v[76:79], v[20:23]
    ds_read_b64_tr_b16 v[128:129], v144 offset:24576
    ds_read_b64_tr_b16 v[130:131], v144 offset:26624
    s_waitcnt lgkmcnt(4)
    v_mfma_f32_16x16x32_bf16 v[8:11], v[136:139], v[68:71], v[8:11]
    v_mfma_f32_16x16x32_bf16 v[24:27], v[136:139], v[76:79], v[24:27]
    ds_read_b64_tr_b16 v[132:133], v145 offset:24576
    ds_read_b64_tr_b16 v[134:135], v145 offset:26624
    s_waitcnt lgkmcnt(4)
    v_mfma_f32_16x16x32_bf16 v[12:15], v[140:143], v[68:71], v[12:15]
    v_mfma_f32_16x16x32_bf16 v[28:31], v[140:143], v[76:79], v[28:31]
    ds_read_b64_tr_b16 v[136:137], v146 offset:24576
    ds_read_b64_tr_b16 v[138:139], v146 offset:26624
    s_waitcnt vmcnt(22)
    s_barrier
    s_add_u32 m0, s29, 16384
    s_waitcnt lgkmcnt(4)
    v_mfma_f32_16x16x32_bf16 v[0:3], v[128:131], v[80:83], v[0:3]
    buffer_load_dwordx4 v150, s[8:11], s25 offen lds
    v_mfma_f32_16x16x32_bf16 v[16:19], v[128:131], v[88:91], v[16:19]
    ds_read_b64_tr_b16 v[140:141], v147 offset:24576
    ds_read_b64_tr_b16 v[142:143], v147 offset:26624
    s_add_u32 m0, s29, 17408
    s_waitcnt lgkmcnt(4)
    v_mfma_f32_16x16x32_bf16 v[4:7], v[132:135], v[80:83], v[4:7]
    buffer_load_dwordx4 v151, s[8:11], s25 offen lds
    s_add_u32 s25, s25, 131072
    v_mfma_f32_16x16x32_bf16 v[20:23], v[132:135], v[88:91], v[20:23]
    ds_read_b64_tr_b16 v[128:129], v144 offset:28672
    ds_read_b64_tr_b16 v[130:131], v144 offset:30720
    s_waitcnt lgkmcnt(4)
    v_mfma_f32_16x16x32_bf16 v[8:11], v[136:139], v[80:83], v[8:11]
    buffer_load_dwordx4 v[64:67], v148, s[4:7], s26 offen offset:0
    v_mfma_f32_16x16x32_bf16 v[24:27], v[136:139], v[88:91], v[24:27]
    ds_read_b64_tr_b16 v[132:133], v145 offset:28672
    ds_read_b64_tr_b16 v[134:135], v145 offset:30720
    s_waitcnt lgkmcnt(4)
    v_mfma_f32_16x16x32_bf16 v[12:15], v[140:143], v[80:83], v[12:15]
    buffer_load_dwordx4 v[68:71], v148, s[4:7], s26 offen offset:1024
    v_mfma_f32_16x16x32_bf16 v[28:31], v[140:143], v[88:91], v[28:31]
    ds_read_b64_tr_b16 v[136:137], v146 offset:28672
    ds_read_b64_tr_b16 v[138:139], v146 offset:30720
    s_waitcnt lgkmcnt(4)
    v_mfma_f32_16x16x32_bf16 v[0:3], v[128:131], v[84:87], v[0:3]
    buffer_load_dwordx4 v[72:75], v149, s[4:7], s26 offen offset:0
    v_mfma_f32_16x16x32_bf16 v[16:19], v[128:131], v[92:95], v[16:19]
    ds_read_b64_tr_b16 v[140:141], v147 offset:28672
    ds_read_b64_tr_b16 v[142:143], v147 offset:30720
    s_waitcnt lgkmcnt(4)
    v_mfma_f32_16x16x32_bf16 v[4:7], v[132:135], v[84:87], v[4:7]
    buffer_load_dwordx4 v[76:79], v149, s[4:7], s26 offen offset:1024
    s_add_u32 s26, s26, 2048
    v_mfma_f32_16x16x32_bf16 v[20:23], v[132:135], v[92:95], v[20:23]
    ds_read_b64_tr_b16 v[128:129], v144 offset:32768
    ds_read_b64_tr_b16 v[130:131], v144 offset:34816
    s_waitcnt lgkmcnt(4)
    v_mfma_f32_16x16x32_bf16 v[8:11], v[136:139], v[84:87], v[8:11]
    buffer_load_dword v160, v161, s[4:7], s52 offen sc1
    v_mfma_f32_16x16x32_bf16 v[24:27], v[136:139], v[92:95], v[24:27]
    ds_read_b64_tr_b16 v[132:133], v145 offset:32768
    ds_read_b64_tr_b16 v[134:135], v145 offset:34816
    s_waitcnt lgkmcnt(4)
    v_mfma_f32_16x16x32_bf16 v[12:15], v[140:143], v[84:87], v[12:15]
    v_mfma_f32_16x16x32_bf16 v[28:31], v[140:143], v[92:95], v[28:31]
    ds_read_b64_tr_b16 v[136:137], v146 offset:32768
    ds_read_b64_tr_b16 v[138:139], v146 offset:34816
    s_waitcnt vmcnt(23)
    s_barrier
    s_add_u32 m0, s29, 24576
    s_waitcnt lgkmcnt(4)
    v_mfma_f32_16x16x32_bf16 v[0:3], v[128:131], v[96:99], v[0:3]
    buffer_load_dwordx4 v150, s[8:11], s25 offen lds
    v_mfma_f32_16x16x32_bf16 v[16:19], v[128:131], v[104:107], v[16:19]
    ds_read_b64_tr_b16 v[140:141], v147 offset:32768
    ds_read_b64_tr_b16 v[142:143], v147 offset:34816
    s_add_u32 m0, s29, 25600
    s_waitcnt lgkmcnt(4)
    v_mfma_f32_16x16x32_bf16 v[4:7], v[132:135], v[96:99], v[4:7]
    buffer_load_dwordx4 v151, s[8:11], s25 offen lds
    s_add_u32 s25, s25, 131072
    v_mfma_f32_16x16x32_bf16 v[20:23], v[132:135], v[104:107], v[20:23]
    ds_read_b64_tr_b16 v[128:129], v144 offset:36864
    ds_read_b64_tr_b16 v[130:131], v144 offset:38912
    s_waitcnt lgkmcnt(4)
    v_mfma_f32_16x16x32_bf16 v[8:11], v[136:139], v[96:99], v[8:11]
    buffer_load_dwordx4 v[80:83], v148, s[4:7], s26 offen offset:0
    v_mfma_f32_16x16x32_bf16 v[24:27], v[136:139], v[104:107], v[24:27]
    ds_read_b64_tr_b16 v[132:133], v145 offset:36864
    ds_read_b64_tr_b16 v[134:135], v145 offset:38912
    s_waitcnt lgkmcnt(4)
    v_mfma_f32_16x16x32_bf16 v[12:15], v[140:143], v[96:99], v[12:15]
    buffer_load_dwordx4 v[84:87], v148, s[4:7], s26 offen offset:1024
    v_mfma_f32_16x16x32_bf16 v[28:31], v[140:143], v[104:107], v[28:31]
    ds_read_b64_tr_b16 v[136:137], v146 offset:36864
    ds_read_b64_tr_b16 v[138:139], v146 offset:38912
    s_waitcnt lgkmcnt(4)
    v_mfma_f32_16x16x32_bf16 v[0:3], v[128:131], v[100:103], v[0:3]
    buffer_load_dwordx4 v[88:91], v149, s[4:7], s26 offen offset:0
    v_mfma_f32_16x16x32_bf16 v[16:19], v[128:131], v[108:111], v[16:19]
    ds_read_b64_tr_b16 v[140:141], v147 offset:36864
    ds_read_b64_tr_b16 v[142:143], v147 offset:38912
    s_waitcnt lgkmcnt(4)
    v_mfma_f32_16x16x32_bf16 v[4:7], v[132:135], v[100:103], v[4:7]
    buffer_load_dwordx4 v[92:95], v149, s[4:7], s26 offen offset:1024
    s_add_u32 s26, s26, 2048
    v_mfma_f32_16x16x32_bf16 v[20:23], v[132:135], v[108:111], v[20:23]
    ds_read_b64_tr_b16 v[128:129], v144 offset:40960
    ds_read_b64_tr_b16 v[130:131], v144 offset:43008
    s_waitcnt lgkmcnt(4)
    v_mfma_f32_16x16x32_bf16 v[8:11], v[136:139], v[100:103], v[8:11]
    v_mfma_f32_16x16x32_bf16 v[24:27], v[136:139], v[108:111], v[24:27]
    ds_read_b64_tr_b16 v[132:133], v145 offset:40960
    ds_read_b64_tr_b16 v[134:135], v145 offset:43008
    s_waitcnt lgkmcnt(4)
    v_mfma_f32_16x16x32_bf16 v[12:15], v[140:143], v[100:103], v[12:15]
    v_mfma_f32_16x16x32_bf16 v[28:31], v[140:143], v[108:111], v[28:31]
    ds_read_b64_tr_b16 v[136:137], v146 offset:40960
    ds_read_b64_tr_b16 v[138:139], v146 offset:43008
    s_waitcnt vmcnt(6)
    v_readfirstlane_b32 s3, v160
    s_nop 0
    s_cmp_ge_u32 s3, 16
    s_cbranch_scc1 k2_kernel_o1_ok
k2_kernel_o1_spin:
    s_sleep 1
    buffer_load_dword v160, v161, s[4:7], s52 offen sc1
    s_waitcnt vmcnt(0)
    v_readfirstlane_b32 s3, v160
    s_nop 0
    s_cmp_lt_u32 s3, 16
    s_cbranch_scc1 k2_kernel_o1_spin
k2_kernel_o1_ok:
    s_setprio 3
    s_waitcnt vmcnt(23)
    s_barrier
    s_add_u32 m0, s29, 32768
    s_waitcnt lgkmcnt(4)
    v_mfma_f32_16x16x32_bf16 v[0:3], v[128:131], v[112:115], v[0:3]
    buffer_load_dwordx4 v150, s[8:11], s25 offen lds
    v_mfma_f32_16x16x32_bf16 v[16:19], v[128:131], v[120:123], v[16:19]
    ds_read_b64_tr_b16 v[140:141], v147 offset:40960
    ds_read_b64_tr_b16 v[142:143], v147 offset:43008
    s_add_u32 m0, s29, 33792
    s_waitcnt lgkmcnt(4)
    v_mfma_f32_16x16x32_bf16 v[4:7], v[132:135], v[112:115], v[4:7]
    buffer_load_dwordx4 v151, s[8:11], s25 offen lds
    s_add_u32 s25, s25, 131072
    v_mfma_f32_16x16x32_bf16 v[20:23], v[132:135], v[120:123], v[20:23]
    ds_read_b64_tr_b16 v[128:129], v144 offset:45056
    ds_read_b64_tr_b16 v[130:131], v144 offset:47104
    s_waitcnt lgkmcnt(4)
    v_mfma_f32_16x16x32_bf16 v[8:11], v[136:139], v[112:115], v[8:11]
    buffer_load_dwordx4 v[96:99], v148, s[4:7], s26 offen offset:0
    v_mfma_f32_16x16x32_bf16 v[24:27], v[136:139], v[120:123], v[24:27]
    ds_read_b64_tr_b16 v[132:133], v145 offset:45056
    ds_read_b64_tr_b16 v[134:135], v145 offset:47104
    s_waitcnt lgkmcnt(4)
    v_mfma_f32_16x16x32_bf16 v[12:15], v[140:143], v[112:115], v[12:15]
    buffer_load_dwordx4 v[100:103], v148, s[4:7], s26 offen offset:1024
    v_mfma_f32_16x16x32_bf16 v[28:31], v[140:143], v[120:123], v[28:31]
    ds_read_b64_tr_b16 v[136:137], v146 offset:45056
    ds_read_b64_tr_b16 v[138:139], v146 offset:47104
    s_waitcnt lgkmcnt(4)
    v_mfma_f32_16x16x32_bf16 v[0:3], v[128:131], v[116:119], v[0:3]
    buffer_load_dwordx4 v[104:107], v149, s[4:7], s26 offen offset:0
    v_mfma_f32_16x16x32_bf16 v[16:19], v[128:131], v[124:127], v[16:19]
    ds_read_b64_tr_b16 v[140:141], v147 offset:45056
    ds_read_b64_tr_b16 v[142:143], v147 offset:47104
    s_waitcnt lgkmcnt(4)
    v_mfma_f32_16x16x32_bf16 v[4:7], v[132:135], v[116:119], v[4:7]
    buffer_load_dwordx4 v[108:111], v149, s[4:7], s26 offen offset:1024
    s_add_u32 s26, s26, 2048
    v_mfma_f32_16x16x32_bf16 v[20:23], v[132:135], v[124:127], v[20:23]
    ds_read_b64_tr_b16 v[128:129], v144 offset:0
    ds_read_b64_tr_b16 v[130:131], v144 offset:2048
    s_waitcnt lgkmcnt(4)
    v_mfma_f32_16x16x32_bf16 v[8:11], v[136:139], v[116:119], v[8:11]
    v_mfma_f32_16x16x32_bf16 v[24:27], v[136:139], v[124:127], v[24:27]
    ds_read_b64_tr_b16 v[132:133], v145 offset:0
    ds_read_b64_tr_b16 v[134:135], v145 offset:2048
    s_waitcnt lgkmcnt(4)
    v_mfma_f32_16x16x32_bf16 v[12:15], v[140:143], v[116:119], v[12:15]
    v_mfma_f32_16x16x32_bf16 v[28:31], v[140:143], v[124:127], v[28:31]
    ds_read_b64_tr_b16 v[136:137], v146 offset:0
    ds_read_b64_tr_b16 v[138:139], v146 offset:2048
    s_waitcnt vmcnt(23)
    s_barrier
    s_add_u32 m0, s29, 40960
    s_waitcnt lgkmcnt(4)
    v_mfma_f32_16x16x32_bf16 v[0:3], v[128:131], v[32:35], v[0:3]
    buffer_load_dwordx4 v150, s[8:11], s25 offen lds
    v_mfma_f32_16x16x32_bf16 v[16:19], v[128:131], v[40:43], v[16:19]
    ds_read_b64_tr_b16 v[140:141], v147 offset:0
    ds_read_b64_tr_b16 v[142:143], v147 offset:2048
    s_add_u32 m0, s29, 41984
    s_waitcnt lgkmcnt(4)
    v_mfma_f32_16x16x32_bf16 v[4:7], v[132:135], v[32:35], v[4:7]
    buffer_load_dwordx4 v151, s[8:11], s25 offen lds
    s_add_u32 s25, s25, 131072
    v_mfma_f32_16x16x32_bf16 v[20:23], v[132:135], v[40:43], v[20:23]
    ds_read_b64_tr_b16 v[128:129], v144 offset:4096
    ds_read_b64_tr_b16 v[130:131], v144 offset:6144
    s_waitcnt lgkmcnt(4)
    v_mfma_f32_16x16x32_bf16 v[8:11], v[136:139], v[32:35], v[8:11]
    buffer_load_dwordx4 v[112:115], v148, s[4:7], s26 offen offset:0
    v_mfma_f32_16x16x32_bf16 v[24:27], v[136:139], v[40:43], v[24:27]
    ds_read_b64_tr_b16 v[132:133], v145 offset:4096
    ds_read_b64_tr_b16 v[134:135], v145 offset:6144
    s_waitcnt lgkmcnt(4)
    v_mfma_f32_16x16x32_bf16 v[12:15], v[140:143], v[32:35], v[12:15]
    buffer_load_dwordx4 v[116:119], v148, s[4:7], s26 offen offset:1024
    v_mfma_f32_16x16x32_bf16 v[28:31], v[140:143], v[40:43], v[28:31]
    ds_read_b64_tr_b16 v[136:137], v146 offset:4096
    ds_read_b64_tr_b16 v[138:139], v146 offset:6144
    s_waitcnt lgkmcnt(4)
    v_mfma_f32_16x16x32_bf16 v[0:3], v[128:131], v[36:39], v[0:3]
    buffer_load_dwordx4 v[120:123], v149, s[4:7], s26 offen offset:0
    v_mfma_f32_16x16x32_bf16 v[16:19], v[128:131], v[44:47], v[16:19]
    ds_read_b64_tr_b16 v[140:141], v147 offset:4096
    ds_read_b64_tr_b16 v[142:143], v147 offset:6144
    s_waitcnt lgkmcnt(4)
    v_mfma_f32_16x16x32_bf16 v[4:7], v[132:135], v[36:39], v[4:7]
    buffer_load_dwordx4 v[124:127], v149, s[4:7], s26 offen offset:1024
    s_add_u32 s26, s26, 2048
    v_mfma_f32_16x16x32_bf16 v[20:23], v[132:135], v[44:47], v[20:23]
    ds_read_b64_tr_b16 v[128:129], v144 offset:8192
    ds_read_b64_tr_b16 v[130:131], v144 offset:10240
    s_waitcnt lgkmcnt(4)
    v_mfma_f32_16x16x32_bf16 v[8:11], v[136:139], v[36:39], v[8:11]
    v_mfma_f32_16x16x32_bf16 v[24:27], v[136:139], v[44:47], v[24:27]
    ds_read_b64_tr_b16 v[132:133], v145 offset:8192
    ds_read_b64_tr_b16 v[134:135], v145 offset:10240
    s_waitcnt lgkmcnt(4)
    v_mfma_f32_16x16x32_bf16 v[12:15], v[140:143], v[36:39], v[12:15]
    v_mfma_f32_16x16x32_bf16 v[28:31], v[140:143], v[44:47], v[28:31]
    ds_read_b64_tr_b16 v[136:137], v146 offset:8192
    ds_read_b64_tr_b16 v[138:139], v146 offset:10240
    s_waitcnt vmcnt(23)
    s_barrier
    s_add_u32 m0, s29, 0
    s_waitcnt lgkmcnt(4)
    v_mfma_f32_16x16x32_bf16 v[0:3], v[128:131], v[48:51], v[0:3]
    buffer_load_dwordx4 v150, s[8:11], s25 offen lds
    v_mfma_f32_16x16x32_bf16 v[16:19], v[128:131], v[56:59], v[16:19]
    ds_read_b64_tr_b16 v[140:141], v147 offset:8192
    ds_read_b64_tr_b16 v[142:143], v147 offset:10240
    s_add_u32 m0, s29, 1024
    s_waitcnt lgkmcnt(4)
    v_mfma_f32_16x16x32_bf16 v[4:7], v[132:135], v[48:51], v[4:7]
    buffer_load_dwordx4 v151, s[8:11], s25 offen lds
    s_add_u32 s25, s25, 131072
    v_mfma_f32_16x16x32_bf16 v[20:23], v[132:135], v[56:59], v[20:23]
    ds_read_b64_tr_b16 v[128:129], v144 offset:12288
    ds_read_b64_tr_b16 v[130:131], v144 offset:14336
    s_waitcnt lgkmcnt(4)
    v_mfma_f32_16x16x32_bf16 v[8:11], v[136:139], v[48:51], v[8:11]
    buffer_load_dwordx4 v[32:35], v148, s[4:7], s26 offen offset:0
    v_mfma_f32_16x16x32_bf16 v[24:27], v[136:139], v[56:59], v[24:27]
    ds_read_b64_tr_b16 v[132:133], v145 offset:12288
    ds_read_b64_tr_b16 v[134:135], v145 offset:14336
    s_waitcnt lgkmcnt(4)
    v_mfma_f32_16x16x32_bf16 v[12:15], v[140:143], v[48:51], v[12:15]
    buffer_load_dwordx4 v[36:39], v148, s[4:7], s26 offen offset:1024
    v_mfma_f32_16x16x32_bf16 v[28:31], v[140:143], v[56:59], v[28:31]
    ds_read_b64_tr_b16 v[136:137], v146 offset:12288
    ds_read_b64_tr_b16 v[138:139], v146 offset:14336
    s_waitcnt lgkmcnt(4)
    v_mfma_f32_16x16x32_bf16 v[0:3], v[128:131], v[52:55], v[0:3]
    buffer_load_dwordx4 v[40:43], v149, s[4:7], s26 offen offset:0
    v_mfma_f32_16x16x32_bf16 v[16:19], v[128:131], v[60:63], v[16:19]
    ds_read_b64_tr_b16 v[140:141], v147 offset:12288
    ds_read_b64_tr_b16 v[142:143], v147 offset:14336
    s_waitcnt lgkmcnt(4)
    v_mfma_f32_16x16x32_bf16 v[4:7], v[132:135], v[52:55], v[4:7]
    buffer_load_dwordx4 v[44:47], v149, s[4:7], s26 offen offset:1024
    s_add_u32 s26, s26, 2048
    v_mfma_f32_16x16x32_bf16 v[20:23], v[132:135], v[60:63], v[20:23]
    ds_read_b64_tr_b16 v[128:129], v144 offset:16384
    ds_read_b64_tr_b16 v[130:131], v144 offset:18432
    s_waitcnt lgkmcnt(4)
    v_mfma_f32_16x16x32_bf16 v[8:11], v[136:139], v[52:55], v[8:11]
    v_mfma_f32_16x16x32_bf16 v[24:27], v[136:139], v[60:63], v[24:27]
    ds_read_b64_tr_b16 v[132:133], v145 offset:16384
    ds_read_b64_tr_b16 v[134:135], v145 offset:18432
    s_waitcnt lgkmcnt(4)
    v_mfma_f32_16x16x32_bf16 v[12:15], v[140:143], v[52:55], v[12:15]
    v_mfma_f32_16x16x32_bf16 v[28:31], v[140:143], v[60:63], v[28:31]
    ds_read_b64_tr_b16 v[136:137], v146 offset:16384
    ds_read_b64_tr_b16 v[138:139], v146 offset:18432
    s_waitcnt vmcnt(22)
    s_barrier
    s_add_u32 m0, s29, 8192
    s_waitcnt lgkmcnt(4)
    v_mfma_f32_16x16x32_bf16 v[0:3], v[128:131], v[64:67], v[0:3]
    buffer_load_dwordx4 v150, s[8:11], s25 offen lds
    v_mfma_f32_16x16x32_bf16 v[16:19], v[128:131], v[72:75], v[16:19]
    ds_read_b64_tr_b16 v[140:141], v147 offset:16384
    ds_read_b64_tr_b16 v[142:143], v147 offset:18432
    s_add_u32 m0, s29, 9216
    s_waitcnt lgkmcnt(4)
    v_mfma_f32_16x16x32_bf16 v[4:7], v[132:135], v[64:67], v[4:7]
    buffer_load_dwordx4 v151, s[8:11], s25 offen lds
    s_add_u32 s25, s25, 131072
    v_mfma_f32_16x16x32_bf16 v[20:23], v[132:135], v[72:75], v[20:23]
    ds_read_b64_tr_b16 v[128:129], v144 offset:20480
    ds_read_b64_tr_b16 v[130:131], v144 offset:22528
    s_waitcnt lgkmcnt(4)
    v_mfma_f32_16x16x32_bf16 v[8:11], v[136:139], v[64:67], v[8:11]
    buffer_load_dwordx4 v[48:51], v148, s[4:7], s26 offen offset:0
    v_mfma_f32_16x16x32_bf16 v[24:27], v[136:139], v[72:75], v[24:27]
    ds_read_b64_tr_b16 v[132:133], v145 offset:20480
    ds_read_b64_tr_b16 v[134:135], v145 offset:22528
    s_waitcnt lgkmcnt(4)
    v_mfma_f32_16x16x32_bf16 v[12:15], v[140:143], v[64:67], v[12:15]
    buffer_load_dwordx4 v[52:55], v148, s[4:7], s26 offen offset:1024
    v_mfma_f32_16x16x32_bf16 v[28:31], v[140:143], v[72:75], v[28:31]
    ds_read_b64_tr_b16 v[136:137], v146 offset:20480
    ds_read_b64_tr_b16 v[138:139], v146 offset:22528
    s_waitcnt lgkmcnt(4)
    v_mfma_f32_16x16x32_bf16 v[0:3], v[128:131], v[68:71], v[0:3]
    buffer_load_dwordx4 v[56:59], v149, s[4:7], s26 offen offset:0
    v_mfma_f32_16x16x32_bf16 v[16:19], v[128:131], v[76:79], v[16:19]
    ds_read_b64_tr_b16 v[140:141], v147 offset:20480
    ds_read_b64_tr_b16 v[142:143], v147 offset:22528
    s_waitcnt lgkmcnt(4)
    v_mfma_f32_16x16x32_bf16 v[4:7], v[132:135], v[68:71], v[4:7]
    buffer_load_dwordx4 v[60:63], v149, s[4:7], s26 offen offset:1024
    s_add_u32 s26, s26, 2048
    v_mfma_f32_16x16x32_bf16 v[20:23], v[132:135], v[76:79], v[20:23]
    ds_read_b64_tr_b16 v[128:129], v144 offset:24576
    ds_read_b64_tr_b16 v[130:131], v144 offset:26624
    s_waitcnt lgkmcnt(4)
    v_mfma_f32_16x16x32_bf16 v[8:11], v[136:139], v[68:71], v[8:11]
    v_mfma_f32_16x16x32_bf16 v[24:27], v[136:139], v[76:79], v[24:27]
    ds_read_b64_tr_b16 v[132:133], v145 offset:24576
    ds_read_b64_tr_b16 v[134:135], v145 offset:26624
    s_waitcnt lgkmcnt(4)
    v_mfma_f32_16x16x32_bf16 v[12:15], v[140:143], v[68:71], v[12:15]
    v_mfma_f32_16x16x32_bf16 v[28:31], v[140:143], v[76:79], v[28:31]
    ds_read_b64_tr_b16 v[136:137], v146 offset:24576
    ds_read_b64_tr_b16 v[138:139], v146 offset:26624
    s_waitcnt vmcnt(22)
    s_barrier
    s_add_u32 m0, s29, 16384
    s_waitcnt lgkmcnt(4)
    v_mfma_f32_16x16x32_bf16 v[0:3], v[128:131], v[80:83], v[0:3]
    buffer_load_dwordx4 v150, s[8:11], s25 offen lds
    v_mfma_f32_16x16x32_bf16 v[16:19], v[128:131], v[88:91], v[16:19]
    ds_read_b64_tr_b16 v[140:141], v147 offset:24576
    ds_read_b64_tr_b16 v[142:143], v147 offset:26624
    s_add_u32 m0, s29, 17408
    s_waitcnt lgkmcnt(4)
    v_mfma_f32_16x16x32_bf16 v[4:7], v[132:135], v[80:83], v[4:7]
    buffer_load_dwordx4 v151, s[8:11], s25 offen lds
    s_add_u32 s25, s25, 131072
    v_mfma_f32_16x16x32_bf16 v[20:23], v[132:135], v[88:91], v[20:23]
    ds_read_b64_tr_b16 v[128:129], v144 offset:28672
    ds_read_b64_tr_b16 v[130:131], v144 offset:30720
    s_waitcnt lgkmcnt(4)
    v_mfma_f32_16x16x32_bf16 v[8:11], v[136:139], v[80:83], v[8:11]
    buffer_load_dwordx4 v[64:67], v148, s[4:7], s26 offen offset:0
    v_mfma_f32_16x16x32_bf16 v[24:27], v[136:139], v[88:91], v[24:27]
    ds_read_b64_tr_b16 v[132:133], v145 offset:28672
    ds_read_b64_tr_b16 v[134:135], v145 offset:30720
    s_waitcnt lgkmcnt(4)
    v_mfma_f32_16x16x32_bf16 v[12:15], v[140:143], v[80:83], v[12:15]
    buffer_load_dwordx4 v[68:71], v148, s[4:7], s26 offen offset:1024
    v_mfma_f32_16x16x32_bf16 v[28:31], v[140:143], v[88:91], v[28:31]
    ds_read_b64_tr_b16 v[136:137], v146 offset:28672
    ds_read_b64_tr_b16 v[138:139], v146 offset:30720
    s_waitcnt lgkmcnt(4)
    v_mfma_f32_16x16x32_bf16 v[0:3], v[128:131], v[84:87], v[0:3]
    buffer_load_dwordx4 v[72:75], v149, s[4:7], s26 offen offset:0
    v_mfma_f32_16x16x32_bf16 v[16:19], v[128:131], v[92:95], v[16:19]
    ds_read_b64_tr_b16 v[140:141], v147 offset:28672
    ds_read_b64_tr_b16 v[142:143], v147 offset:30720
    s_waitcnt lgkmcnt(4)
    v_mfma_f32_16x16x32_bf16 v[4:7], v[132:135], v[84:87], v[4:7]
    buffer_load_dwordx4 v[76:79], v149, s[4:7], s26 offen offset:1024
    s_add_u32 s26, s26, 2048
    v_mfma_f32_16x16x32_bf16 v[20:23], v[132:135], v[92:95], v[20:23]
    ds_read_b64_tr_b16 v[128:129], v144 offset:32768
    ds_read_b64_tr_b16 v[130:131], v144 offset:34816
    s_waitcnt lgkmcnt(4)
    v_mfma_f32_16x16x32_bf16 v[8:11], v[136:139], v[84:87], v[8:11]
    v_mfma_f32_16x16x32_bf16 v[24:27], v[136:139], v[92:95], v[24:27]
    ds_read_b64_tr_b16 v[132:133], v145 offset:32768
    ds_read_b64_tr_b16 v[134:135], v145 offset:34816
    s_waitcnt lgkmcnt(4)
    v_mfma_f32_16x16x32_bf16 v[12:15], v[140:143], v[84:87], v[12:15]
    v_mfma_f32_16x16x32_bf16 v[28:31], v[140:143], v[92:95], v[28:31]
    ds_read_b64_tr_b16 v[136:137], v146 offset:32768
    ds_read_b64_tr_b16 v[138:139], v146 offset:34816
    s_waitcnt vmcnt(22)
    s_barrier
    s_add_u32 m0, s29, 24576
    s_waitcnt lgkmcnt(4)
    v_mfma_f32_16x16x32_bf16 v[0:3], v[128:131], v[96:99], v[0:3]
    buffer_load_dwordx4 v150, s[8:11], s25 offen lds
    v_mfma_f32_16x16x32_bf16 v[16:19], v[128:131], v[104:107], v[16:19]
    ds_read_b64_tr_b16 v[140:141], v147 offset:32768
    ds_read_b64_tr_b16 v[142:143], v147 offset:34816
    s_add_u32 m0, s29, 25600
    s_waitcnt lgkmcnt(4)
    v_mfma_f32_16x16x32_bf16 v[4:7], v[132:135], v[96:99], v[4:7]
    buffer_load_dwordx4 v151, s[8:11], s25 offen lds
    s_add_u32 s25, s25, 131072
    v_mfma_f32_16x16x32_bf16 v[20:23], v[132:135], v[104:107], v[20:23]
    ds_read_b64_tr_b16 v[128:129], v144 offset:36864
    ds_read_b64_tr_b16 v[130:131], v144 offset:38912
    s_waitcnt lgkmcnt(4)
    v_mfma_f32_16x16x32_bf16 v[8:11], v[136:139], v[96:99], v[8:11]
    buffer_load_dwordx4 v[80:83], v148, s[4:7], s26 offen offset:0
    v_mfma_f32_16x16x32_bf16 v[24:27], v[136:139], v[104:107], v[24:27]
    ds_read_b64_tr_b16 v[132:133], v145 offset:36864
    ds_read_b64_tr_b16 v[134:135], v145 offset:38912
    s_waitcnt lgkmcnt(4)
    v_mfma_f32_16x16x32_bf16 v[12:15], v[140:143], v[96:99], v[12:15]
    buffer_load_dwordx4 v[84:87], v148, s[4:7], s26 offen offset:1024
    v_mfma_f32_16x16x32_bf16 v[28:31], v[140:143], v[104:107], v[28:31]
    ds_read_b64_tr_b16 v[136:137], v146 offset:36864
    ds_read_b64_tr_b16 v[138:139], v146 offset:38912
    s_waitcnt lgkmcnt(4)
    v_mfma_f32_16x16x32_bf16 v[0:3], v[128:131], v[100:103], v[0:3]
    buffer_load_dwordx4 v[88:91], v149, s[4:7], s26 offen offset:0
    v_mfma_f32_16x16x32_bf16 v[16:19], v[128:131], v[108:111], v[16:19]
    ds_read_b64_tr_b16 v[140:141], v147 offset:36864
    ds_read_b64_tr_b16 v[142:143], v147 offset:38912
    s_waitcnt lgkmcnt(4)
    v_mfma_f32_16x16x32_bf16 v[4:7], v[132:135], v[100:103], v[4:7]
    buffer_load_dwordx4 v[92:95], v149, s[4:7], s26 offen offset:1024
    s_add_u32 s26, s26, 2048
    v_mfma_f32_16x16x32_bf16 v[20:23], v[132:135], v[108:111], v[20:23]
    ds_read_b64_tr_b16 v[128:129], v144 offset:40960
    ds_read_b64_tr_b16 v[130:131], v144 offset:43008
    s_waitcnt lgkmcnt(4)
    v_mfma_f32_16x16x32_bf16 v[8:11], v[136:139], v[100:103], v[8:11]
    v_mfma_f32_16x16x32_bf16 v[24:27], v[136:139], v[108:111], v[24:27]
    ds_read_b64_tr_b16 v[132:133], v145 offset:40960
    ds_read_b64_tr_b16 v[134:135], v145 offset:43008
    s_waitcnt lgkmcnt(4)
    v_mfma_f32_16x16x32_bf16 v[12:15], v[140:143], v[100:103], v[12:15]
    v_mfma_f32_16x16x32_bf16 v[28:31], v[140:143], v[108:111], v[28:31]
    ds_read_b64_tr_b16 v[136:137], v146 offset:40960
    ds_read_b64_tr_b16 v[138:139], v146 offset:43008
    s_waitcnt vmcnt(22)
    s_barrier
    s_add_u32 m0, s29, 32768
    s_waitcnt lgkmcnt(4)
    v_mfma_f32_16x16x32_bf16 v[0:3], v[128:131], v[112:115], v[0:3]
    buffer_load_dwordx4 v150, s[8:11], s25 offen lds
    v_mfma_f32_16x16x32_bf16 v[16:19], v[128:131], v[120:123], v[16:19]
    ds_read_b64_tr_b16 v[140:141], v147 offset:40960
    ds_read_b64_tr_b16 v[142:143], v147 offset:43008
    s_add_u32 m0, s29, 33792
    s_waitcnt lgkmcnt(4)
    v_mfma_f32_16x16x32_bf16 v[4:7], v[132:135], v[112:115], v[4:7]
    buffer_load_dwordx4 v151, s[8:11], s25 offen lds
    s_add_u32 s25, s25, 131072
    v_mfma_f32_16x16x32_bf16 v[20:23], v[132:135], v[120:123], v[20:23]
    ds_read_b64_tr_b16 v[128:129], v144 offset:45056
    ds_read_b64_tr_b16 v[130:131], v144 offset:47104
    s_waitcnt lgkmcnt(4)
    v_mfma_f32_16x16x32_bf16 v[8:11], v[136:139], v[112:115], v[8:11]
    buffer_load_dwordx4 v[96:99], v148, s[4:7], s26 offen offset:0
    v_mfma_f32_16x16x32_bf16 v[24:27], v[136:139], v[120:123], v[24:27]
    ds_read_b64_tr_b16 v[132:133], v145 offset:45056
    ds_read_b64_tr_b16 v[134:135], v145 offset:47104
    s_waitcnt lgkmcnt(4)
    v_mfma_f32_16x16x32_bf16 v[12:15], v[140:143], v[112:115], v[12:15]
    buffer_load_dwordx4 v[100:103], v148, s[4:7], s26 offen offset:1024
    v_mfma_f32_16x16x32_bf16 v[28:31], v[140:143], v[120:123], v[28:31]
    ds_read_b64_tr_b16 v[136:137], v146 offset:45056
    ds_read_b64_tr_b16 v[138:139], v146 offset:47104
    s_waitcnt lgkmcnt(4)
    v_mfma_f32_16x16x32_bf16 v[0:3], v[128:131], v[116:119], v[0:3]
    buffer_load_dwordx4 v[104:107], v149, s[4:7], s26 offen offset:0
    v_mfma_f32_16x16x32_bf16 v[16:19], v[128:131], v[124:127], v[16:19]
    ds_read_b64_tr_b16 v[140:141], v147 offset:45056
    ds_read_b64_tr_b16 v[142:143], v147 offset:47104
    s_waitcnt lgkmcnt(4)
    v_mfma_f32_16x16x32_bf16 v[4:7], v[132:135], v[116:119], v[4:7]
    buffer_load_dwordx4 v[108:111], v149, s[4:7], s26 offen offset:1024
    s_add_u32 s26, s26, 2048
    v_mfma_f32_16x16x32_bf16 v[20:23], v[132:135], v[124:127], v[20:23]
    ds_read_b64_tr_b16 v[128:129], v144 offset:0
    ds_read_b64_tr_b16 v[130:131], v144 offset:2048
    s_waitcnt lgkmcnt(4)
    v_mfma_f32_16x16x32_bf16 v[8:11], v[136:139], v[116:119], v[8:11]
    v_mfma_f32_16x16x32_bf16 v[24:27], v[136:139], v[124:127], v[24:27]
    ds_read_b64_tr_b16 v[132:133], v145 offset:0
    ds_read_b64_tr_b16 v[134:135], v145 offset:2048
    s_waitcnt lgkmcnt(4)
    v_mfma_f32_16x16x32_bf16 v[12:15], v[140:143], v[116:119], v[12:15]
    v_mfma_f32_16x16x32_bf16 v[28:31], v[140:143], v[124:127], v[28:31]
    ds_read_b64_tr_b16 v[136:137], v146 offset:0
    ds_read_b64_tr_b16 v[138:139], v146 offset:2048
    s_waitcnt vmcnt(22)
    s_barrier
    s_add_u32 m0, s29, 40960
    s_waitcnt lgkmcnt(4)
    v_mfma_f32_16x16x32_bf16 v[0:3], v[128:131], v[32:35], v[0:3]
    buffer_load_dwordx4 v150, s[8:11], s25 offen lds
    v_mfma_f32_16x16x32_bf16 v[16:19], v[128:131], v[40:43], v[16:19]
    ds_read_b64_tr_b16 v[140:141], v147 offset:0
    ds_read_b64_tr_b16 v[142:143], v147 offset:2048
    s_add_u32 m0, s29, 41984
    s_waitcnt lgkmcnt(4)
    v_mfma_f32_16x16x32_bf16 v[4:7], v[132:135], v[32:35], v[4:7]
    buffer_load_dwordx4 v151, s[8:11], s25 offen lds
    s_add_u32 s25, s25, 131072
    v_mfma_f32_16x16x32_bf16 v[20:23], v[132:135], v[40:43], v[20:23]
    ds_read_b64_tr_b16 v[128:129], v144 offset:4096
    ds_read_b64_tr_b16 v[130:131], v144 offset:6144
    s_waitcnt lgkmcnt(4)
    v_mfma_f32_16x16x32_bf16 v[8:11], v[136:139], v[32:35], v[8:11]
    buffer_load_dwordx4 v[112:115], v148, s[4:7], s26 offen offset:0
    v_mfma_f32_16x16x32_bf16 v[24:27], v[136:139], v[40:43], v[24:27]
    ds_read_b64_tr_b16 v[132:133], v145 offset:4096
    ds_read_b64_tr_b16 v[134:135], v145 offset:6144
    s_waitcnt lgkmcnt(4)
    v_mfma_f32_16x16x32_bf16 v[12:15], v[140:143], v[32:35], v[12:15]
    buffer_load_dwordx4 v[116:119], v148, s[4:7], s26 offen offset:1024
    v_mfma_f32_16x16x32_bf16 v[28:31], v[140:143], v[40:43], v[28:31]
    ds_read_b64_tr_b16 v[136:137], v146 offset:4096
    ds_read_b64_tr_b16 v[138:139], v146 offset:6144
    s_waitcnt lgkmcnt(4)
    v_mfma_f32_16x16x32_bf16 v[0:3], v[128:131], v[36:39], v[0:3]
    buffer_load_dwordx4 v[120:123], v149, s[4:7], s26 offen offset:0
    v_mfma_f32_16x16x32_bf16 v[16:19], v[128:131], v[44:47], v[16:19]
    ds_read_b64_tr_b16 v[140:141], v147 offset:4096
    ds_read_b64_tr_b16 v[142:143], v147 offset:6144
    s_waitcnt lgkmcnt(4)
    v_mfma_f32_16x16x32_bf16 v[4:7], v[132:135], v[36:39], v[4:7]
    buffer_load_dwordx4 v[124:127], v149, s[4:7], s26 offen offset:1024
    s_add_u32 s26, s26, 2048
    v_mfma_f32_16x16x32_bf16 v[20:23], v[132:135], v[44:47], v[20:23]
    ds_read_b64_tr_b16 v[128:129], v144 offset:8192
    ds_read_b64_tr_b16 v[130:131], v144 offset:10240
    s_waitcnt lgkmcnt(4)
    v_mfma_f32_16x16x32_bf16 v[8:11], v[136:139], v[36:39], v[8:11]
    v_mfma_f32_16x16x32_bf16 v[24:27], v[136:139], v[44:47], v[24:27]
    ds_read_b64_tr_b16 v[132:133], v145 offset:8192
    ds_read_b64_tr_b16 v[134:135], v145 offset:10240
    s_waitcnt lgkmcnt(4)
    v_mfma_f32_16x16x32_bf16 v[12:15], v[140:143], v[36:39], v[12:15]
    v_mfma_f32_16x16x32_bf16 v[28:31], v[140:143], v[44:47], v[28:31]
    ds_read_b64_tr_b16 v[136:137], v146 offset:8192
    ds_read_b64_tr_b16 v[138:139], v146 offset:10240
    s_waitcnt vmcnt(22)
    s_barrier
    s_waitcnt lgkmcnt(4)
    v_mfma_f32_16x16x32_bf16 v[0:3], v[128:131], v[48:51], v[0:3]
    v_mfma_f32_16x16x32_bf16 v[16:19], v[128:131], v[56:59], v[16:19]
    ds_read_b64_tr_b16 v[140:141], v147 offset:8192
    ds_read_b64_tr_b16 v[142:143], v147 offset:10240
    s_waitcnt lgkmcnt(4)
    v_mfma_f32_16x16x32_bf16 v[4:7], v[132:135], v[48:51], v[4:7]
    v_mfma_f32_16x16x32_bf16 v[20:23], v[132:135], v[56:59], v[20:23]
    ds_read_b64_tr_b16 v[128:129], v144 offset:12288
    ds_read_b64_tr_b16 v[130:131], v144 offset:14336
    s_waitcnt lgkmcnt(4)
    v_mfma_f32_16x16x32_bf16 v[8:11], v[136:139], v[48:51], v[8:11]
    v_mfma_f32_16x16x32_bf16 v[24:27], v[136:139], v[56:59], v[24:27]
    ds_read_b64_tr_b16 v[132:133], v145 offset:12288
    ds_read_b64_tr_b16 v[134:135], v145 offset:14336
    s_waitcnt lgkmcnt(4)
    v_mfma_f32_16x16x32_bf16 v[12:15], v[140:143], v[48:51], v[12:15]
    v_mfma_f32_16x16x32_bf16 v[28:31], v[140:143], v[56:59], v[28:31]
    ds_read_b64_tr_b16 v[136:137], v146 offset:12288
    ds_read_b64_tr_b16 v[138:139], v146 offset:14336
    s_waitcnt lgkmcnt(4)
    v_mfma_f32_16x16x32_bf16 v[0:3], v[128:131], v[52:55], v[0:3]
    v_mfma_f32_16x16x32_bf16 v[16:19], v[128:131], v[60:63], v[16:19]
    ds_read_b64_tr_b16 v[140:141], v147 offset:12288
    ds_read_b64_tr_b16 v[142:143], v147 offset:14336
    s_waitcnt lgkmcnt(4)
    v_mfma_f32_16x16x32_bf16 v[4:7], v[132:135], v[52:55], v[4:7]
    v_mfma_f32_16x16x32_bf16 v[20:23], v[132:135], v[60:63], v[20:23]
    ds_read_b64_tr_b16 v[128:129], v144 offset:16384
    ds_read_b64_tr_b16 v[130:131], v144 offset:18432
    s_waitcnt lgkmcnt(4)
    v_mfma_f32_16x16x32_bf16 v[8:11], v[136:139], v[52:55], v[8:11]
    v_mfma_f32_16x16x32_bf16 v[24:27], v[136:139], v[60:63], v[24:27]
    ds_read_b64_tr_b16 v[132:133], v145 offset:16384
    ds_read_b64_tr_b16 v[134:135], v145 offset:18432
    s_waitcnt lgkmcnt(4)
    v_mfma_f32_16x16x32_bf16 v[12:15], v[140:143], v[52:55], v[12:15]
    v_mfma_f32_16x16x32_bf16 v[28:31], v[140:143], v[60:63], v[28:31]
    ds_read_b64_tr_b16 v[136:137], v146 offset:16384
    ds_read_b64_tr_b16 v[138:139], v146 offset:18432
    s_waitcnt vmcnt(16)
    s_barrier
    s_waitcnt lgkmcnt(4)
    v_mfma_f32_16x16x32_bf16 v[0:3], v[128:131], v[64:67], v[0:3]
    v_mfma_f32_16x16x32_bf16 v[16:19], v[128:131], v[72:75], v[16:19]
    ds_read_b64_tr_b16 v[140:141], v147 offset:16384
    ds_read_b64_tr_b16 v[142:143], v147 offset:18432
    s_waitcnt lgkmcnt(4)
    v_mfma_f32_16x16x32_bf16 v[4:7], v[132:135], v[64:67], v[4:7]
    v_mfma_f32_16x16x32_bf16 v[20:23], v[132:135], v[72:75], v[20:23]
    ds_read_b64_tr_b16 v[128:129], v144 offset:20480
    ds_read_b64_tr_b16 v[130:131], v144 offset:22528
    s_waitcnt lgkmcnt(4)
    v_mfma_f32_16x16x32_bf16 v[8:11], v[136:139], v[64:67], v[8:11]
    v_mfma_f32_16x16x32_bf16 v[24:27], v[136:139], v[72:75], v[24:27]
    ds_read_b64_tr_b16 v[132:133], v145 offset:20480
    ds_read_b64_tr_b16 v[134:135], v145 offset:22528
    s_waitcnt lgkmcnt(4)
    v_mfma_f32_16x16x32_bf16 v[12:15], v[140:143], v[64:67], v[12:15]
    v_mfma_f32_16x16x32_bf16 v[28:31], v[140:143], v[72:75], v[28:31]
    ds_read_b64_tr_b16 v[136:137], v146 offset:20480
    ds_read_b64_tr_b16 v[138:139], v146 offset:22528
    s_waitcnt lgkmcnt(4)
    v_mfma_f32_16x16x32_bf16 v[0:3], v[128:131], v[68:71], v[0:3]
    v_mfma_f32_16x16x32_bf16 v[16:19], v[128:131], v[76:79], v[16:19]
    ds_read_b64_tr_b16 v[140:141], v147 offset:20480
    ds_read_b64_tr_b16 v[142:143], v147 offset:22528
    s_waitcnt lgkmcnt(4)
    v_mfma_f32_16x16x32_bf16 v[4:7], v[132:135], v[68:71], v[4:7]
    v_mfma_f32_16x16x32_bf16 v[20:23], v[132:135], v[76:79], v[20:23]
    ds_read_b64_tr_b16 v[128:129], v144 offset:24576
    ds_read_b64_tr_b16 v[130:131], v144 offset:26624
    s_waitcnt lgkmcnt(4)
    v_mfma_f32_16x16x32_bf16 v[8:11], v[136:139], v[68:71], v[8:11]
    v_mfma_f32_16x16x32_bf16 v[24:27], v[136:139], v[76:79], v[24:27]
    ds_read_b64_tr_b16 v[132:133], v145 offset:24576
    ds_read_b64_tr_b16 v[134:135], v145 offset:26624
    s_waitcnt lgkmcnt(4)
    v_mfma_f32_16x16x32_bf16 v[12:15], v[140:143], v[68:71], v[12:15]
    v_mfma_f32_16x16x32_bf16 v[28:31], v[140:143], v[76:79], v[28:31]
    ds_read_b64_tr_b16 v[136:137], v146 offset:24576
    ds_read_b64_tr_b16 v[138:139], v146 offset:26624
    s_waitcnt vmcnt(10)
    s_barrier
    s_waitcnt lgkmcnt(4)
    v_mfma_f32_16x16x32_bf16 v[0:3], v[128:131], v[80:83], v[0:3]
    v_mfma_f32_16x16x32_bf16 v[16:19], v[128:131], v[88:91], v[16:19]
    ds_read_b64_tr_b16 v[140:141], v147 offset:24576
    ds_read_b64_tr_b16 v[142:143], v147 offset:26624
    s_waitcnt lgkmcnt(4)
    v_mfma_f32_16x16x32_bf16 v[4:7], v[132:135], v[80:83], v[4:7]
    v_mfma_f32_16x16x32_bf16 v[20:23], v[132:135], v[88:91], v[20:23]
    ds_read_b64_tr_b16 v[128:129], v144 offset:28672
    ds_read_b64_tr_b16 v[130:131], v144 offset:30720
    s_waitcnt lgkmcnt(4)
    v_mfma_f32_16x16x32_bf16 v[8:11], v[136:139], v[80:83], v[8:11]
    v_mfma_f32_16x16x32_bf16 v[24:27], v[136:139], v[88:91], v[24:27]
    ds_read_b64_tr_b16 v[132:133], v145 offset:28672
    ds_read_b64_tr_b16 v[134:135], v145 offset:30720
    s_waitcnt lgkmcnt(4)
    v_mfma_f32_16x16x32_bf16 v[12:15], v[140:143], v[80:83], v[12:15]
    v_mfma_f32_16x16x32_bf16 v[28:31], v[140:143], v[88:91], v[28:31]
    ds_read_b64_tr_b16 v[136:137], v146 offset:28672
    ds_read_b64_tr_b16 v[138:139], v146 offset:30720
    s_waitcnt lgkmcnt(4)
    v_mfma_f32_16x16x32_bf16 v[0:3], v[128:131], v[84:87], v[0:3]
    v_mfma_f32_16x16x32_bf16 v[16:19], v[128:131], v[92:95], v[16:19]
    ds_read_b64_tr_b16 v[140:141], v147 offset:28672
    ds_read_b64_tr_b16 v[142:143], v147 offset:30720
    s_waitcnt lgkmcnt(4)
    v_mfma_f32_16x16x32_bf16 v[4:7], v[132:135], v[84:87], v[4:7]
    v_mfma_f32_16x16x32_bf16 v[20:23], v[132:135], v[92:95], v[20:23]
    ds_read_b64_tr_b16 v[128:129], v144 offset:32768
    ds_read_b64_tr_b16 v[130:131], v144 offset:34816
    s_waitcnt lgkmcnt(4)
    v_mfma_f32_16x16x32_bf16 v[8:11], v[136:139], v[84:87], v[8:11]
    v_mfma_f32_16x16x32_bf16 v[24:27], v[136:139], v[92:95], v[24:27]
    ds_read_b64_tr_b16 v[132:133], v145 offset:32768
    ds_read_b64_tr_b16 v[134:135], v145 offset:34816
    s_waitcnt lgkmcnt(4)
    v_mfma_f32_16x16x32_bf16 v[12:15], v[140:143], v[84:87], v[12:15]
    v_mfma_f32_16x16x32_bf16 v[28:31], v[140:143], v[92:95], v[28:31]
    ds_read_b64_tr_b16 v[136:137], v146 offset:32768
    ds_read_b64_tr_b16 v[138:139], v146 offset:34816
    s_waitcnt vmcnt(4)
    s_barrier
    s_waitcnt lgkmcnt(4)
    v_mfma_f32_16x16x32_bf16 v[0:3], v[128:131], v[96:99], v[0:3]
    v_mfma_f32_16x16x32_bf16 v[16:19], v[128:131], v[104:107], v[16:19]
    ds_read_b64_tr_b16 v[140:141], v147 offset:32768
    ds_read_b64_tr_b16 v[142:143], v147 offset:34816
    s_waitcnt lgkmcnt(4)
    v_mfma_f32_16x16x32_bf16 v[4:7], v[132:135], v[96:99], v[4:7]
    v_mfma_f32_16x16x32_bf16 v[20:23], v[132:135], v[104:107], v[20:23]
    ds_read_b64_tr_b16 v[128:129], v144 offset:36864
    ds_read_b64_tr_b16 v[130:131], v144 offset:38912
    s_waitcnt lgkmcnt(4)
    v_mfma_f32_16x16x32_bf16 v[8:11], v[136:139], v[96:99], v[8:11]
    v_mfma_f32_16x16x32_bf16 v[24:27], v[136:139], v[104:107], v[24:27]
    ds_read_b64_tr_b16 v[132:133], v145 offset:36864
    ds_read_b64_tr_b16 v[134:135], v145 offset:38912
    s_waitcnt lgkmcnt(4)
    v_mfma_f32_16x16x32_bf16 v[12:15], v[140:143], v[96:99], v[12:15]
    v_mfma_f32_16x16x32_bf16 v[28:31], v[140:143], v[104:107], v[28:31]
    ds_read_b64_tr_b16 v[136:137], v146 offset:36864
    ds_read_b64_tr_b16 v[138:139], v146 offset:38912
    s_waitcnt lgkmcnt(4)
    v_mfma_f32_16x16x32_bf16 v[0:3], v[128:131], v[100:103], v[0:3]
    v_mfma_f32_16x16x32_bf16 v[16:19], v[128:131], v[108:111], v[16:19]
    ds_read_b64_tr_b16 v[140:141], v147 offset:36864
    ds_read_b64_tr_b16 v[142:143], v147 offset:38912
    s_waitcnt lgkmcnt(4)
    v_mfma_f32_16x16x32_bf16 v[4:7], v[132:135], v[100:103], v[4:7]
    v_mfma_f32_16x16x32_bf16 v[20:23], v[132:135], v[108:111], v[20:23]
    ds_read_b64_tr_b16 v[128:129], v144 offset:40960
    ds_read_b64_tr_b16 v[130:131], v144 offset:43008
    s_waitcnt lgkmcnt(4)
    v_mfma_f32_16x16x32_bf16 v[8:11], v[136:139], v[100:103], v[8:11]
    v_mfma_f32_16x16x32_bf16 v[24:27], v[136:139], v[108:111], v[24:27]
    ds_read_b64_tr_b16 v[132:133], v145 offset:40960
    ds_read_b64_tr_b16 v[134:135], v145 offset:43008
    s_waitcnt lgkmcnt(4)
    v_mfma_f32_16x16x32_bf16 v[12:15], v[140:143], v[100:103], v[12:15]
    v_mfma_f32_16x16x32_bf16 v[28:31], v[140:143], v[108:111], v[28:31]
    ds_read_b64_tr_b16 v[136:137], v146 offset:40960
    ds_read_b64_tr_b16 v[138:139], v146 offset:43008
    s_waitcnt vmcnt(0)
    s_waitcnt lgkmcnt(4)
    v_mfma_f32_16x16x32_bf16 v[0:3], v[128:131], v[112:115], v[0:3]
    v_mfma_f32_16x16x32_bf16 v[16:19], v[128:131], v[120:123], v[16:19]
    ds_read_b64_tr_b16 v[140:141], v147 offset:40960
    ds_read_b64_tr_b16 v[142:143], v147 offset:43008
    s_waitcnt lgkmcnt(4)
    v_mfma_f32_16x16x32_bf16 v[4:7], v[132:135], v[112:115], v[4:7]
    v_mfma_f32_16x16x32_bf16 v[20:23], v[132:135], v[120:123], v[20:23]
    ds_read_b64_tr_b16 v[128:129], v144 offset:45056
    ds_read_b64_tr_b16 v[130:131], v144 offset:47104
    s_waitcnt lgkmcnt(4)
    v_mfma_f32_16x16x32_bf16 v[8:11], v[136:139], v[112:115], v[8:11]
    v_mfma_f32_16x16x32_bf16 v[24:27], v[136:139], v[120:123], v[24:27]
    ds_read_b64_tr_b16 v[132:133], v145 offset:45056
    ds_read_b64_tr_b16 v[134:135], v145 offset:47104
    s_waitcnt lgkmcnt(4)
    v_mfma_f32_16x16x32_bf16 v[12:15], v[140:143], v[112:115], v[12:15]
    v_mfma_f32_16x16x32_bf16 v[28:31], v[140:143], v[120:123], v[28:31]
    ds_read_b64_tr_b16 v[136:137], v146 offset:45056
    ds_read_b64_tr_b16 v[138:139], v146 offset:47104
    s_waitcnt lgkmcnt(4)
    v_mfma_f32_16x16x32_bf16 v[0:3], v[128:131], v[116:119], v[0:3]
    v_mfma_f32_16x16x32_bf16 v[16:19], v[128:131], v[124:127], v[16:19]
    ds_read_b64_tr_b16 v[140:141], v147 offset:45056
    ds_read_b64_tr_b16 v[142:143], v147 offset:47104
    s_waitcnt lgkmcnt(4)
    v_mfma_f32_16x16x32_bf16 v[4:7], v[132:135], v[116:119], v[4:7]
    v_mfma_f32_16x16x32_bf16 v[20:23], v[132:135], v[124:127], v[20:23]
    s_waitcnt lgkmcnt(2)
    v_mfma_f32_16x16x32_bf16 v[8:11], v[136:139], v[116:119], v[8:11]
    v_mfma_f32_16x16x32_bf16 v[24:27], v[136:139], v[124:127], v[24:27]
    s_waitcnt lgkmcnt(0)
    v_mfma_f32_16x16x32_bf16 v[12:15], v[140:143], v[116:119], v[12:15]
    v_mfma_f32_16x16x32_bf16 v[28:31], v[140:143], v[124:127], v[28:31]
    v_cvt_pk_bf16_f32 v32, v0, v1
    v_cvt_pk_bf16_f32 v33, v2, v3
    ds_write_b64 v165, v[32:33] offset:0
    v_cvt_pk_bf16_f32 v34, v4, v5
    v_cvt_pk_bf16_f32 v35, v6, v7
    ds_write_b64 v165, v[34:35] offset:32
    v_cvt_pk_bf16_f32 v36, v8, v9
    v_cvt_pk_bf16_f32 v37, v10, v11
    ds_write_b64 v165, v[36:37] offset:64
    v_cvt_pk_bf16_f32 v38, v12, v13
    v_cvt_pk_bf16_f32 v39, v14, v15
    ds_write_b64 v165, v[38:39] offset:96
    v_cvt_pk_bf16_f32 v40, v16, v17
    v_cvt_pk_bf16_f32 v41, v18, v19
    ds_write_b64 v165, v[40:41] offset:2304
    v_cvt_pk_bf16_f32 v42, v20, v21
    v_cvt_pk_bf16_f32 v43, v22, v23
    ds_write_b64 v165, v[42:43] offset:2336
    v_cvt_pk_bf16_f32 v44, v24, v25
    v_cvt_pk_bf16_f32 v45, v26, v27
    ds_write_b64 v165, v[44:45] offset:2368
    v_cvt_pk_bf16_f32 v46, v28, v29
    v_cvt_pk_bf16_f32 v47, v30, v31
    ds_write_b64 v165, v[46:47] offset:2400
    ds_read_b128 v[48:51], v164 offset:0
    ds_read_b128 v[52:55], v164 offset:1152
    ds_read_b128 v[56:59], v164 offset:2304
    ds_read_b128 v[60:63], v164 offset:3456
    s_waitcnt lgkmcnt(3)
    buffer_store_dwordx4 v[48:51], v166, s[16:19], s60 offen
    s_waitcnt lgkmcnt(2)
    buffer_store_dwordx4 v[52:55], v166, s[16:19], s61 offen
    s_waitcnt lgkmcnt(1)
    buffer_store_dwordx4 v[56:59], v166, s[16:19], s62 offen
    s_waitcnt lgkmcnt(0)
    buffer_store_dwordx4 v[60:63], v166, s[16:19], s63 offen
    s_endpgm
k2_kernel_end:
    s_endpgm
.section .rodata,"a"
.p2align 6
.amdhsa_kernel k2_kernel
  .amdhsa_next_free_vgpr 168
  .amdhsa_next_free_sgpr 102
  .amdhsa_accum_offset 168
  .amdhsa_group_segment_fixed_size 0
  .amdhsa_kernarg_size 80
  .amdhsa_user_sgpr_count 2
  .amdhsa_user_sgpr_kernarg_segment_ptr 1
  .amdhsa_system_sgpr_workgroup_id_x 1
.end_amdhsa_kernel
```
